```python
import torch

def _softmax(x, axis=-1):
    return torch.softmax(x, dim=axis)
def _gelu(x):
    return torch.nn.functional.gelu(x, approximate="tanh")
def _silu(x):
    return torch.nn.functional.silu(x)
def _sigmoid(x):
    return torch.sigmoid(x)
def _layernorm(x, axis=-1, eps=1e-5):
    m = x.mean(dim=axis, keepdim=True)
    v = x.var(dim=axis, keepdim=True, unbiased=False)
    return (x - m) / torch.sqrt(v + eps)
def _scatter_add(tgt, idx, src, axis=0):
    return tgt.clone().index_add_(axis, idx, src)
def _segment_sum(src, seg, n):
    out = torch.zeros((n,) + src.shape[1:], dtype=src.dtype)
    return out.index_add_(0, seg, src)
def _pad(x, pw):
    flat = tuple(v for pair in reversed(pw) for v in pair)
    return torch.nn.functional.pad(x, flat)

kernel_name = 'parallel_sum__grouped_kv_mqa__glu_gated_bilinear__prompt'

def setup_inputs():

    _w = (lambda a: (lambda t: t.to(torch.bfloat16) if t.is_floating_point() else t)(torch.as_tensor(a)))
    def _A_setup():
        B, S, D, H = 1, 2048, 640, 32
        Dh = D // H
        return {
            "x": _w((lambda *s: torch.randn(*s, dtype=torch.bfloat16) * 0.05)(B, S, D)),
            "wq": _w((lambda *s: torch.randn(*s, dtype=torch.bfloat16) * 0.05)(D, H * Dh)),
            "wk": _w((lambda *s: torch.randn(*s, dtype=torch.bfloat16) * 0.05)(D, Dh)),
            "wv": _w((lambda *s: torch.randn(*s, dtype=torch.bfloat16) * 0.05)(D, Dh)),
            "wo": _w((lambda *s: torch.randn(*s, dtype=torch.bfloat16) * 0.05)(H * Dh, D)),
        }
    _A_in = _A_setup()

    def _B_setup():
        B, S, D, F = 1, 2048, 640, 1536
        return {
            "x": _w((lambda *s: torch.randn(*s, dtype=torch.bfloat16) * 0.05)(B, S, D)),
            "w_gate": _w((lambda *s: torch.randn(*s, dtype=torch.bfloat16) * 0.8)(D, F) * (D ** -0.5)),
            "w_up": _w((lambda *s: torch.randn(*s, dtype=torch.bfloat16) * 0.8)(D, F) * (D ** -0.5)),
            "w_down": _w((lambda *s: torch.randn(*s, dtype=torch.bfloat16) * 0.8)(F, D) * (F ** -0.5)),
        }
    _B_in = _B_setup()

    return {
        "A_x": _A_in["x"],
        "A_wq": _A_in["wq"],
        "A_wk": _A_in["wk"],
        "A_wv": _A_in["wv"],
        "A_wo": _A_in["wo"],
        "B_x": _B_in["x"],
        "B_w_gate": _B_in["w_gate"],
        "B_w_up": _B_in["w_up"],
        "B_w_down": _B_in["w_down"],
    }

def reference(A_x, A_wq, A_wk, A_wv, A_wo, B_x, B_w_gate, B_w_up, B_w_down):
    def _A_ref(x, wq, wk, wv, wo):
        B, S, D = x.shape
        H = 32
        Dh = D // H
        q = (lambda x, *d: x.permute(*d))((x @ wq).reshape(B, S, H, Dh), 0, 2, 1, 3)
        k = x @ wk
        v = x @ wv
        scores = torch.einsum("bhqd,bkd->bhqk", q, k) * (Dh ** -0.5)
        p = _softmax(scores, axis=-1)
        o = torch.einsum("bhqk,bkd->bhqd", p, v)
        return (lambda x, *d: x.permute(*d))(o, 0, 2, 1, 3).reshape(B, S, H * Dh) @ wo

    def _B_ref(x, w_gate, w_up, w_down):
        g = torch.einsum("bsd,df->bsf", x, w_gate)
        u = torch.einsum("bsd,df->bsf", x, w_up)
        h = g * u
        return torch.einsum("bsf,fd->bsd", h, w_down)

    x = A_x
    xn = _layernorm(x, axis=-1)
    return x + _A_ref(xn, A_wq, A_wk, A_wv, A_wo) + _B_ref(xn, B_w_gate, B_w_up, B_w_down)
```

```asm
; @launch grid=(256,1,1) block=(512,1,1) lds=155904
.amdgcn_target "amdgcn-amd-amdhsa--gfx950"
.text
.globl parallel_sum__grouped_kv_mqa__glu_gated_bilinear__prompt_kernel
.p2align 8
.type parallel_sum__grouped_kv_mqa__glu_gated_bilinear__prompt_kernel,@function
parallel_sum__grouped_kv_mqa__glu_gated_bilinear__prompt_kernel:
    s_cmp_ge_u32 s2, 256
    s_cbranch_scc1 L_end
    s_load_dwordx16 s[16:31], s[0:1], 0
    s_load_dwordx8 s[32:39], s[0:1], 64
    s_getpc_b64 s[72:73]
L_pc:
    s_lshr_b32 s74, s2, 3
    s_and_b32 s74, s74, 3
    s_mul_i32 s74, s74, 12288
    v_subrev_u32 v1, 416, v0
    v_cmp_gt_u32 vcc, 96, v1
    v_lshl_add_u32 v1, v1, 7, s74
    s_nop 0
    v_cndmask_b32 v1, 0, v1, vcc
    v_min_u32 v1, L_end-L_pc, v1
    global_load_dword v249, v1, s[72:73]
    v_lshrrev_b32 v1, 6, v0
    v_and_b32 v250, 63, v0
    v_readfirstlane_b32 s3, v1
    s_and_b32 s72, s2, 7
    s_lshr_b32 s66, s2, 3
    s_add_u32 s66, s66, 24
    s_and_b32 s66, s66, 31
    s_and_b32 s64, s72, 1
    s_lshr_b32 s65, s72, 1
    s_and_b32 s67, s3, 3
    s_lshr_b32 s68, s3, 2
    s_lshl_b32 s71, s64, 2
    s_and_b32 s73, s66, 3
    s_add_u32 s71, s71, s73
    s_lshl_b32 s71, s71, 8
    s_mul_i32 s87, s65, 6
    s_lshr_b32 s73, s66, 2
    s_add_u32 s87, s87, s73
    s_lshl_b32 s73, s64, 3
    s_add_u32 s73, s73, s66
    s_sub_u32 s73, s73, 24
    s_lshl_b32 s73, s73, 7
    s_cmp_lt_u32 s66, 24
    s_cselect_b32 s71, s71, s73
    s_cselect_b32 s87, s87, s65
    s_cselect_b32 s73, 6, 5
    v_and_b32 v251, 31, v0
    v_bfe_u32 v252, v0, 5, 1
    s_cmp_lg_u32 s68, 0
    s_cbranch_scc1 L_p0_h
    v_lshrrev_b32 v1, 3, v250
    v_lshrrev_b32 v2, 4, v250
    v_and_b32 v4, 7, v250
    v_xor_b32 v3, v2, v4
    s_lshl_b32 s74, s67, s73
    s_add_u32 s74, s74, s71
    v_add_u32 v5, s74, v1
    v_mul_u32_u24 v5, 1280, v5
    v_lshl_add_u32 v22, v3, 4, v5
    v_xor_b32 v3, 4, v3
    v_lshl_add_u32 v23, v3, 4, v5
    s_mul_i32 s74, s66, 3
    s_mul_i32 s75, s74, 205
    s_lshr_b32 s75, s75, 11
    s_mul_i32 s75, s75, 10
    s_sub_u32 s99, s74, s75
    s_mov_b32 s99, 0
    s_lshr_b32 s74, s66, 2
    s_xor_b32 s74, s74, s66
    s_and_b32 s74, s74, 1
    s_mul_i32 s99, s74, 5
    s_lshl_b32 s82, s99, 7
    s_cmp_lt_u32 s66, 24
    s_cbranch_scc1 L_g_l
L_q_l:
    s_cmp_eq_u32 s87, 3
    s_cselect_b32 s72, 40, 1280
    s_lshl_b32 s85, s72, 6
    v_and_b32 v2, 1, v2
    v_lshlrev_b32 v2, 2, v2
    v_xor_b32 v4, v4, v2
    s_lshl_b32 s73, s67, 4
    v_add_u32 v1, s73, v1
    v_mul_u32_u24 v3, 1280, v1
    v_lshl_add_u32 v3, v4, 4, v3
    s_mul_i32 s74, s87, 384
    v_add_u32 v24, s74, v3
    v_add_u32 v25, 128, v24
    v_add_u32 v190, 256, v24
    s_lshl_b32 s81, s67, 12
    s_lshl_b32 s80, s67, 11
    s_add_u32 s79, s80, 8192
    s_mov_b64 s[60:61], -1
    s_mov_b64 s[62:63], -1
    s_mul_i32 s83, s99, s85
    s_mul_i32 s99, s99, 81920
    s_lshr_b32 s84, s85, 3
    s_sub_u32 s84, s84, 1024
    s_waitcnt lgkmcnt(0)
    s_mov_b32 s40, s16
    s_mov_b32 s41, s17
    s_mov_b32 s42, 2621440
    s_mov_b32 s43, 0x00020000
    s_mov_b32 s52, s18
    s_mov_b32 s53, s19
    s_mov_b32 s54, 819200
    s_mov_b32 s55, 0x00020000
    s_mov_b32 s56, s18
    s_mov_b32 s57, s19
    s_mov_b32 s58, 819200
    s_mov_b32 s59, 0x00020000
    s_mov_b32 s88, s18
    s_mov_b32 s89, s19
    s_mov_b32 s90, 819200
    s_mov_b32 s91, 0x00020000
    s_cmp_eq_u32 s87, 3
    s_cbranch_scc0 L_q_l1
    s_mov_b64 s[56:57], s[20:21]
    s_mov_b64 s[88:89], s[22:23]
    s_mov_b32 s58, 25600
    s_mov_b32 s90, 25600
    s_mov_b32 s79, s80
    v_mul_u32_u24 v3, 40, v1
    v_and_b32 v2, 3, v4
    v_lshl_add_u32 v25, v2, 4, v3
    v_mov_b32 v190, v25
    v_cmp_gt_u32 s[60:61], 4, v4
    v_cmp_le_u32 s[62:63], 4, v4
L_q_l1:
    s_add_u32 m0, s81, 0
    s_add_u32 s75, s82, 0
    buffer_load_dwordx4 v22, s[40:43], s75 offen offset:0 lds
    s_add_u32 s75, s82, 9216
    buffer_load_dwordx4 v23, s[40:43], s75 offen offset:1024 lds
    s_add_u32 s75, s82, 18432
    buffer_load_dwordx4 v22, s[40:43], s75 offen offset:2048 lds
    s_add_u32 s75, s82, 27648
    buffer_load_dwordx4 v23, s[40:43], s75 offen offset:3072 lds
    s_add_u32 m0, s80, 16384
    s_add_u32 s75, s99, 9216
    buffer_load_dwordx4 v24, s[52:55], s99 offen lds
    buffer_load_dwordx4 v24, s[52:55], s75 offen offset:1024 lds
    s_add_u32 m0, s80, 24576
    s_mov_b64 exec, s[60:61]
    buffer_load_dwordx4 v25, s[56:59], s83 offen lds
    s_mov_b64 exec, -1
    s_add_u32 m0, s80, 25600
    s_add_u32 s75, s83, s84
    s_add_u32 s75, s75, 1024
    s_mov_b64 exec, s[60:61]
    buffer_load_dwordx4 v25, s[56:59], s75 offen lds
    s_mov_b64 exec, -1
    s_add_u32 m0, s79, 24576
    s_mov_b64 exec, s[62:63]
    buffer_load_dwordx4 v190, s[88:91], s83 offen lds
    s_mov_b64 exec, -1
    s_add_u32 m0, s79, 25600
    s_add_u32 s75, s83, s84
    s_add_u32 s75, s75, 1024
    s_mov_b64 exec, s[62:63]
    buffer_load_dwordx4 v190, s[88:91], s75 offen lds
    s_mov_b64 exec, -1
    s_add_u32 s82, s82, 128
    s_add_u32 s99, s99, 81920
    s_add_u32 s83, s83, s85
    s_cmp_eq_u32 s82, 1280
    s_cselect_b32 s82, 0, s82
    s_cselect_b32 s99, 0, s99
    s_cselect_b32 s83, 0, s83
    s_branch L_common
L_p0_h:
    s_lshl_b32 s72, s2, 3
    s_lshl_b32 s73, s67, 1
    s_add_u32 s72, s72, s73
    v_add_u32 v4, s72, v252
    v_mul_u32_u24 v5, 1280, v4
    v_lshl_add_u32 v5, v251, 3, v5
    v_lshlrev_b32 v255, 3, v4
    v_mov_b32 v242, 0
    s_mov_b32 s73, 3141632
    s_waitcnt lgkmcnt(0)
    s_mov_b32 s40, s16
    s_mov_b32 s41, s17
    s_mov_b32 s42, 2621440
    s_mov_b32 s43, 0x00020000
    s_mov_b32 s44, s38
    s_mov_b32 s45, s39
    s_mov_b32 s46, 17825792
    s_mov_b32 s47, 0x00020000
    buffer_load_dword v203, v242, s[44:47], s73 offen sc1
    buffer_load_dwordx2 v[192:193], v5, s[40:43], 0 offen offset:0
    buffer_load_dwordx2 v[194:195], v5, s[40:43], 0 offen offset:256
    buffer_load_dwordx2 v[196:197], v5, s[40:43], 0 offen offset:512
    buffer_load_dwordx2 v[198:199], v5, s[40:43], 0 offen offset:768
    buffer_load_dwordx2 v[200:201], v5, s[40:43], 0 offen offset:1024
L_common:
    s_mov_b32 s44, s38
    s_mov_b32 s45, s39
    s_mov_b32 s46, 17825792
    s_mov_b32 s47, 0x00020000
    s_mov_b32 s48, s36
    s_mov_b32 s49, s37
    s_mov_b32 s50, 256
    s_mov_b32 s51, 0x00020000
    s_and_b32 s101, s3, 1
    s_lshr_b32 s100, s3, 1
    s_mov_b32 s92, 0
    s_mov_b32 s93, -1
    v_lshlrev_b32 v253, 4, v250
    v_bfe_u32 v1, v251, 1, 3
    v_xor_b32 v1, v1, v252
    s_lshl_b32 s73, s100, 1
    v_xor_b32 v1, s73, v1
    v_lshlrev_b32 v2, 7, v251
    s_cmp_lt_u32 s66, 24
    s_cselect_b32 s72, 13, 12
    s_lshl_b32 s72, s100, s72
    v_add_u32 v2, s72, v2
    v_xor_b32 v3, 0, v1
    v_lshl_add_u32 v18, v3, 4, v2
    v_xor_b32 v3, 2, v1
    v_lshl_add_u32 v19, v3, 4, v2
    v_xor_b32 v3, 4, v1
    v_lshl_add_u32 v20, v3, 4, v2
    v_xor_b32 v3, 6, v1
    v_lshl_add_u32 v21, v3, 4, v2
    v_mov_b32 v26, 0
    v_mov_b32 v27, 0
    v_mov_b32 v28, 0
    v_mov_b32 v29, 0
    v_mov_b32 v30, 0
    v_mov_b32 v31, 0
    s_and_b32 s72, s2, 7
    s_lshl_b32 s69, s72, 3
    s_and_b32 s73, s66, 7
    s_add_u32 s69, s69, s73
    s_lshr_b32 s70, s66, 3
    s_mov_b32 s86, 0
    s_mov_b32 s98, 49408
    s_mov_b32 s78, 4294868480
    v_bfe_u32 v1, v250, 2, 2
    v_lshl_add_u32 v2, v252, 3, v1
    v_bfe_u32 v3, v250, 4, 1
    s_cmp_lt_u32 s66, 24
    s_cbranch_scc1 L_g_rd
L_q_rd:
    v_lshlrev_b32 v2, 7, v2
    v_lshl_add_u32 v2, v3, 5, v2
    v_and_b32 v3, 3, v250
    v_lshl_add_u32 v2, v3, 3, v2
    v_and_b32 v1, 2, v1
    v_lshl_add_u32 v2, v1, 5, v2
    s_lshl_b32 s72, s101, 6
    v_xor_b32 v2, s72, v2
    s_lshl_b32 s72, s101, 13
    s_add_u32 s74, s72, 16384
    s_xor_b32 s73, s100, 0
    s_lshl_b32 s73, s73, 11
    s_add_u32 s73, s73, s74
    v_add_u32 v10, s73, v2
    v_xor_b32 v11, 64, v10
    v_add_u32 v11, s72, v11
    s_xor_b32 s73, s100, 1
    s_lshl_b32 s73, s73, 11
    s_add_u32 s73, s73, s74
    v_add_u32 v12, s73, v2
    v_xor_b32 v13, 64, v12
    v_add_u32 v13, s72, v13
    s_xor_b32 s73, s100, 2
    s_lshl_b32 s73, s73, 11
    s_add_u32 s73, s73, s74
    v_add_u32 v14, s73, v2
    v_xor_b32 v15, 64, v14
    v_add_u32 v15, s72, v15
    s_xor_b32 s73, s100, 3
    s_lshl_b32 s73, s73, 11
    s_add_u32 s73, s73, s74
    v_add_u32 v16, s73, v2
    v_xor_b32 v17, 64, v16
    v_add_u32 v17, s72, v17
    s_cmp_lg_u32 s68, 0
    s_cbranch_scc1 L_q_h
    v_add_u32 v208, 49408, v10
    v_add_u32 v209, 49408, v11
    v_add_u32 v210, 49408, v12
    v_add_u32 v211, 49408, v13
    v_add_u32 v212, 49408, v14
    v_add_u32 v213, 49408, v15
    v_add_u32 v214, 49408, v16
    v_add_u32 v215, 49408, v17
    v_add_u32 v216, 49408, v18
    v_add_u32 v217, 49408, v19
    v_add_u32 v218, 49408, v20
    v_add_u32 v219, 49408, v21
    v_add_u32 v220, 98816, v10
    v_add_u32 v221, 98816, v11
    v_add_u32 v222, 98816, v12
    v_add_u32 v223, 98816, v13
    v_add_u32 v224, 98816, v14
    v_add_u32 v225, 98816, v15
    v_add_u32 v226, 98816, v16
    v_add_u32 v227, 98816, v17
    v_add_u32 v228, 98816, v18
    v_add_u32 v229, 98816, v19
    v_add_u32 v230, 98816, v20
    v_add_u32 v231, 98816, v21
    s_add_u32 m0, s81, 49408
    s_add_u32 s75, s82, 0
    buffer_load_dwordx4 v22, s[40:43], s75 offen offset:0 lds
    s_add_u32 s75, s82, 9216
    buffer_load_dwordx4 v23, s[40:43], s75 offen offset:1024 lds
    s_add_u32 s75, s82, 18432
    buffer_load_dwordx4 v22, s[40:43], s75 offen offset:2048 lds
    s_add_u32 s75, s82, 27648
    buffer_load_dwordx4 v23, s[40:43], s75 offen offset:3072 lds
    s_add_u32 m0, s80, 65792
    s_add_u32 s75, s99, 9216
    buffer_load_dwordx4 v24, s[52:55], s99 offen lds
    buffer_load_dwordx4 v24, s[52:55], s75 offen offset:1024 lds
    s_add_u32 m0, s80, 73984
    s_mov_b64 exec, s[60:61]
    buffer_load_dwordx4 v25, s[56:59], s83 offen lds
    s_mov_b64 exec, -1
    s_add_u32 m0, s80, 75008
    s_add_u32 s75, s83, s84
    s_add_u32 s75, s75, 1024
    s_mov_b64 exec, s[60:61]
    buffer_load_dwordx4 v25, s[56:59], s75 offen lds
    s_mov_b64 exec, -1
    s_add_u32 m0, s79, 73984
    s_mov_b64 exec, s[62:63]
    buffer_load_dwordx4 v190, s[88:91], s83 offen lds
    s_mov_b64 exec, -1
    s_add_u32 m0, s79, 75008
    s_add_u32 s75, s83, s84
    s_add_u32 s75, s75, 1024
    s_mov_b64 exec, s[62:63]
    buffer_load_dwordx4 v190, s[88:91], s75 offen lds
    s_mov_b64 exec, -1
    s_add_u32 s82, s82, 128
    s_add_u32 s99, s99, 81920
    s_add_u32 s83, s83, s85
    s_cmp_eq_u32 s82, 1280
    s_cselect_b32 s82, 0, s82
    s_cselect_b32 s99, 0, s99
    s_cselect_b32 s83, 0, s83
    s_waitcnt vmcnt(10)
    s_barrier
    ds_read_b128 v[44:47], v18
    ds_read_b64_tr_b16 v[32:33], v10 offset:0
    ds_read_b64_tr_b16 v[34:35], v10 offset:512
    ds_read_b64_tr_b16 v[36:37], v11 offset:0
    s_add_u32 m0, s81, 98816
    s_add_u32 s75, s82, 0
    buffer_load_dwordx4 v22, s[40:43], s75 offen offset:0 lds
    ds_read_b64_tr_b16 v[38:39], v11 offset:512
    ds_read_b64_tr_b16 v[40:41], v10 offset:8192
    ds_read_b64_tr_b16 v[42:43], v10 offset:8704
    s_add_u32 s75, s82, 9216
    buffer_load_dwordx4 v23, s[40:43], s75 offen offset:1024 lds
    s_add_u32 s75, s82, 18432
    buffer_load_dwordx4 v22, s[40:43], s75 offen offset:2048 lds
    ds_read_b128 v[60:63], v19
    ds_read_b64_tr_b16 v[48:49], v12 offset:0
    ds_read_b64_tr_b16 v[50:51], v12 offset:512
    ds_read_b64_tr_b16 v[52:53], v13 offset:0
    s_add_u32 s75, s82, 27648
    buffer_load_dwordx4 v23, s[40:43], s75 offen offset:3072 lds
    ds_read_b64_tr_b16 v[54:55], v13 offset:512
    ds_read_b64_tr_b16 v[56:57], v12 offset:8192
    ds_read_b64_tr_b16 v[58:59], v12 offset:8704
    s_add_u32 m0, s80, 115200
    s_add_u32 s75, s99, 9216
    buffer_load_dwordx4 v24, s[52:55], s99 offen lds
    buffer_load_dwordx4 v24, s[52:55], s75 offen offset:1024 lds
    s_waitcnt lgkmcnt(7)
    v_mfma_f32_32x32x16_bf16 v[64:79], v[32:35], v[44:47], 0
    ds_read_b128 v[140:143], v20
    ds_read_b64_tr_b16 v[128:129], v14 offset:0
    ds_read_b64_tr_b16 v[130:131], v14 offset:512
    ds_read_b64_tr_b16 v[132:133], v15 offset:0
    s_add_u32 m0, s80, 123392
    s_mov_b64 exec, s[60:61]
    buffer_load_dwordx4 v25, s[56:59], s83 offen lds
    s_mov_b64 exec, -1
    v_lshlrev_b32 v2, 16, v32
    v_and_b32 v3, 0xffff0000, v32
    v_add_f32 v26, v26, v2
    v_add_f32 v27, v27, v3
    v_mfma_f32_32x32x16_bf16 v[80:95], v[36:39], v[44:47], 0
    ds_read_b64_tr_b16 v[134:135], v15 offset:512
    ds_read_b64_tr_b16 v[136:137], v14 offset:8192
    ds_read_b64_tr_b16 v[138:139], v14 offset:8704
    s_add_u32 m0, s80, 124416
    s_add_u32 s75, s83, s84
    s_add_u32 s75, s75, 1024
    s_mov_b64 exec, s[60:61]
    buffer_load_dwordx4 v25, s[56:59], s75 offen lds
    s_mov_b64 exec, -1
    v_lshlrev_b32 v2, 16, v33
    v_and_b32 v3, 0xffff0000, v33
    v_add_f32 v26, v26, v2
    v_add_f32 v27, v27, v3
    v_mfma_f32_32x32x16_bf16 v[96:111], v[40:43], v[44:47], 0
    s_add_u32 m0, s79, 123392
    s_mov_b64 exec, s[62:63]
    buffer_load_dwordx4 v190, s[88:91], s83 offen lds
    s_mov_b64 exec, -1
    v_lshlrev_b32 v2, 16, v34
    v_and_b32 v3, 0xffff0000, v34
    v_add_f32 v26, v26, v2
    v_add_f32 v27, v27, v3
    s_waitcnt lgkmcnt(7)
    v_mfma_f32_32x32x16_bf16 v[64:79], v[48:51], v[60:63], v[64:79]
    ds_read_b128 v[156:159], v21
    ds_read_b64_tr_b16 v[144:145], v16 offset:0
    ds_read_b64_tr_b16 v[146:147], v16 offset:512
    ds_read_b64_tr_b16 v[148:149], v17 offset:0
    s_add_u32 m0, s79, 124416
    s_add_u32 s75, s83, s84
    s_add_u32 s75, s75, 1024
    s_mov_b64 exec, s[62:63]
    buffer_load_dwordx4 v190, s[88:91], s75 offen lds
    s_mov_b64 exec, -1
    s_add_u32 s82, s82, 128
    s_add_u32 s99, s99, 81920
    s_add_u32 s83, s83, s85
    s_cmp_eq_u32 s82, 1280
    s_cselect_b32 s82, 0, s82
    s_cselect_b32 s99, 0, s99
    s_cselect_b32 s83, 0, s83
    v_lshlrev_b32 v2, 16, v35
    v_and_b32 v3, 0xffff0000, v35
    v_add_f32 v26, v26, v2
    v_add_f32 v27, v27, v3
    v_mfma_f32_32x32x16_bf16 v[80:95], v[52:55], v[60:63], v[80:95]
    ds_read_b64_tr_b16 v[150:151], v17 offset:512
    ds_read_b64_tr_b16 v[152:153], v16 offset:8192
    ds_read_b64_tr_b16 v[154:155], v16 offset:8704
    v_lshlrev_b32 v2, 16, v36
    v_and_b32 v3, 0xffff0000, v36
    v_add_f32 v28, v28, v2
    v_add_f32 v29, v29, v3
    v_mfma_f32_32x32x16_bf16 v[96:111], v[56:59], v[60:63], v[96:111]
    v_lshlrev_b32 v2, 16, v37
    v_and_b32 v3, 0xffff0000, v37
    v_add_f32 v28, v28, v2
    v_add_f32 v29, v29, v3
    s_waitcnt lgkmcnt(0)
    s_waitcnt vmcnt(10)
    s_barrier
    v_mfma_f32_32x32x16_bf16 v[64:79], v[128:131], v[140:143], v[64:79]
    ds_read_b128 v[44:47], v216
    ds_read_b64_tr_b16 v[32:33], v208 offset:0
    ds_read_b64_tr_b16 v[34:35], v208 offset:512
    ds_read_b64_tr_b16 v[36:37], v209 offset:0
    s_add_u32 m0, s81, 0
    s_add_u32 s75, s82, 0
    buffer_load_dwordx4 v22, s[40:43], s75 offen offset:0 lds
    v_lshlrev_b32 v2, 16, v134
    v_and_b32 v3, 0xffff0000, v134
    v_add_f32 v28, v28, v2
    v_add_f32 v29, v29, v3
    v_lshlrev_b32 v254, 3, v250
    v_mfma_f32_32x32x16_bf16 v[80:95], v[132:135], v[140:143], v[80:95]
    ds_read_b64_tr_b16 v[38:39], v209 offset:512
    ds_read_b64_tr_b16 v[40:41], v208 offset:8192
    ds_read_b64_tr_b16 v[42:43], v208 offset:8704
    s_add_u32 s75, s82, 9216
    buffer_load_dwordx4 v23, s[40:43], s75 offen offset:1024 lds
    v_lshlrev_b32 v2, 16, v135
    v_and_b32 v3, 0xffff0000, v135
    v_add_f32 v28, v28, v2
    v_add_f32 v29, v29, v3
    v_mfma_f32_32x32x16_bf16 v[96:111], v[136:139], v[140:143], v[96:111]
    s_add_u32 s75, s82, 18432
    buffer_load_dwordx4 v22, s[40:43], s75 offen offset:2048 lds
    v_lshlrev_b32 v2, 16, v136
    v_and_b32 v3, 0xffff0000, v136
    v_add_f32 v30, v30, v2
    v_add_f32 v31, v31, v3
    v_mfma_f32_32x32x16_bf16 v[64:79], v[144:147], v[156:159], v[64:79]
    ds_read_b128 v[60:63], v217
    ds_read_b64_tr_b16 v[48:49], v210 offset:0
    ds_read_b64_tr_b16 v[50:51], v210 offset:512
    ds_read_b64_tr_b16 v[52:53], v211 offset:0
    s_add_u32 s75, s82, 27648
    buffer_load_dwordx4 v23, s[40:43], s75 offen offset:3072 lds
    v_lshlrev_b32 v2, 16, v137
    v_and_b32 v3, 0xffff0000, v137
    v_add_f32 v30, v30, v2
    v_add_f32 v31, v31, v3
    v_mov_b32 v4, 0x80000000
    v_mfma_f32_32x32x16_bf16 v[80:95], v[148:151], v[156:159], v[80:95]
    ds_read_b64_tr_b16 v[54:55], v211 offset:512
    ds_read_b64_tr_b16 v[56:57], v210 offset:8192
    ds_read_b64_tr_b16 v[58:59], v210 offset:8704
    s_add_u32 m0, s80, 16384
    s_add_u32 s75, s99, 9216
    buffer_load_dwordx4 v24, s[52:55], s99 offen lds
    v_lshlrev_b32 v2, 16, v138
    v_and_b32 v3, 0xffff0000, v138
    v_add_f32 v30, v30, v2
    v_add_f32 v31, v31, v3
    v_mfma_f32_32x32x16_bf16 v[96:111], v[152:155], v[156:159], v[96:111]
    buffer_load_dwordx4 v24, s[52:55], s75 offen offset:1024 lds
    v_lshlrev_b32 v2, 16, v139
    v_and_b32 v3, 0xffff0000, v139
    v_add_f32 v30, v30, v2
    v_add_f32 v31, v31, v3
    s_waitcnt lgkmcnt(7)
    v_mfma_f32_32x32x16_bf16 v[64:79], v[32:35], v[44:47], v[64:79]
    ds_read_b128 v[140:143], v218
    ds_read_b64_tr_b16 v[128:129], v212 offset:0
    ds_read_b64_tr_b16 v[130:131], v212 offset:512
    ds_read_b64_tr_b16 v[132:133], v213 offset:0
    s_add_u32 m0, s80, 24576
    s_mov_b64 exec, s[60:61]
    buffer_load_dwordx4 v25, s[56:59], s83 offen lds
    s_mov_b64 exec, -1
    v_lshlrev_b32 v2, 16, v32
    v_and_b32 v3, 0xffff0000, v32
    v_add_f32 v26, v26, v2
    v_add_f32 v27, v27, v3
    v_cndmask_b32 v254, v254, v4, s[92:93]
    v_mfma_f32_32x32x16_bf16 v[80:95], v[36:39], v[44:47], v[80:95]
    ds_read_b64_tr_b16 v[134:135], v213 offset:512
    ds_read_b64_tr_b16 v[136:137], v212 offset:8192
    ds_read_b64_tr_b16 v[138:139], v212 offset:8704
    s_add_u32 m0, s80, 25600
    s_add_u32 s75, s83, s84
    s_add_u32 s75, s75, 1024
    s_mov_b64 exec, s[60:61]
    buffer_load_dwordx4 v25, s[56:59], s75 offen lds
    s_mov_b64 exec, -1
    v_lshlrev_b32 v2, 16, v33
    v_and_b32 v3, 0xffff0000, v33
    v_add_f32 v26, v26, v2
    v_add_f32 v27, v27, v3
    v_mfma_f32_32x32x16_bf16 v[96:111], v[40:43], v[44:47], v[96:111]
    s_add_u32 m0, s79, 24576
    s_mov_b64 exec, s[62:63]
    buffer_load_dwordx4 v190, s[88:91], s83 offen lds
    s_mov_b64 exec, -1
    v_lshlrev_b32 v2, 16, v34
    v_and_b32 v3, 0xffff0000, v34
    v_add_f32 v26, v26, v2
    v_add_f32 v27, v27, v3
    s_waitcnt lgkmcnt(7)
    v_mfma_f32_32x32x16_bf16 v[64:79], v[48:51], v[60:63], v[64:79]
    ds_read_b128 v[156:159], v219
    ds_read_b64_tr_b16 v[144:145], v214 offset:0
    ds_read_b64_tr_b16 v[146:147], v214 offset:512
    ds_read_b64_tr_b16 v[148:149], v215 offset:0
    s_add_u32 m0, s79, 25600
    s_add_u32 s75, s83, s84
    s_add_u32 s75, s75, 1024
    s_mov_b64 exec, s[62:63]
    buffer_load_dwordx4 v190, s[88:91], s75 offen lds
    s_mov_b64 exec, -1
    s_add_u32 s82, s82, 128
    s_add_u32 s99, s99, 81920
    s_add_u32 s83, s83, s85
    s_cmp_eq_u32 s82, 1280
    s_cselect_b32 s82, 0, s82
    s_cselect_b32 s99, 0, s99
    s_cselect_b32 s83, 0, s83
    v_lshlrev_b32 v2, 16, v35
    v_and_b32 v3, 0xffff0000, v35
    v_add_f32 v26, v26, v2
    v_add_f32 v27, v27, v3
    v_mfma_f32_32x32x16_bf16 v[80:95], v[52:55], v[60:63], v[80:95]
    ds_read_b64_tr_b16 v[150:151], v215 offset:512
    ds_read_b64_tr_b16 v[152:153], v214 offset:8192
    ds_read_b64_tr_b16 v[154:155], v214 offset:8704
    v_lshlrev_b32 v2, 16, v36
    v_and_b32 v3, 0xffff0000, v36
    v_add_f32 v28, v28, v2
    v_add_f32 v29, v29, v3
    v_mfma_f32_32x32x16_bf16 v[96:111], v[56:59], v[60:63], v[96:111]
    v_lshlrev_b32 v2, 16, v37
    v_and_b32 v3, 0xffff0000, v37
    v_add_f32 v28, v28, v2
    v_add_f32 v29, v29, v3
    s_waitcnt lgkmcnt(0)
    s_waitcnt vmcnt(10)
    s_barrier
    v_mfma_f32_32x32x16_bf16 v[64:79], v[128:131], v[140:143], v[64:79]
    ds_read_b128 v[44:47], v228
    ds_read_b64_tr_b16 v[32:33], v220 offset:0
    ds_read_b64_tr_b16 v[34:35], v220 offset:512
    ds_read_b64_tr_b16 v[36:37], v221 offset:0
    s_add_u32 m0, s81, 49408
    s_add_u32 s75, s82, 0
    buffer_load_dwordx4 v22, s[40:43], s75 offen offset:0 lds
    v_lshlrev_b32 v2, 16, v134
    v_and_b32 v3, 0xffff0000, v134
    v_add_f32 v28, v28, v2
    v_add_f32 v29, v29, v3
    v_mul_u32_u24 v5, 21, v252
    v_mfma_f32_32x32x16_bf16 v[80:95], v[132:135], v[140:143], v[80:95]
    ds_read_b64_tr_b16 v[38:39], v221 offset:512
    ds_read_b64_tr_b16 v[40:41], v220 offset:8192
    ds_read_b64_tr_b16 v[42:43], v220 offset:8704
    s_add_u32 s75, s82, 9216
    buffer_load_dwordx4 v23, s[40:43], s75 offen offset:1024 lds
    v_lshlrev_b32 v2, 16, v135
    v_and_b32 v3, 0xffff0000, v135
    v_add_f32 v28, v28, v2
    v_add_f32 v29, v29, v3
    v_mfma_f32_32x32x16_bf16 v[96:111], v[136:139], v[140:143], v[96:111]
    s_add_u32 s75, s82, 18432
    buffer_load_dwordx4 v22, s[40:43], s75 offen offset:2048 lds
    v_lshlrev_b32 v2, 16, v136
    v_and_b32 v3, 0xffff0000, v136
    v_add_f32 v30, v30, v2
    v_add_f32 v31, v31, v3
    v_mfma_f32_32x32x16_bf16 v[64:79], v[144:147], v[156:159], v[64:79]
    ds_read_b128 v[60:63], v229
    ds_read_b64_tr_b16 v[48:49], v222 offset:0
    ds_read_b64_tr_b16 v[50:51], v222 offset:512
    ds_read_b64_tr_b16 v[52:53], v223 offset:0
    s_add_u32 s75, s82, 27648
    buffer_load_dwordx4 v23, s[40:43], s75 offen offset:3072 lds
    v_lshlrev_b32 v2, 16, v137
    v_and_b32 v3, 0xffff0000, v137
    v_add_f32 v30, v30, v2
    v_add_f32 v31, v31, v3
    v_add_lshl_u32 v5, v5, v251, 4
    v_mfma_f32_32x32x16_bf16 v[80:95], v[148:151], v[156:159], v[80:95]
    ds_read_b64_tr_b16 v[54:55], v223 offset:512
    ds_read_b64_tr_b16 v[56:57], v222 offset:8192
    ds_read_b64_tr_b16 v[58:59], v222 offset:8704
    s_add_u32 m0, s80, 65792
    s_add_u32 s75, s99, 9216
    buffer_load_dwordx4 v24, s[52:55], s99 offen lds
    v_lshlrev_b32 v2, 16, v138
    v_and_b32 v3, 0xffff0000, v138
    v_add_f32 v30, v30, v2
    v_add_f32 v31, v31, v3
    v_mfma_f32_32x32x16_bf16 v[96:111], v[152:155], v[156:159], v[96:111]
    buffer_load_dwordx4 v24, s[52:55], s75 offen offset:1024 lds
    v_lshlrev_b32 v2, 16, v139
    v_and_b32 v3, 0xffff0000, v139
    v_add_f32 v30, v30, v2
    v_add_f32 v31, v31, v3
    s_waitcnt lgkmcnt(7)
    v_mfma_f32_32x32x16_bf16 v[64:79], v[32:35], v[44:47], v[64:79]
    ds_read_b128 v[140:143], v230
    ds_read_b64_tr_b16 v[128:129], v224 offset:0
    ds_read_b64_tr_b16 v[130:131], v224 offset:512
    ds_read_b64_tr_b16 v[132:133], v225 offset:0
    s_add_u32 m0, s80, 73984
    s_mov_b64 exec, s[60:61]
    buffer_load_dwordx4 v25, s[56:59], s83 offen lds
    s_mov_b64 exec, -1
    v_lshlrev_b32 v2, 16, v32
    v_and_b32 v3, 0xffff0000, v32
    v_add_f32 v26, v26, v2
    v_add_f32 v27, v27, v3
    v_cmp_gt_u32 vcc, 21, v251
    v_mfma_f32_32x32x16_bf16 v[80:95], v[36:39], v[44:47], v[80:95]
    ds_read_b64_tr_b16 v[134:135], v225 offset:512
    ds_read_b64_tr_b16 v[136:137], v224 offset:8192
    ds_read_b64_tr_b16 v[138:139], v224 offset:8704
    s_add_u32 m0, s80, 75008
    s_add_u32 s75, s83, s84
    s_add_u32 s75, s75, 1024
    s_mov_b64 exec, s[60:61]
    buffer_load_dwordx4 v25, s[56:59], s75 offen lds
    s_mov_b64 exec, -1
    v_lshlrev_b32 v2, 16, v33
    v_and_b32 v3, 0xffff0000, v33
    v_add_f32 v26, v26, v2
    v_add_f32 v27, v27, v3
    v_mfma_f32_32x32x16_bf16 v[96:111], v[40:43], v[44:47], v[96:111]
    s_add_u32 m0, s79, 73984
    s_mov_b64 exec, s[62:63]
    buffer_load_dwordx4 v190, s[88:91], s83 offen lds
    s_mov_b64 exec, -1
    v_lshlrev_b32 v2, 16, v34
    v_and_b32 v3, 0xffff0000, v34
    v_add_f32 v26, v26, v2
    v_add_f32 v27, v27, v3
    s_waitcnt lgkmcnt(7)
    v_mfma_f32_32x32x16_bf16 v[64:79], v[48:51], v[60:63], v[64:79]
    ds_read_b128 v[156:159], v231
    ds_read_b64_tr_b16 v[144:145], v226 offset:0
    ds_read_b64_tr_b16 v[146:147], v226 offset:512
    ds_read_b64_tr_b16 v[148:149], v227 offset:0
    s_add_u32 m0, s79, 75008
    s_add_u32 s75, s83, s84
    s_add_u32 s75, s75, 1024
    s_mov_b64 exec, s[62:63]
    buffer_load_dwordx4 v190, s[88:91], s75 offen lds
    s_mov_b64 exec, -1
    s_add_u32 s82, s82, 128
    s_add_u32 s99, s99, 81920
    s_add_u32 s83, s83, s85
    s_cmp_eq_u32 s82, 1280
    s_cselect_b32 s82, 0, s82
    s_cselect_b32 s99, 0, s99
    s_cselect_b32 s83, 0, s83
    v_lshlrev_b32 v2, 16, v35
    v_and_b32 v3, 0xffff0000, v35
    v_add_f32 v26, v26, v2
    v_add_f32 v27, v27, v3
    v_mfma_f32_32x32x16_bf16 v[80:95], v[52:55], v[60:63], v[80:95]
    ds_read_b64_tr_b16 v[150:151], v227 offset:512
    ds_read_b64_tr_b16 v[152:153], v226 offset:8192
    ds_read_b64_tr_b16 v[154:155], v226 offset:8704
    v_lshlrev_b32 v2, 16, v36
    v_and_b32 v3, 0xffff0000, v36
    v_add_f32 v28, v28, v2
    v_add_f32 v29, v29, v3
    v_mfma_f32_32x32x16_bf16 v[96:111], v[56:59], v[60:63], v[96:111]
    v_lshlrev_b32 v2, 16, v37
    v_and_b32 v3, 0xffff0000, v37
    v_add_f32 v28, v28, v2
    v_add_f32 v29, v29, v3
    s_waitcnt lgkmcnt(0)
    s_waitcnt vmcnt(10)
    s_barrier
    v_mfma_f32_32x32x16_bf16 v[64:79], v[128:131], v[140:143], v[64:79]
    ds_read_b128 v[44:47], v18
    ds_read_b64_tr_b16 v[32:33], v10 offset:0
    ds_read_b64_tr_b16 v[34:35], v10 offset:512
    ds_read_b64_tr_b16 v[36:37], v11 offset:0
    s_add_u32 m0, s81, 98816
    s_add_u32 s75, s82, 0
    buffer_load_dwordx4 v22, s[40:43], s75 offen offset:0 lds
    v_lshlrev_b32 v2, 16, v134
    v_and_b32 v3, 0xffff0000, v134
    v_add_f32 v28, v28, v2
    v_add_f32 v29, v29, v3
    s_nop 1
    v_mfma_f32_32x32x16_bf16 v[80:95], v[132:135], v[140:143], v[80:95]
    ds_read_b64_tr_b16 v[38:39], v11 offset:512
    ds_read_b64_tr_b16 v[40:41], v10 offset:8192
    ds_read_b64_tr_b16 v[42:43], v10 offset:8704
    s_add_u32 s75, s82, 9216
    buffer_load_dwordx4 v23, s[40:43], s75 offen offset:1024 lds
    v_lshlrev_b32 v2, 16, v135
    v_and_b32 v3, 0xffff0000, v135
    v_add_f32 v28, v28, v2
    v_add_f32 v29, v29, v3
    v_mfma_f32_32x32x16_bf16 v[96:111], v[136:139], v[140:143], v[96:111]
    s_add_u32 s75, s82, 18432
    buffer_load_dwordx4 v22, s[40:43], s75 offen offset:2048 lds
    v_lshlrev_b32 v2, 16, v136
    v_and_b32 v3, 0xffff0000, v136
    v_add_f32 v30, v30, v2
    v_add_f32 v31, v31, v3
    v_mfma_f32_32x32x16_bf16 v[64:79], v[144:147], v[156:159], v[64:79]
    ds_read_b128 v[60:63], v19
    ds_read_b64_tr_b16 v[48:49], v12 offset:0
    ds_read_b64_tr_b16 v[50:51], v12 offset:512
    ds_read_b64_tr_b16 v[52:53], v13 offset:0
    s_add_u32 s75, s82, 27648
    buffer_load_dwordx4 v23, s[40:43], s75 offen offset:3072 lds
    v_lshlrev_b32 v2, 16, v137
    v_and_b32 v3, 0xffff0000, v137
    v_add_f32 v30, v30, v2
    v_add_f32 v31, v31, v3
    v_cndmask_b32 v0, v4, v5, vcc
    v_mfma_f32_32x32x16_bf16 v[80:95], v[148:151], v[156:159], v[80:95]
    ds_read_b64_tr_b16 v[54:55], v13 offset:512
    ds_read_b64_tr_b16 v[56:57], v12 offset:8192
    ds_read_b64_tr_b16 v[58:59], v12 offset:8704
    s_add_u32 m0, s80, 115200
    s_add_u32 s75, s99, 9216
    buffer_load_dwordx4 v24, s[52:55], s99 offen lds
    v_lshlrev_b32 v2, 16, v138
    v_and_b32 v3, 0xffff0000, v138
    v_add_f32 v30, v30, v2
    v_add_f32 v31, v31, v3
    v_mfma_f32_32x32x16_bf16 v[96:111], v[152:155], v[156:159], v[96:111]
    buffer_load_dwordx4 v24, s[52:55], s75 offen offset:1024 lds
    v_lshlrev_b32 v2, 16, v139
    v_and_b32 v3, 0xffff0000, v139
    v_add_f32 v30, v30, v2
    v_add_f32 v31, v31, v3
    s_waitcnt lgkmcnt(7)
    v_mfma_f32_32x32x16_bf16 v[64:79], v[32:35], v[44:47], v[64:79]
    ds_read_b128 v[140:143], v20
    ds_read_b64_tr_b16 v[128:129], v14 offset:0
    ds_read_b64_tr_b16 v[130:131], v14 offset:512
    ds_read_b64_tr_b16 v[132:133], v15 offset:0
    s_add_u32 m0, s80, 123392
    s_mov_b64 exec, s[60:61]
    buffer_load_dwordx4 v25, s[56:59], s83 offen lds
    s_mov_b64 exec, -1
    v_lshlrev_b32 v2, 16, v32
    v_and_b32 v3, 0xffff0000, v32
    v_add_f32 v26, v26, v2
    v_add_f32 v27, v27, v3
    s_lshl_b32 s72, s3, 2
    v_mfma_f32_32x32x16_bf16 v[80:95], v[36:39], v[44:47], v[80:95]
    ds_read_b64_tr_b16 v[134:135], v15 offset:512
    ds_read_b64_tr_b16 v[136:137], v14 offset:8192
    ds_read_b64_tr_b16 v[138:139], v14 offset:8704
    s_add_u32 m0, s80, 124416
    s_add_u32 s75, s83, s84
    s_add_u32 s75, s75, 1024
    s_mov_b64 exec, s[60:61]
    buffer_load_dwordx4 v25, s[56:59], s75 offen lds
    s_mov_b64 exec, -1
    v_lshlrev_b32 v2, 16, v33
    v_and_b32 v3, 0xffff0000, v33
    v_add_f32 v26, v26, v2
    v_add_f32 v27, v27, v3
    v_mfma_f32_32x32x16_bf16 v[96:111], v[40:43], v[44:47], v[96:111]
    s_add_u32 m0, s79, 123392
    s_mov_b64 exec, s[62:63]
    buffer_load_dwordx4 v190, s[88:91], s83 offen lds
    s_mov_b64 exec, -1
    v_lshlrev_b32 v2, 16, v34
    v_and_b32 v3, 0xffff0000, v34
    v_add_f32 v26, v26, v2
    v_add_f32 v27, v27, v3
    s_waitcnt lgkmcnt(7)
    v_mfma_f32_32x32x16_bf16 v[64:79], v[48:51], v[60:63], v[64:79]
    ds_read_b128 v[156:159], v21
    ds_read_b64_tr_b16 v[144:145], v16 offset:0
    ds_read_b64_tr_b16 v[146:147], v16 offset:512
    ds_read_b64_tr_b16 v[148:149], v17 offset:0
    s_add_u32 m0, s79, 124416
    s_add_u32 s75, s83, s84
    s_add_u32 s75, s75, 1024
    s_mov_b64 exec, s[62:63]
    buffer_load_dwordx4 v190, s[88:91], s75 offen lds
    s_mov_b64 exec, -1
    s_add_u32 s82, s82, 128
    s_add_u32 s99, s99, 81920
    s_add_u32 s83, s83, s85
    s_cmp_eq_u32 s82, 1280
    s_cselect_b32 s82, 0, s82
    s_cselect_b32 s99, 0, s99
    s_cselect_b32 s83, 0, s83
    v_lshlrev_b32 v2, 16, v35
    v_and_b32 v3, 0xffff0000, v35
    v_add_f32 v26, v26, v2
    v_add_f32 v27, v27, v3
    v_mfma_f32_32x32x16_bf16 v[80:95], v[52:55], v[60:63], v[80:95]
    ds_read_b64_tr_b16 v[150:151], v17 offset:512
    ds_read_b64_tr_b16 v[152:153], v16 offset:8192
    ds_read_b64_tr_b16 v[154:155], v16 offset:8704
    v_lshlrev_b32 v2, 16, v36
    v_and_b32 v3, 0xffff0000, v36
    v_add_f32 v28, v28, v2
    v_add_f32 v29, v29, v3
    v_mfma_f32_32x32x16_bf16 v[96:111], v[56:59], v[60:63], v[96:111]
    v_lshlrev_b32 v2, 16, v37
    v_and_b32 v3, 0xffff0000, v37
    v_add_f32 v28, v28, v2
    v_add_f32 v29, v29, v3
    s_waitcnt lgkmcnt(0)
    s_waitcnt vmcnt(10)
    s_barrier
    v_mfma_f32_32x32x16_bf16 v[64:79], v[128:131], v[140:143], v[64:79]
    ds_read_b128 v[44:47], v216
    ds_read_b64_tr_b16 v[32:33], v208 offset:0
    ds_read_b64_tr_b16 v[34:35], v208 offset:512
    ds_read_b64_tr_b16 v[36:37], v209 offset:0
    s_add_u32 m0, s81, 0
    s_add_u32 s75, s82, 0
    buffer_load_dwordx4 v22, s[40:43], s75 offen offset:0 lds
    v_lshlrev_b32 v2, 16, v134
    v_and_b32 v3, 0xffff0000, v134
    v_add_f32 v28, v28, v2
    v_add_f32 v29, v29, v3
    s_add_u32 s72, s72, 155648
    v_mfma_f32_32x32x16_bf16 v[80:95], v[132:135], v[140:143], v[80:95]
    ds_read_b64_tr_b16 v[38:39], v209 offset:512
    ds_read_b64_tr_b16 v[40:41], v208 offset:8192
    ds_read_b64_tr_b16 v[42:43], v208 offset:8704
    s_add_u32 s75, s82, 9216
    buffer_load_dwordx4 v23, s[40:43], s75 offen offset:1024 lds
    v_lshlrev_b32 v2, 16, v135
    v_and_b32 v3, 0xffff0000, v135
    v_add_f32 v28, v28, v2
    v_add_f32 v29, v29, v3
    v_mfma_f32_32x32x16_bf16 v[96:111], v[136:139], v[140:143], v[96:111]
    s_add_u32 s75, s82, 18432
    buffer_load_dwordx4 v22, s[40:43], s75 offen offset:2048 lds
    v_lshlrev_b32 v2, 16, v136
    v_and_b32 v3, 0xffff0000, v136
    v_add_f32 v30, v30, v2
    v_add_f32 v31, v31, v3
    v_mfma_f32_32x32x16_bf16 v[64:79], v[144:147], v[156:159], v[64:79]
    ds_read_b128 v[60:63], v217
    ds_read_b64_tr_b16 v[48:49], v210 offset:0
    ds_read_b64_tr_b16 v[50:51], v210 offset:512
    ds_read_b64_tr_b16 v[52:53], v211 offset:0
    s_add_u32 s75, s82, 27648
    buffer_load_dwordx4 v23, s[40:43], s75 offen offset:3072 lds
    v_lshlrev_b32 v2, 16, v137
    v_and_b32 v3, 0xffff0000, v137
    v_add_f32 v30, v30, v2
    v_add_f32 v31, v31, v3
    v_mov_b32 v248, s72
    v_mfma_f32_32x32x16_bf16 v[80:95], v[148:151], v[156:159], v[80:95]
    ds_read_b64_tr_b16 v[54:55], v211 offset:512
    ds_read_b64_tr_b16 v[56:57], v210 offset:8192
    ds_read_b64_tr_b16 v[58:59], v210 offset:8704
    s_add_u32 m0, s80, 16384
    s_add_u32 s75, s99, 9216
    buffer_load_dwordx4 v24, s[52:55], s99 offen lds
    v_lshlrev_b32 v2, 16, v138
    v_and_b32 v3, 0xffff0000, v138
    v_add_f32 v30, v30, v2
    v_add_f32 v31, v31, v3
    v_mfma_f32_32x32x16_bf16 v[96:111], v[152:155], v[156:159], v[96:111]
    buffer_load_dwordx4 v24, s[52:55], s75 offen offset:1024 lds
    v_lshlrev_b32 v2, 16, v139
    v_and_b32 v3, 0xffff0000, v139
    v_add_f32 v30, v30, v2
    v_add_f32 v31, v31, v3
    s_waitcnt lgkmcnt(7)
    v_mfma_f32_32x32x16_bf16 v[64:79], v[32:35], v[44:47], v[64:79]
    ds_read_b128 v[140:143], v218
    ds_read_b64_tr_b16 v[128:129], v212 offset:0
    ds_read_b64_tr_b16 v[130:131], v212 offset:512
    ds_read_b64_tr_b16 v[132:133], v213 offset:0
    s_add_u32 m0, s80, 24576
    s_mov_b64 exec, s[60:61]
    buffer_load_dwordx4 v25, s[56:59], s83 offen lds
    s_mov_b64 exec, -1
    v_lshlrev_b32 v2, 16, v32
    v_and_b32 v3, 0xffff0000, v32
    v_add_f32 v26, v26, v2
    v_add_f32 v27, v27, v3
    v_mov_b32 v243, 0
    v_mfma_f32_32x32x16_bf16 v[80:95], v[36:39], v[44:47], v[80:95]
    ds_read_b64_tr_b16 v[134:135], v213 offset:512
    ds_read_b64_tr_b16 v[136:137], v212 offset:8192
    ds_read_b64_tr_b16 v[138:139], v212 offset:8704
    s_add_u32 m0, s80, 25600
    s_add_u32 s75, s83, s84
    s_add_u32 s75, s75, 1024
    s_mov_b64 exec, s[60:61]
    buffer_load_dwordx4 v25, s[56:59], s75 offen lds
    s_mov_b64 exec, -1
    v_lshlrev_b32 v2, 16, v33
    v_and_b32 v3, 0xffff0000, v33
    v_add_f32 v26, v26, v2
    v_add_f32 v27, v27, v3
    v_mfma_f32_32x32x16_bf16 v[96:111], v[40:43], v[44:47], v[96:111]
    s_add_u32 m0, s79, 24576
    s_mov_b64 exec, s[62:63]
    buffer_load_dwordx4 v190, s[88:91], s83 offen lds
    s_mov_b64 exec, -1
    v_lshlrev_b32 v2, 16, v34
    v_and_b32 v3, 0xffff0000, v34
    v_add_f32 v26, v26, v2
    v_add_f32 v27, v27, v3
    s_waitcnt lgkmcnt(7)
    v_mfma_f32_32x32x16_bf16 v[64:79], v[48:51], v[60:63], v[64:79]
    ds_read_b128 v[156:159], v219
    ds_read_b64_tr_b16 v[144:145], v214 offset:0
    ds_read_b64_tr_b16 v[146:147], v214 offset:512
    ds_read_b64_tr_b16 v[148:149], v215 offset:0
    s_add_u32 m0, s79, 25600
    s_add_u32 s75, s83, s84
    s_add_u32 s75, s75, 1024
    s_mov_b64 exec, s[62:63]
    buffer_load_dwordx4 v190, s[88:91], s75 offen lds
    s_mov_b64 exec, -1
    s_add_u32 s82, s82, 128
    s_add_u32 s99, s99, 81920
    s_add_u32 s83, s83, s85
    s_cmp_eq_u32 s82, 1280
    s_cselect_b32 s82, 0, s82
    s_cselect_b32 s99, 0, s99
    s_cselect_b32 s83, 0, s83
    v_lshlrev_b32 v2, 16, v35
    v_and_b32 v3, 0xffff0000, v35
    v_add_f32 v26, v26, v2
    v_add_f32 v27, v27, v3
    v_mfma_f32_32x32x16_bf16 v[80:95], v[52:55], v[60:63], v[80:95]
    ds_read_b64_tr_b16 v[150:151], v215 offset:512
    ds_read_b64_tr_b16 v[152:153], v214 offset:8192
    ds_read_b64_tr_b16 v[154:155], v214 offset:8704
    v_lshlrev_b32 v2, 16, v36
    v_and_b32 v3, 0xffff0000, v36
    v_add_f32 v28, v28, v2
    v_add_f32 v29, v29, v3
    v_mfma_f32_32x32x16_bf16 v[96:111], v[56:59], v[60:63], v[96:111]
    v_lshlrev_b32 v2, 16, v37
    v_and_b32 v3, 0xffff0000, v37
    v_add_f32 v28, v28, v2
    v_add_f32 v29, v29, v3
    s_waitcnt lgkmcnt(0)
    s_waitcnt vmcnt(10)
    s_barrier
    v_mfma_f32_32x32x16_bf16 v[64:79], v[128:131], v[140:143], v[64:79]
    ds_read_b128 v[44:47], v228
    ds_read_b64_tr_b16 v[32:33], v220 offset:0
    ds_read_b64_tr_b16 v[34:35], v220 offset:512
    ds_read_b64_tr_b16 v[36:37], v221 offset:0
    s_add_u32 m0, s81, 49408
    s_add_u32 s75, s82, 0
    buffer_load_dwordx4 v22, s[40:43], s75 offen offset:0 lds
    v_lshlrev_b32 v2, 16, v134
    v_and_b32 v3, 0xffff0000, v134
    v_add_f32 v28, v28, v2
    v_add_f32 v29, v29, v3
    v_mov_b32 v244, 0
    v_mfma_f32_32x32x16_bf16 v[80:95], v[132:135], v[140:143], v[80:95]
    ds_read_b64_tr_b16 v[38:39], v221 offset:512
    ds_read_b64_tr_b16 v[40:41], v220 offset:8192
    ds_read_b64_tr_b16 v[42:43], v220 offset:8704
    s_add_u32 s75, s82, 9216
    buffer_load_dwordx4 v23, s[40:43], s75 offen offset:1024 lds
    v_lshlrev_b32 v2, 16, v135
    v_and_b32 v3, 0xffff0000, v135
    v_add_f32 v28, v28, v2
    v_add_f32 v29, v29, v3
    v_mfma_f32_32x32x16_bf16 v[96:111], v[136:139], v[140:143], v[96:111]
    s_add_u32 s75, s82, 18432
    buffer_load_dwordx4 v22, s[40:43], s75 offen offset:2048 lds
    v_lshlrev_b32 v2, 16, v136
    v_and_b32 v3, 0xffff0000, v136
    v_add_f32 v30, v30, v2
    v_add_f32 v31, v31, v3
    v_mfma_f32_32x32x16_bf16 v[64:79], v[144:147], v[156:159], v[64:79]
    ds_read_b128 v[60:63], v229
    ds_read_b64_tr_b16 v[48:49], v222 offset:0
    ds_read_b64_tr_b16 v[50:51], v222 offset:512
    ds_read_b64_tr_b16 v[52:53], v223 offset:0
    s_add_u32 s75, s82, 27648
    buffer_load_dwordx4 v23, s[40:43], s75 offen offset:3072 lds
    v_lshlrev_b32 v2, 16, v137
    v_and_b32 v3, 0xffff0000, v137
    v_add_f32 v30, v30, v2
    v_add_f32 v31, v31, v3
    v_mov_b32 v245, 0
    v_mfma_f32_32x32x16_bf16 v[80:95], v[148:151], v[156:159], v[80:95]
    ds_read_b64_tr_b16 v[54:55], v223 offset:512
    ds_read_b64_tr_b16 v[56:57], v222 offset:8192
    ds_read_b64_tr_b16 v[58:59], v222 offset:8704
    s_add_u32 m0, s80, 65792
    s_add_u32 s75, s99, 9216
    buffer_load_dwordx4 v24, s[52:55], s99 offen lds
    v_lshlrev_b32 v2, 16, v138
    v_and_b32 v3, 0xffff0000, v138
    v_add_f32 v30, v30, v2
    v_add_f32 v31, v31, v3
    v_mfma_f32_32x32x16_bf16 v[96:111], v[152:155], v[156:159], v[96:111]
    buffer_load_dwordx4 v24, s[52:55], s75 offen offset:1024 lds
    v_lshlrev_b32 v2, 16, v139
    v_and_b32 v3, 0xffff0000, v139
    v_add_f32 v30, v30, v2
    v_add_f32 v31, v31, v3
    s_waitcnt lgkmcnt(7)
    v_mfma_f32_32x32x16_bf16 v[64:79], v[32:35], v[44:47], v[64:79]
    ds_read_b128 v[140:143], v230
    ds_read_b64_tr_b16 v[128:129], v224 offset:0
    ds_read_b64_tr_b16 v[130:131], v224 offset:512
    ds_read_b64_tr_b16 v[132:133], v225 offset:0
    s_add_u32 m0, s80, 73984
    s_mov_b64 exec, s[60:61]
    buffer_load_dwordx4 v25, s[56:59], s83 offen lds
    s_mov_b64 exec, -1
    v_lshlrev_b32 v2, 16, v32
    v_and_b32 v3, 0xffff0000, v32
    v_add_f32 v26, v26, v2
    v_add_f32 v27, v27, v3
    v_mfma_f32_32x32x16_bf16 v[80:95], v[36:39], v[44:47], v[80:95]
    ds_read_b64_tr_b16 v[134:135], v225 offset:512
    ds_read_b64_tr_b16 v[136:137], v224 offset:8192
    ds_read_b64_tr_b16 v[138:139], v224 offset:8704
    s_add_u32 m0, s80, 75008
    s_add_u32 s75, s83, s84
    s_add_u32 s75, s75, 1024
    s_mov_b64 exec, s[60:61]
    buffer_load_dwordx4 v25, s[56:59], s75 offen lds
    s_mov_b64 exec, -1
    v_lshlrev_b32 v2, 16, v33
    v_and_b32 v3, 0xffff0000, v33
    v_add_f32 v26, v26, v2
    v_add_f32 v27, v27, v3
    v_mfma_f32_32x32x16_bf16 v[96:111], v[40:43], v[44:47], v[96:111]
    s_add_u32 m0, s79, 73984
    s_mov_b64 exec, s[62:63]
    buffer_load_dwordx4 v190, s[88:91], s83 offen lds
    s_mov_b64 exec, -1
    v_lshlrev_b32 v2, 16, v34
    v_and_b32 v3, 0xffff0000, v34
    v_add_f32 v26, v26, v2
    v_add_f32 v27, v27, v3
    s_waitcnt lgkmcnt(7)
    v_mfma_f32_32x32x16_bf16 v[64:79], v[48:51], v[60:63], v[64:79]
    ds_read_b128 v[156:159], v231
    ds_read_b64_tr_b16 v[144:145], v226 offset:0
    ds_read_b64_tr_b16 v[146:147], v226 offset:512
    ds_read_b64_tr_b16 v[148:149], v227 offset:0
    s_add_u32 m0, s79, 75008
    s_add_u32 s75, s83, s84
    s_add_u32 s75, s75, 1024
    s_mov_b64 exec, s[62:63]
    buffer_load_dwordx4 v190, s[88:91], s75 offen lds
    s_mov_b64 exec, -1
    s_add_u32 s82, s82, 128
    s_add_u32 s99, s99, 81920
    s_add_u32 s83, s83, s85
    s_cmp_eq_u32 s82, 1280
    s_cselect_b32 s82, 0, s82
    s_cselect_b32 s99, 0, s99
    s_cselect_b32 s83, 0, s83
    v_lshlrev_b32 v2, 16, v35
    v_and_b32 v3, 0xffff0000, v35
    v_add_f32 v26, v26, v2
    v_add_f32 v27, v27, v3
    v_mfma_f32_32x32x16_bf16 v[80:95], v[52:55], v[60:63], v[80:95]
    ds_read_b64_tr_b16 v[150:151], v227 offset:512
    ds_read_b64_tr_b16 v[152:153], v226 offset:8192
    ds_read_b64_tr_b16 v[154:155], v226 offset:8704
    v_lshlrev_b32 v2, 16, v36
    v_and_b32 v3, 0xffff0000, v36
    v_add_f32 v28, v28, v2
    v_add_f32 v29, v29, v3
    v_mfma_f32_32x32x16_bf16 v[96:111], v[56:59], v[60:63], v[96:111]
    v_lshlrev_b32 v2, 16, v37
    v_and_b32 v3, 0xffff0000, v37
    v_add_f32 v28, v28, v2
    v_add_f32 v29, v29, v3
    s_waitcnt lgkmcnt(0)
    s_waitcnt vmcnt(10)
    s_barrier
    v_mfma_f32_32x32x16_bf16 v[64:79], v[128:131], v[140:143], v[64:79]
    ds_read_b128 v[44:47], v18
    ds_read_b64_tr_b16 v[32:33], v10 offset:0
    ds_read_b64_tr_b16 v[34:35], v10 offset:512
    ds_read_b64_tr_b16 v[36:37], v11 offset:0
    s_add_u32 m0, s81, 98816
    s_add_u32 s75, s82, 0
    buffer_load_dwordx4 v22, s[40:43], s75 offen offset:0 lds
    v_lshlrev_b32 v2, 16, v134
    v_and_b32 v3, 0xffff0000, v134
    v_add_f32 v28, v28, v2
    v_add_f32 v29, v29, v3
    v_mfma_f32_32x32x16_bf16 v[80:95], v[132:135], v[140:143], v[80:95]
    ds_read_b64_tr_b16 v[38:39], v11 offset:512
    ds_read_b64_tr_b16 v[40:41], v10 offset:8192
    ds_read_b64_tr_b16 v[42:43], v10 offset:8704
    s_add_u32 s75, s82, 9216
    buffer_load_dwordx4 v23, s[40:43], s75 offen offset:1024 lds
    v_lshlrev_b32 v2, 16, v135
    v_and_b32 v3, 0xffff0000, v135
    v_add_f32 v28, v28, v2
    v_add_f32 v29, v29, v3
    v_mfma_f32_32x32x16_bf16 v[96:111], v[136:139], v[140:143], v[96:111]
    s_add_u32 s75, s82, 18432
    buffer_load_dwordx4 v22, s[40:43], s75 offen offset:2048 lds
    v_lshlrev_b32 v2, 16, v136
    v_and_b32 v3, 0xffff0000, v136
    v_add_f32 v30, v30, v2
    v_add_f32 v31, v31, v3
    v_mfma_f32_32x32x16_bf16 v[64:79], v[144:147], v[156:159], v[64:79]
    ds_read_b128 v[60:63], v19
    ds_read_b64_tr_b16 v[48:49], v12 offset:0
    ds_read_b64_tr_b16 v[50:51], v12 offset:512
    ds_read_b64_tr_b16 v[52:53], v13 offset:0
    s_add_u32 s75, s82, 27648
    buffer_load_dwordx4 v23, s[40:43], s75 offen offset:3072 lds
    v_lshlrev_b32 v2, 16, v137
    v_and_b32 v3, 0xffff0000, v137
    v_add_f32 v30, v30, v2
    v_add_f32 v31, v31, v3
    v_mfma_f32_32x32x16_bf16 v[80:95], v[148:151], v[156:159], v[80:95]
    ds_read_b64_tr_b16 v[54:55], v13 offset:512
    ds_read_b64_tr_b16 v[56:57], v12 offset:8192
    ds_read_b64_tr_b16 v[58:59], v12 offset:8704
    s_add_u32 m0, s80, 115200
    s_add_u32 s75, s99, 9216
    buffer_load_dwordx4 v24, s[52:55], s99 offen lds
    v_lshlrev_b32 v2, 16, v138
    v_and_b32 v3, 0xffff0000, v138
    v_add_f32 v30, v30, v2
    v_add_f32 v31, v31, v3
    v_mfma_f32_32x32x16_bf16 v[96:111], v[152:155], v[156:159], v[96:111]
    buffer_load_dwordx4 v24, s[52:55], s75 offen offset:1024 lds
    v_lshlrev_b32 v2, 16, v139
    v_and_b32 v3, 0xffff0000, v139
    v_add_f32 v30, v30, v2
    v_add_f32 v31, v31, v3
    s_waitcnt lgkmcnt(7)
    v_mfma_f32_32x32x16_bf16 v[64:79], v[32:35], v[44:47], v[64:79]
    ds_read_b128 v[140:143], v20
    ds_read_b64_tr_b16 v[128:129], v14 offset:0
    ds_read_b64_tr_b16 v[130:131], v14 offset:512
    ds_read_b64_tr_b16 v[132:133], v15 offset:0
    s_add_u32 m0, s80, 123392
    s_mov_b64 exec, s[60:61]
    buffer_load_dwordx4 v25, s[56:59], s83 offen lds
    s_mov_b64 exec, -1
    v_lshlrev_b32 v2, 16, v32
    v_and_b32 v3, 0xffff0000, v32
    v_add_f32 v26, v26, v2
    v_add_f32 v27, v27, v3
    v_mfma_f32_32x32x16_bf16 v[80:95], v[36:39], v[44:47], v[80:95]
    ds_read_b64_tr_b16 v[134:135], v15 offset:512
    ds_read_b64_tr_b16 v[136:137], v14 offset:8192
    ds_read_b64_tr_b16 v[138:139], v14 offset:8704
    s_add_u32 m0, s80, 124416
    s_add_u32 s75, s83, s84
    s_add_u32 s75, s75, 1024
    s_mov_b64 exec, s[60:61]
    buffer_load_dwordx4 v25, s[56:59], s75 offen lds
    s_mov_b64 exec, -1
    v_lshlrev_b32 v2, 16, v33
    v_and_b32 v3, 0xffff0000, v33
    v_add_f32 v26, v26, v2
    v_add_f32 v27, v27, v3
    v_mfma_f32_32x32x16_bf16 v[96:111], v[40:43], v[44:47], v[96:111]
    s_add_u32 m0, s79, 123392
    s_mov_b64 exec, s[62:63]
    buffer_load_dwordx4 v190, s[88:91], s83 offen lds
    s_mov_b64 exec, -1
    v_lshlrev_b32 v2, 16, v34
    v_and_b32 v3, 0xffff0000, v34
    v_add_f32 v26, v26, v2
    v_add_f32 v27, v27, v3
    s_waitcnt lgkmcnt(7)
    v_mfma_f32_32x32x16_bf16 v[64:79], v[48:51], v[60:63], v[64:79]
    ds_read_b128 v[156:159], v21
    ds_read_b64_tr_b16 v[144:145], v16 offset:0
    ds_read_b64_tr_b16 v[146:147], v16 offset:512
    ds_read_b64_tr_b16 v[148:149], v17 offset:0
    s_add_u32 m0, s79, 124416
    s_add_u32 s75, s83, s84
    s_add_u32 s75, s75, 1024
    s_mov_b64 exec, s[62:63]
    buffer_load_dwordx4 v190, s[88:91], s75 offen lds
    s_mov_b64 exec, -1
    s_add_u32 s82, s82, 128
    s_add_u32 s99, s99, 81920
    s_add_u32 s83, s83, s85
    s_cmp_eq_u32 s82, 1280
    s_cselect_b32 s82, 0, s82
    s_cselect_b32 s99, 0, s99
    s_cselect_b32 s83, 0, s83
    v_lshlrev_b32 v2, 16, v35
    v_and_b32 v3, 0xffff0000, v35
    v_add_f32 v26, v26, v2
    v_add_f32 v27, v27, v3
    v_mfma_f32_32x32x16_bf16 v[80:95], v[52:55], v[60:63], v[80:95]
    ds_read_b64_tr_b16 v[150:151], v17 offset:512
    ds_read_b64_tr_b16 v[152:153], v16 offset:8192
    ds_read_b64_tr_b16 v[154:155], v16 offset:8704
    v_lshlrev_b32 v2, 16, v36
    v_and_b32 v3, 0xffff0000, v36
    v_add_f32 v28, v28, v2
    v_add_f32 v29, v29, v3
    v_mfma_f32_32x32x16_bf16 v[96:111], v[56:59], v[60:63], v[96:111]
    v_lshlrev_b32 v2, 16, v37
    v_and_b32 v3, 0xffff0000, v37
    v_add_f32 v28, v28, v2
    v_add_f32 v29, v29, v3
    s_waitcnt lgkmcnt(0)
    s_waitcnt vmcnt(10)
    s_barrier
    v_mfma_f32_32x32x16_bf16 v[64:79], v[128:131], v[140:143], v[64:79]
    ds_read_b128 v[44:47], v216
    ds_read_b64_tr_b16 v[32:33], v208 offset:0
    ds_read_b64_tr_b16 v[34:35], v208 offset:512
    ds_read_b64_tr_b16 v[36:37], v209 offset:0
    s_add_u32 m0, s81, 0
    s_add_u32 s75, s82, 0
    buffer_load_dwordx4 v22, s[40:43], s75 offen offset:0 lds
    v_lshlrev_b32 v2, 16, v134
    v_and_b32 v3, 0xffff0000, v134
    v_add_f32 v28, v28, v2
    v_add_f32 v29, v29, v3
    v_mfma_f32_32x32x16_bf16 v[80:95], v[132:135], v[140:143], v[80:95]
    ds_read_b64_tr_b16 v[38:39], v209 offset:512
    ds_read_b64_tr_b16 v[40:41], v208 offset:8192
    ds_read_b64_tr_b16 v[42:43], v208 offset:8704
    s_add_u32 s75, s82, 9216
    buffer_load_dwordx4 v23, s[40:43], s75 offen offset:1024 lds
    v_lshlrev_b32 v2, 16, v135
    v_and_b32 v3, 0xffff0000, v135
    v_add_f32 v28, v28, v2
    v_add_f32 v29, v29, v3
    v_mfma_f32_32x32x16_bf16 v[96:111], v[136:139], v[140:143], v[96:111]
    s_add_u32 s75, s82, 18432
    buffer_load_dwordx4 v22, s[40:43], s75 offen offset:2048 lds
    v_lshlrev_b32 v2, 16, v136
    v_and_b32 v3, 0xffff0000, v136
    v_add_f32 v30, v30, v2
    v_add_f32 v31, v31, v3
    v_mfma_f32_32x32x16_bf16 v[64:79], v[144:147], v[156:159], v[64:79]
    ds_read_b128 v[60:63], v217
    ds_read_b64_tr_b16 v[48:49], v210 offset:0
    ds_read_b64_tr_b16 v[50:51], v210 offset:512
    ds_read_b64_tr_b16 v[52:53], v211 offset:0
    s_add_u32 s75, s82, 27648
    buffer_load_dwordx4 v23, s[40:43], s75 offen offset:3072 lds
    v_lshlrev_b32 v2, 16, v137
    v_and_b32 v3, 0xffff0000, v137
    v_add_f32 v30, v30, v2
    v_add_f32 v31, v31, v3
    v_mfma_f32_32x32x16_bf16 v[80:95], v[148:151], v[156:159], v[80:95]
    ds_read_b64_tr_b16 v[54:55], v211 offset:512
    ds_read_b64_tr_b16 v[56:57], v210 offset:8192
    ds_read_b64_tr_b16 v[58:59], v210 offset:8704
    s_add_u32 m0, s80, 16384
    s_add_u32 s75, s99, 9216
    buffer_load_dwordx4 v24, s[52:55], s99 offen lds
    v_lshlrev_b32 v2, 16, v138
    v_and_b32 v3, 0xffff0000, v138
    v_add_f32 v30, v30, v2
    v_add_f32 v31, v31, v3
    v_mfma_f32_32x32x16_bf16 v[96:111], v[152:155], v[156:159], v[96:111]
    buffer_load_dwordx4 v24, s[52:55], s75 offen offset:1024 lds
    v_lshlrev_b32 v2, 16, v139
    v_and_b32 v3, 0xffff0000, v139
    v_add_f32 v30, v30, v2
    v_add_f32 v31, v31, v3
    s_waitcnt lgkmcnt(7)
    v_mfma_f32_32x32x16_bf16 v[64:79], v[32:35], v[44:47], v[64:79]
    ds_read_b128 v[140:143], v218
    ds_read_b64_tr_b16 v[128:129], v212 offset:0
    ds_read_b64_tr_b16 v[130:131], v212 offset:512
    ds_read_b64_tr_b16 v[132:133], v213 offset:0
    s_add_u32 m0, s80, 24576
    s_mov_b64 exec, s[60:61]
    buffer_load_dwordx4 v25, s[56:59], s83 offen lds
    s_mov_b64 exec, -1
    v_lshlrev_b32 v2, 16, v32
    v_and_b32 v3, 0xffff0000, v32
    v_add_f32 v26, v26, v2
    v_add_f32 v27, v27, v3
    v_mfma_f32_32x32x16_bf16 v[80:95], v[36:39], v[44:47], v[80:95]
    ds_read_b64_tr_b16 v[134:135], v213 offset:512
    ds_read_b64_tr_b16 v[136:137], v212 offset:8192
    ds_read_b64_tr_b16 v[138:139], v212 offset:8704
    s_add_u32 m0, s80, 25600
    s_add_u32 s75, s83, s84
    s_add_u32 s75, s75, 1024
    s_mov_b64 exec, s[60:61]
    buffer_load_dwordx4 v25, s[56:59], s75 offen lds
    s_mov_b64 exec, -1
    v_lshlrev_b32 v2, 16, v33
    v_and_b32 v3, 0xffff0000, v33
    v_add_f32 v26, v26, v2
    v_add_f32 v27, v27, v3
    v_mfma_f32_32x32x16_bf16 v[96:111], v[40:43], v[44:47], v[96:111]
    s_add_u32 m0, s79, 24576
    s_mov_b64 exec, s[62:63]
    buffer_load_dwordx4 v190, s[88:91], s83 offen lds
    s_mov_b64 exec, -1
    v_lshlrev_b32 v2, 16, v34
    v_and_b32 v3, 0xffff0000, v34
    v_add_f32 v26, v26, v2
    v_add_f32 v27, v27, v3
    s_waitcnt lgkmcnt(7)
    v_mfma_f32_32x32x16_bf16 v[64:79], v[48:51], v[60:63], v[64:79]
    ds_read_b128 v[156:159], v219
    ds_read_b64_tr_b16 v[144:145], v214 offset:0
    ds_read_b64_tr_b16 v[146:147], v214 offset:512
    ds_read_b64_tr_b16 v[148:149], v215 offset:0
    s_add_u32 m0, s79, 25600
    s_add_u32 s75, s83, s84
    s_add_u32 s75, s75, 1024
    s_mov_b64 exec, s[62:63]
    buffer_load_dwordx4 v190, s[88:91], s75 offen lds
    s_mov_b64 exec, -1
    s_add_u32 s82, s82, 128
    s_add_u32 s99, s99, 81920
    s_add_u32 s83, s83, s85
    s_cmp_eq_u32 s82, 1280
    s_cselect_b32 s82, 0, s82
    s_cselect_b32 s99, 0, s99
    s_cselect_b32 s83, 0, s83
    v_lshlrev_b32 v2, 16, v35
    v_and_b32 v3, 0xffff0000, v35
    v_add_f32 v26, v26, v2
    v_add_f32 v27, v27, v3
    v_mfma_f32_32x32x16_bf16 v[80:95], v[52:55], v[60:63], v[80:95]
    ds_read_b64_tr_b16 v[150:151], v215 offset:512
    ds_read_b64_tr_b16 v[152:153], v214 offset:8192
    ds_read_b64_tr_b16 v[154:155], v214 offset:8704
    v_lshlrev_b32 v2, 16, v36
    v_and_b32 v3, 0xffff0000, v36
    v_add_f32 v28, v28, v2
    v_add_f32 v29, v29, v3
    v_mfma_f32_32x32x16_bf16 v[96:111], v[56:59], v[60:63], v[96:111]
    v_lshlrev_b32 v2, 16, v37
    v_and_b32 v3, 0xffff0000, v37
    v_add_f32 v28, v28, v2
    v_add_f32 v29, v29, v3
    s_waitcnt lgkmcnt(0)
    s_waitcnt vmcnt(10)
    s_barrier
    v_mfma_f32_32x32x16_bf16 v[64:79], v[128:131], v[140:143], v[64:79]
    ds_read_b128 v[44:47], v228
    ds_read_b64_tr_b16 v[32:33], v220 offset:0
    ds_read_b64_tr_b16 v[34:35], v220 offset:512
    ds_read_b64_tr_b16 v[36:37], v221 offset:0
    v_lshlrev_b32 v2, 16, v134
    v_and_b32 v3, 0xffff0000, v134
    v_add_f32 v28, v28, v2
    v_add_f32 v29, v29, v3
    v_mfma_f32_32x32x16_bf16 v[80:95], v[132:135], v[140:143], v[80:95]
    ds_read_b64_tr_b16 v[38:39], v221 offset:512
    ds_read_b64_tr_b16 v[40:41], v220 offset:8192
    ds_read_b64_tr_b16 v[42:43], v220 offset:8704
    v_lshlrev_b32 v2, 16, v135
    v_and_b32 v3, 0xffff0000, v135
    v_add_f32 v28, v28, v2
    v_add_f32 v29, v29, v3
    v_mfma_f32_32x32x16_bf16 v[96:111], v[136:139], v[140:143], v[96:111]
    v_lshlrev_b32 v2, 16, v136
    v_and_b32 v3, 0xffff0000, v136
    v_add_f32 v30, v30, v2
    v_add_f32 v31, v31, v3
    v_mfma_f32_32x32x16_bf16 v[64:79], v[144:147], v[156:159], v[64:79]
    ds_read_b128 v[60:63], v229
    ds_read_b64_tr_b16 v[48:49], v222 offset:0
    ds_read_b64_tr_b16 v[50:51], v222 offset:512
    ds_read_b64_tr_b16 v[52:53], v223 offset:0
    v_lshlrev_b32 v2, 16, v137
    v_and_b32 v3, 0xffff0000, v137
    v_add_f32 v30, v30, v2
    v_add_f32 v31, v31, v3
    v_mfma_f32_32x32x16_bf16 v[80:95], v[148:151], v[156:159], v[80:95]
    ds_read_b64_tr_b16 v[54:55], v223 offset:512
    ds_read_b64_tr_b16 v[56:57], v222 offset:8192
    ds_read_b64_tr_b16 v[58:59], v222 offset:8704
    v_lshlrev_b32 v2, 16, v138
    v_and_b32 v3, 0xffff0000, v138
    v_add_f32 v30, v30, v2
    v_add_f32 v31, v31, v3
    v_mfma_f32_32x32x16_bf16 v[96:111], v[152:155], v[156:159], v[96:111]
    v_lshlrev_b32 v2, 16, v139
    v_and_b32 v3, 0xffff0000, v139
    v_add_f32 v30, v30, v2
    v_add_f32 v31, v31, v3
    s_waitcnt lgkmcnt(7)
    v_mfma_f32_32x32x16_bf16 v[64:79], v[32:35], v[44:47], v[64:79]
    ds_read_b128 v[140:143], v230
    ds_read_b64_tr_b16 v[128:129], v224 offset:0
    ds_read_b64_tr_b16 v[130:131], v224 offset:512
    ds_read_b64_tr_b16 v[132:133], v225 offset:0
    v_lshlrev_b32 v2, 16, v32
    v_and_b32 v3, 0xffff0000, v32
    v_add_f32 v26, v26, v2
    v_add_f32 v27, v27, v3
    v_mfma_f32_32x32x16_bf16 v[80:95], v[36:39], v[44:47], v[80:95]
    ds_read_b64_tr_b16 v[134:135], v225 offset:512
    ds_read_b64_tr_b16 v[136:137], v224 offset:8192
    ds_read_b64_tr_b16 v[138:139], v224 offset:8704
    v_lshlrev_b32 v2, 16, v33
    v_and_b32 v3, 0xffff0000, v33
    v_add_f32 v26, v26, v2
    v_add_f32 v27, v27, v3
    v_mfma_f32_32x32x16_bf16 v[96:111], v[40:43], v[44:47], v[96:111]
    v_lshlrev_b32 v2, 16, v34
    v_and_b32 v3, 0xffff0000, v34
    v_add_f32 v26, v26, v2
    v_add_f32 v27, v27, v3
    s_waitcnt lgkmcnt(7)
    v_mfma_f32_32x32x16_bf16 v[64:79], v[48:51], v[60:63], v[64:79]
    ds_read_b128 v[156:159], v231
    ds_read_b64_tr_b16 v[144:145], v226 offset:0
    ds_read_b64_tr_b16 v[146:147], v226 offset:512
    ds_read_b64_tr_b16 v[148:149], v227 offset:0
    v_lshlrev_b32 v2, 16, v35
    v_and_b32 v3, 0xffff0000, v35
    v_add_f32 v26, v26, v2
    v_add_f32 v27, v27, v3
    v_mfma_f32_32x32x16_bf16 v[80:95], v[52:55], v[60:63], v[80:95]
    ds_read_b64_tr_b16 v[150:151], v227 offset:512
    ds_read_b64_tr_b16 v[152:153], v226 offset:8192
    ds_read_b64_tr_b16 v[154:155], v226 offset:8704
    v_lshlrev_b32 v2, 16, v36
    v_and_b32 v3, 0xffff0000, v36
    v_add_f32 v28, v28, v2
    v_add_f32 v29, v29, v3
    v_mfma_f32_32x32x16_bf16 v[96:111], v[56:59], v[60:63], v[96:111]
    v_lshlrev_b32 v2, 16, v37
    v_and_b32 v3, 0xffff0000, v37
    v_add_f32 v28, v28, v2
    v_add_f32 v29, v29, v3
    s_waitcnt lgkmcnt(0)
    s_waitcnt vmcnt(0)
    s_barrier
    v_mov_b32 v4, 155776
    ds_read_b32 v5, v4
    v_mfma_f32_32x32x16_bf16 v[64:79], v[128:131], v[140:143], v[64:79]
    ds_read_b128 v[44:47], v18
    ds_read_b64_tr_b16 v[32:33], v10 offset:0
    ds_read_b64_tr_b16 v[34:35], v10 offset:512
    ds_read_b64_tr_b16 v[36:37], v11 offset:0
    v_lshlrev_b32 v2, 16, v134
    v_and_b32 v3, 0xffff0000, v134
    v_add_f32 v28, v28, v2
    v_add_f32 v29, v29, v3
    v_mfma_f32_32x32x16_bf16 v[80:95], v[132:135], v[140:143], v[80:95]
    ds_read_b64_tr_b16 v[38:39], v11 offset:512
    ds_read_b64_tr_b16 v[40:41], v10 offset:8192
    ds_read_b64_tr_b16 v[42:43], v10 offset:8704
    v_lshlrev_b32 v2, 16, v135
    v_and_b32 v3, 0xffff0000, v135
    v_add_f32 v28, v28, v2
    v_add_f32 v29, v29, v3
    v_mfma_f32_32x32x16_bf16 v[96:111], v[136:139], v[140:143], v[96:111]
    v_lshlrev_b32 v2, 16, v136
    v_and_b32 v3, 0xffff0000, v136
    v_add_f32 v30, v30, v2
    v_add_f32 v31, v31, v3
    v_mfma_f32_32x32x16_bf16 v[64:79], v[144:147], v[156:159], v[64:79]
    ds_read_b128 v[60:63], v19
    ds_read_b64_tr_b16 v[48:49], v12 offset:0
    ds_read_b64_tr_b16 v[50:51], v12 offset:512
    ds_read_b64_tr_b16 v[52:53], v13 offset:0
    v_lshlrev_b32 v2, 16, v137
    v_and_b32 v3, 0xffff0000, v137
    v_add_f32 v30, v30, v2
    v_add_f32 v31, v31, v3
    v_mfma_f32_32x32x16_bf16 v[80:95], v[148:151], v[156:159], v[80:95]
    ds_read_b64_tr_b16 v[54:55], v13 offset:512
    ds_read_b64_tr_b16 v[56:57], v12 offset:8192
    ds_read_b64_tr_b16 v[58:59], v12 offset:8704
    v_lshlrev_b32 v2, 16, v138
    v_and_b32 v3, 0xffff0000, v138
    v_add_f32 v30, v30, v2
    v_add_f32 v31, v31, v3
    v_mfma_f32_32x32x16_bf16 v[96:111], v[152:155], v[156:159], v[96:111]
    v_lshlrev_b32 v2, 16, v139
    v_and_b32 v3, 0xffff0000, v139
    v_add_f32 v30, v30, v2
    v_add_f32 v31, v31, v3
    s_waitcnt lgkmcnt(7)
    v_mfma_f32_32x32x16_bf16 v[64:79], v[32:35], v[44:47], v[64:79]
    ds_read_b128 v[140:143], v20
    ds_read_b64_tr_b16 v[128:129], v14 offset:0
    ds_read_b64_tr_b16 v[130:131], v14 offset:512
    ds_read_b64_tr_b16 v[132:133], v15 offset:0
    v_lshlrev_b32 v2, 16, v32
    v_and_b32 v3, 0xffff0000, v32
    v_add_f32 v26, v26, v2
    v_add_f32 v27, v27, v3
    v_readfirstlane_b32 s79, v5
    v_mfma_f32_32x32x16_bf16 v[80:95], v[36:39], v[44:47], v[80:95]
    ds_read_b64_tr_b16 v[134:135], v15 offset:512
    ds_read_b64_tr_b16 v[136:137], v14 offset:8192
    ds_read_b64_tr_b16 v[138:139], v14 offset:8704
    v_lshlrev_b32 v2, 16, v33
    v_and_b32 v3, 0xffff0000, v33
    v_add_f32 v26, v26, v2
    v_add_f32 v27, v27, v3
    v_mfma_f32_32x32x16_bf16 v[96:111], v[40:43], v[44:47], v[96:111]
    v_lshlrev_b32 v2, 16, v34
    v_and_b32 v3, 0xffff0000, v34
    v_add_f32 v26, v26, v2
    v_add_f32 v27, v27, v3
    s_waitcnt lgkmcnt(7)
    v_mfma_f32_32x32x16_bf16 v[64:79], v[48:51], v[60:63], v[64:79]
    ds_read_b128 v[156:159], v21
    ds_read_b64_tr_b16 v[144:145], v16 offset:0
    ds_read_b64_tr_b16 v[146:147], v16 offset:512
    ds_read_b64_tr_b16 v[148:149], v17 offset:0
    v_lshlrev_b32 v2, 16, v35
    v_and_b32 v3, 0xffff0000, v35
    v_add_f32 v26, v26, v2
    v_add_f32 v27, v27, v3
    v_mfma_f32_32x32x16_bf16 v[80:95], v[52:55], v[60:63], v[80:95]
    ds_read_b64_tr_b16 v[150:151], v17 offset:512
    ds_read_b64_tr_b16 v[152:153], v16 offset:8192
    ds_read_b64_tr_b16 v[154:155], v16 offset:8704
    v_lshlrev_b32 v2, 16, v36
    v_and_b32 v3, 0xffff0000, v36
    v_add_f32 v28, v28, v2
    v_add_f32 v29, v29, v3
    v_mfma_f32_32x32x16_bf16 v[96:111], v[56:59], v[60:63], v[96:111]
    v_lshlrev_b32 v2, 16, v37
    v_and_b32 v3, 0xffff0000, v37
    v_add_f32 v28, v28, v2
    v_add_f32 v29, v29, v3
    s_waitcnt lgkmcnt(0)
    s_branch L_q_fin
L_q_h:
    v_lshlrev_b32 v1, 2, v250
    v_add_u32 v1, 155648, v1
    ds_write_b32 v1, v242
    s_waitcnt lgkmcnt(0)
    v_add_u32 v208, 49408, v10
    v_add_u32 v209, 49408, v11
    v_add_u32 v210, 49408, v12
    v_add_u32 v211, 49408, v13
    v_add_u32 v212, 49408, v14
    v_add_u32 v213, 49408, v15
    v_add_u32 v214, 49408, v16
    v_add_u32 v215, 49408, v17
    v_add_u32 v216, 49408, v18
    v_add_u32 v217, 49408, v19
    v_add_u32 v218, 49408, v20
    v_add_u32 v219, 49408, v21
    v_add_u32 v220, 98816, v10
    v_add_u32 v221, 98816, v11
    v_add_u32 v222, 98816, v12
    v_add_u32 v223, 98816, v13
    v_add_u32 v224, 98816, v14
    v_add_u32 v225, 98816, v15
    v_add_u32 v226, 98816, v16
    v_add_u32 v227, 98816, v17
    v_add_u32 v228, 98816, v18
    v_add_u32 v229, 98816, v19
    v_add_u32 v230, 98816, v20
    v_add_u32 v231, 98816, v21
    s_barrier
    ds_read_b128 v[44:47], v18
    ds_read_b64_tr_b16 v[32:33], v10 offset:0
    ds_read_b64_tr_b16 v[34:35], v10 offset:512
    ds_read_b64_tr_b16 v[36:37], v11 offset:0
    ds_read_b64_tr_b16 v[38:39], v11 offset:512
    ds_read_b64_tr_b16 v[40:41], v10 offset:8192
    ds_read_b64_tr_b16 v[42:43], v10 offset:8704
    ds_read_b128 v[60:63], v19
    ds_read_b64_tr_b16 v[48:49], v12 offset:0
    ds_read_b64_tr_b16 v[50:51], v12 offset:512
    ds_read_b64_tr_b16 v[52:53], v13 offset:0
    ds_read_b64_tr_b16 v[54:55], v13 offset:512
    ds_read_b64_tr_b16 v[56:57], v12 offset:8192
    ds_read_b64_tr_b16 v[58:59], v12 offset:8704
    s_waitcnt lgkmcnt(7)
    v_mfma_f32_32x32x16_bf16 v[64:79], v[32:35], v[44:47], 0
    ds_read_b128 v[140:143], v20
    ds_read_b64_tr_b16 v[128:129], v14 offset:0
    ds_read_b64_tr_b16 v[130:131], v14 offset:512
    ds_read_b64_tr_b16 v[132:133], v15 offset:0
    v_lshlrev_b32 v2, 16, v32
    v_and_b32 v3, 0xffff0000, v32
    v_add_f32 v26, v26, v2
    v_add_f32 v27, v27, v3
    s_waitcnt vmcnt(0)
    v_add_u32 v203, 1, v203
    v_or_b32 v203, 0x80000000, v203
    v_mov_b32 v4, 155776
    ds_write_b32 v4, v203
    v_readfirstlane_b32 s79, v203
    v_mov_b32 v8, 0
    v_mfma_f32_32x32x16_bf16 v[80:95], v[36:39], v[44:47], 0
    ds_read_b64_tr_b16 v[134:135], v15 offset:512
    ds_read_b64_tr_b16 v[136:137], v14 offset:8192
    ds_read_b64_tr_b16 v[138:139], v14 offset:8704
    v_lshlrev_b32 v2, 16, v33
    v_and_b32 v3, 0xffff0000, v33
    v_add_f32 v26, v26, v2
    v_add_f32 v27, v27, v3
    v_mov_b32 v9, 0
    v_lshlrev_b32 v4, 16, v192
    v_and_b32 v5, 0xffff0000, v192
    v_add_f32 v8, v8, v4
    v_fmac_f32 v9, v4, v4
    v_mfma_f32_32x32x16_bf16 v[96:111], v[40:43], v[44:47], 0
    v_lshlrev_b32 v2, 16, v34
    v_and_b32 v3, 0xffff0000, v34
    v_add_f32 v26, v26, v2
    v_add_f32 v27, v27, v3
    v_add_f32 v8, v8, v5
    v_fmac_f32 v9, v5, v5
    v_lshlrev_b32 v4, 16, v193
    v_and_b32 v5, 0xffff0000, v193
    s_waitcnt lgkmcnt(7)
    v_mfma_f32_32x32x16_bf16 v[64:79], v[48:51], v[60:63], v[64:79]
    ds_read_b128 v[156:159], v21
    ds_read_b64_tr_b16 v[144:145], v16 offset:0
    ds_read_b64_tr_b16 v[146:147], v16 offset:512
    ds_read_b64_tr_b16 v[148:149], v17 offset:0
    v_lshlrev_b32 v2, 16, v35
    v_and_b32 v3, 0xffff0000, v35
    v_add_f32 v26, v26, v2
    v_add_f32 v27, v27, v3
    v_add_f32 v8, v8, v4
    v_fmac_f32 v9, v4, v4
    v_add_f32 v8, v8, v5
    v_fmac_f32 v9, v5, v5
    v_lshlrev_b32 v4, 16, v194
    v_mfma_f32_32x32x16_bf16 v[80:95], v[52:55], v[60:63], v[80:95]
    ds_read_b64_tr_b16 v[150:151], v17 offset:512
    ds_read_b64_tr_b16 v[152:153], v16 offset:8192
    ds_read_b64_tr_b16 v[154:155], v16 offset:8704
    v_lshlrev_b32 v2, 16, v36
    v_and_b32 v3, 0xffff0000, v36
    v_add_f32 v28, v28, v2
    v_add_f32 v29, v29, v3
    v_and_b32 v5, 0xffff0000, v194
    v_add_f32 v8, v8, v4
    v_fmac_f32 v9, v4, v4
    v_add_f32 v8, v8, v5
    v_fmac_f32 v9, v5, v5
    v_mfma_f32_32x32x16_bf16 v[96:111], v[56:59], v[60:63], v[96:111]
    v_lshlrev_b32 v2, 16, v37
    v_and_b32 v3, 0xffff0000, v37
    v_add_f32 v28, v28, v2
    v_add_f32 v29, v29, v3
    v_lshlrev_b32 v4, 16, v195
    v_and_b32 v5, 0xffff0000, v195
    v_add_f32 v8, v8, v4
    v_fmac_f32 v9, v4, v4
    s_waitcnt lgkmcnt(0)
    s_barrier
    v_mfma_f32_32x32x16_bf16 v[64:79], v[128:131], v[140:143], v[64:79]
    ds_read_b128 v[44:47], v216
    ds_read_b64_tr_b16 v[32:33], v208 offset:0
    ds_read_b64_tr_b16 v[34:35], v208 offset:512
    ds_read_b64_tr_b16 v[36:37], v209 offset:0
    v_lshlrev_b32 v2, 16, v134
    v_and_b32 v3, 0xffff0000, v134
    v_add_f32 v28, v28, v2
    v_add_f32 v29, v29, v3
    v_add_f32 v8, v8, v5
    v_fmac_f32 v9, v5, v5
    v_lshlrev_b32 v4, 16, v196
    v_and_b32 v5, 0xffff0000, v196
    v_add_f32 v8, v8, v4
    v_fmac_f32 v9, v4, v4
    v_mfma_f32_32x32x16_bf16 v[80:95], v[132:135], v[140:143], v[80:95]
    ds_read_b64_tr_b16 v[38:39], v209 offset:512
    ds_read_b64_tr_b16 v[40:41], v208 offset:8192
    ds_read_b64_tr_b16 v[42:43], v208 offset:8704
    v_lshlrev_b32 v2, 16, v135
    v_and_b32 v3, 0xffff0000, v135
    v_add_f32 v28, v28, v2
    v_add_f32 v29, v29, v3
    v_add_f32 v8, v8, v5
    v_fmac_f32 v9, v5, v5
    v_lshlrev_b32 v4, 16, v197
    v_and_b32 v5, 0xffff0000, v197
    v_add_f32 v8, v8, v4
    v_fmac_f32 v9, v4, v4
    v_mfma_f32_32x32x16_bf16 v[96:111], v[136:139], v[140:143], v[96:111]
    v_lshlrev_b32 v2, 16, v136
    v_and_b32 v3, 0xffff0000, v136
    v_add_f32 v30, v30, v2
    v_add_f32 v31, v31, v3
    v_add_f32 v8, v8, v5
    v_fmac_f32 v9, v5, v5
    v_lshlrev_b32 v4, 16, v198
    v_and_b32 v5, 0xffff0000, v198
    v_add_f32 v8, v8, v4
    v_fmac_f32 v9, v4, v4
    v_mfma_f32_32x32x16_bf16 v[64:79], v[144:147], v[156:159], v[64:79]
    ds_read_b128 v[60:63], v217
    ds_read_b64_tr_b16 v[48:49], v210 offset:0
    ds_read_b64_tr_b16 v[50:51], v210 offset:512
    ds_read_b64_tr_b16 v[52:53], v211 offset:0
    v_lshlrev_b32 v2, 16, v137
    v_and_b32 v3, 0xffff0000, v137
    v_add_f32 v30, v30, v2
    v_add_f32 v31, v31, v3
    v_add_f32 v8, v8, v5
    v_fmac_f32 v9, v5, v5
    v_lshlrev_b32 v4, 16, v199
    v_and_b32 v5, 0xffff0000, v199
    v_add_f32 v8, v8, v4
    v_fmac_f32 v9, v4, v4
    v_mfma_f32_32x32x16_bf16 v[80:95], v[148:151], v[156:159], v[80:95]
    ds_read_b64_tr_b16 v[54:55], v211 offset:512
    ds_read_b64_tr_b16 v[56:57], v210 offset:8192
    ds_read_b64_tr_b16 v[58:59], v210 offset:8704
    v_lshlrev_b32 v2, 16, v138
    v_and_b32 v3, 0xffff0000, v138
    v_add_f32 v30, v30, v2
    v_add_f32 v31, v31, v3
    v_add_f32 v8, v8, v5
    v_fmac_f32 v9, v5, v5
    v_lshlrev_b32 v4, 16, v200
    v_and_b32 v5, 0xffff0000, v200
    v_add_f32 v8, v8, v4
    v_fmac_f32 v9, v4, v4
    v_mfma_f32_32x32x16_bf16 v[96:111], v[152:155], v[156:159], v[96:111]
    v_lshlrev_b32 v2, 16, v139
    v_and_b32 v3, 0xffff0000, v139
    v_add_f32 v30, v30, v2
    v_add_f32 v31, v31, v3
    v_add_f32 v8, v8, v5
    v_fmac_f32 v9, v5, v5
    v_lshlrev_b32 v4, 16, v201
    v_and_b32 v5, 0xffff0000, v201
    v_add_f32 v8, v8, v4
    v_fmac_f32 v9, v4, v4
    s_waitcnt lgkmcnt(7)
    v_mfma_f32_32x32x16_bf16 v[64:79], v[32:35], v[44:47], v[64:79]
    ds_read_b128 v[140:143], v218
    ds_read_b64_tr_b16 v[128:129], v212 offset:0
    ds_read_b64_tr_b16 v[130:131], v212 offset:512
    ds_read_b64_tr_b16 v[132:133], v213 offset:0
    v_lshlrev_b32 v2, 16, v32
    v_and_b32 v3, 0xffff0000, v32
    v_add_f32 v26, v26, v2
    v_add_f32 v27, v27, v3
    v_add_f32 v8, v8, v5
    v_fmac_f32 v9, v5, v5
    s_nop 0
    v_add_f32_dpp v8, v8, v8 row_ror:8 row_mask:0xf bank_mask:0xf
    v_add_f32_dpp v9, v9, v9 row_ror:8 row_mask:0xf bank_mask:0xf
    s_nop 0
    v_mfma_f32_32x32x16_bf16 v[80:95], v[36:39], v[44:47], v[80:95]
    ds_read_b64_tr_b16 v[134:135], v213 offset:512
    ds_read_b64_tr_b16 v[136:137], v212 offset:8192
    ds_read_b64_tr_b16 v[138:139], v212 offset:8704
    v_lshlrev_b32 v2, 16, v33
    v_and_b32 v3, 0xffff0000, v33
    v_add_f32 v26, v26, v2
    v_add_f32 v27, v27, v3
    v_add_f32_dpp v8, v8, v8 row_ror:4 row_mask:0xf bank_mask:0xf
    v_add_f32_dpp v9, v9, v9 row_ror:4 row_mask:0xf bank_mask:0xf
    s_nop 0
    v_add_f32_dpp v8, v8, v8 row_ror:2 row_mask:0xf bank_mask:0xf
    v_add_f32_dpp v9, v9, v9 row_ror:2 row_mask:0xf bank_mask:0xf
    s_nop 0
    v_mfma_f32_32x32x16_bf16 v[96:111], v[40:43], v[44:47], v[96:111]
    v_lshlrev_b32 v2, 16, v34
    v_and_b32 v3, 0xffff0000, v34
    v_add_f32 v26, v26, v2
    v_add_f32 v27, v27, v3
    v_add_f32_dpp v8, v8, v8 row_ror:1 row_mask:0xf bank_mask:0xf
    v_add_f32_dpp v9, v9, v9 row_ror:1 row_mask:0xf bank_mask:0xf
    v_mov_b32 v4, v8
    v_mov_b32 v5, v9
    s_nop 1
    v_permlane16_swap_b32 v4, v8
    s_waitcnt lgkmcnt(7)
    v_mfma_f32_32x32x16_bf16 v[64:79], v[48:51], v[60:63], v[64:79]
    ds_read_b128 v[156:159], v219
    ds_read_b64_tr_b16 v[144:145], v214 offset:0
    ds_read_b64_tr_b16 v[146:147], v214 offset:512
    ds_read_b64_tr_b16 v[148:149], v215 offset:0
    v_lshlrev_b32 v2, 16, v35
    v_and_b32 v3, 0xffff0000, v35
    v_add_f32 v26, v26, v2
    v_add_f32 v27, v27, v3
    v_permlane16_swap_b32 v5, v9
    s_nop 1
    v_add_f32 v4, v4, v8
    v_add_f32 v5, v5, v9
    v_mul_f32 v4, 0xbacccccd, v4
    v_mul_f32 v5, 0x3acccccd, v5
    v_mfma_f32_32x32x16_bf16 v[80:95], v[52:55], v[60:63], v[80:95]
    ds_read_b64_tr_b16 v[150:151], v215 offset:512
    ds_read_b64_tr_b16 v[152:153], v214 offset:8192
    ds_read_b64_tr_b16 v[154:155], v214 offset:8704
    v_lshlrev_b32 v2, 16, v36
    v_and_b32 v3, 0xffff0000, v36
    v_add_f32 v28, v28, v2
    v_add_f32 v29, v29, v3
    v_fma_f32 v5, -v4, v4, v5
    v_max_f32 v5, 0, v5
    v_cvt_pk_bf16_f32 v5, v5, v5
    v_lshlrev_b32 v5, 16, v5
    v_add_f32 v5, 0x3727c5ac, v5
    v_cvt_pk_bf16_f32 v5, v5, v5
    v_mfma_f32_32x32x16_bf16 v[96:111], v[56:59], v[60:63], v[96:111]
    v_lshlrev_b32 v2, 16, v37
    v_and_b32 v3, 0xffff0000, v37
    v_add_f32 v28, v28, v2
    v_add_f32 v29, v29, v3
    v_lshlrev_b32 v5, 16, v5
    v_sqrt_f32 v5, v5
    s_nop 0
    v_cvt_pk_bf16_f32 v202, v4, v5
    s_mov_b32 exec_lo, 1
    s_mov_b32 exec_hi, 1
    s_mov_b32 s72, 3080192
    buffer_store_dwordx2 v[202:203], v255, s[44:47], s72 offen sc1
    s_mov_b64 exec, -1
    s_waitcnt lgkmcnt(0)
    s_barrier
    v_mfma_f32_32x32x16_bf16 v[64:79], v[128:131], v[140:143], v[64:79]
    ds_read_b128 v[44:47], v228
    ds_read_b64_tr_b16 v[32:33], v220 offset:0
    ds_read_b64_tr_b16 v[34:35], v220 offset:512
    ds_read_b64_tr_b16 v[36:37], v221 offset:0
    v_lshlrev_b32 v2, 16, v134
    v_and_b32 v3, 0xffff0000, v134
    v_add_f32 v28, v28, v2
    v_add_f32 v29, v29, v3
    v_lshlrev_b32 v254, 3, v250
    v_mov_b32 v4, 0x80000000
    v_mfma_f32_32x32x16_bf16 v[80:95], v[132:135], v[140:143], v[80:95]
    ds_read_b64_tr_b16 v[38:39], v221 offset:512
    ds_read_b64_tr_b16 v[40:41], v220 offset:8192
    ds_read_b64_tr_b16 v[42:43], v220 offset:8704
    v_lshlrev_b32 v2, 16, v135
    v_and_b32 v3, 0xffff0000, v135
    v_add_f32 v28, v28, v2
    v_add_f32 v29, v29, v3
    v_cndmask_b32 v254, v254, v4, s[92:93]
    v_mul_u32_u24 v5, 21, v252
    v_mfma_f32_32x32x16_bf16 v[96:111], v[136:139], v[140:143], v[96:111]
    v_lshlrev_b32 v2, 16, v136
    v_and_b32 v3, 0xffff0000, v136
    v_add_f32 v30, v30, v2
    v_add_f32 v31, v31, v3
    v_mfma_f32_32x32x16_bf16 v[64:79], v[144:147], v[156:159], v[64:79]
    ds_read_b128 v[60:63], v229
    ds_read_b64_tr_b16 v[48:49], v222 offset:0
    ds_read_b64_tr_b16 v[50:51], v222 offset:512
    ds_read_b64_tr_b16 v[52:53], v223 offset:0
    v_lshlrev_b32 v2, 16, v137
    v_and_b32 v3, 0xffff0000, v137
    v_add_f32 v30, v30, v2
    v_add_f32 v31, v31, v3
    v_add_lshl_u32 v5, v5, v251, 4
    v_cmp_gt_u32 vcc, 21, v251
    v_mfma_f32_32x32x16_bf16 v[80:95], v[148:151], v[156:159], v[80:95]
    ds_read_b64_tr_b16 v[54:55], v223 offset:512
    ds_read_b64_tr_b16 v[56:57], v222 offset:8192
    ds_read_b64_tr_b16 v[58:59], v222 offset:8704
    v_lshlrev_b32 v2, 16, v138
    v_and_b32 v3, 0xffff0000, v138
    v_add_f32 v30, v30, v2
    v_add_f32 v31, v31, v3
    s_nop 1
    v_cndmask_b32 v0, v4, v5, vcc
    v_mfma_f32_32x32x16_bf16 v[96:111], v[152:155], v[156:159], v[96:111]
    v_lshlrev_b32 v2, 16, v139
    v_and_b32 v3, 0xffff0000, v139
    v_add_f32 v30, v30, v2
    v_add_f32 v31, v31, v3
    s_waitcnt lgkmcnt(7)
    v_mfma_f32_32x32x16_bf16 v[64:79], v[32:35], v[44:47], v[64:79]
    ds_read_b128 v[140:143], v230
    ds_read_b64_tr_b16 v[128:129], v224 offset:0
    ds_read_b64_tr_b16 v[130:131], v224 offset:512
    ds_read_b64_tr_b16 v[132:133], v225 offset:0
    v_lshlrev_b32 v2, 16, v32
    v_and_b32 v3, 0xffff0000, v32
    v_add_f32 v26, v26, v2
    v_add_f32 v27, v27, v3
    s_lshl_b32 s72, s3, 2
    s_add_u32 s72, s72, 155648
    v_mfma_f32_32x32x16_bf16 v[80:95], v[36:39], v[44:47], v[80:95]
    ds_read_b64_tr_b16 v[134:135], v225 offset:512
    ds_read_b64_tr_b16 v[136:137], v224 offset:8192
    ds_read_b64_tr_b16 v[138:139], v224 offset:8704
    v_lshlrev_b32 v2, 16, v33
    v_and_b32 v3, 0xffff0000, v33
    v_add_f32 v26, v26, v2
    v_add_f32 v27, v27, v3
    v_mov_b32 v248, s72
    v_mov_b32 v243, 0
    v_mfma_f32_32x32x16_bf16 v[96:111], v[40:43], v[44:47], v[96:111]
    v_lshlrev_b32 v2, 16, v34
    v_and_b32 v3, 0xffff0000, v34
    v_add_f32 v26, v26, v2
    v_add_f32 v27, v27, v3
    s_waitcnt lgkmcnt(7)
    v_mfma_f32_32x32x16_bf16 v[64:79], v[48:51], v[60:63], v[64:79]
    ds_read_b128 v[156:159], v231
    ds_read_b64_tr_b16 v[144:145], v226 offset:0
    ds_read_b64_tr_b16 v[146:147], v226 offset:512
    ds_read_b64_tr_b16 v[148:149], v227 offset:0
    v_lshlrev_b32 v2, 16, v35
    v_and_b32 v3, 0xffff0000, v35
    v_add_f32 v26, v26, v2
    v_add_f32 v27, v27, v3
    v_mov_b32 v244, 0
    v_mfma_f32_32x32x16_bf16 v[80:95], v[52:55], v[60:63], v[80:95]
    ds_read_b64_tr_b16 v[150:151], v227 offset:512
    ds_read_b64_tr_b16 v[152:153], v226 offset:8192
    ds_read_b64_tr_b16 v[154:155], v226 offset:8704
    v_lshlrev_b32 v2, 16, v36
    v_and_b32 v3, 0xffff0000, v36
    v_add_f32 v28, v28, v2
    v_add_f32 v29, v29, v3
    v_mov_b32 v245, 0
    v_mfma_f32_32x32x16_bf16 v[96:111], v[56:59], v[60:63], v[96:111]
    v_lshlrev_b32 v2, 16, v37
    v_and_b32 v3, 0xffff0000, v37
    v_add_f32 v28, v28, v2
    v_add_f32 v29, v29, v3
    s_waitcnt lgkmcnt(0)
    s_barrier
    v_mfma_f32_32x32x16_bf16 v[64:79], v[128:131], v[140:143], v[64:79]
    ds_read_b128 v[44:47], v18
    ds_read_b64_tr_b16 v[32:33], v10 offset:0
    ds_read_b64_tr_b16 v[34:35], v10 offset:512
    ds_read_b64_tr_b16 v[36:37], v11 offset:0
    v_lshlrev_b32 v2, 16, v134
    v_and_b32 v3, 0xffff0000, v134
    v_add_f32 v28, v28, v2
    v_add_f32 v29, v29, v3
    v_mfma_f32_32x32x16_bf16 v[80:95], v[132:135], v[140:143], v[80:95]
    ds_read_b64_tr_b16 v[38:39], v11 offset:512
    ds_read_b64_tr_b16 v[40:41], v10 offset:8192
    ds_read_b64_tr_b16 v[42:43], v10 offset:8704
    v_lshlrev_b32 v2, 16, v135
    v_and_b32 v3, 0xffff0000, v135
    v_add_f32 v28, v28, v2
    v_add_f32 v29, v29, v3
    v_mfma_f32_32x32x16_bf16 v[96:111], v[136:139], v[140:143], v[96:111]
    v_lshlrev_b32 v2, 16, v136
    v_and_b32 v3, 0xffff0000, v136
    v_add_f32 v30, v30, v2
    v_add_f32 v31, v31, v3
    v_mfma_f32_32x32x16_bf16 v[64:79], v[144:147], v[156:159], v[64:79]
    ds_read_b128 v[60:63], v19
    ds_read_b64_tr_b16 v[48:49], v12 offset:0
    ds_read_b64_tr_b16 v[50:51], v12 offset:512
    ds_read_b64_tr_b16 v[52:53], v13 offset:0
    v_lshlrev_b32 v2, 16, v137
    v_and_b32 v3, 0xffff0000, v137
    v_add_f32 v30, v30, v2
    v_add_f32 v31, v31, v3
    v_mfma_f32_32x32x16_bf16 v[80:95], v[148:151], v[156:159], v[80:95]
    ds_read_b64_tr_b16 v[54:55], v13 offset:512
    ds_read_b64_tr_b16 v[56:57], v12 offset:8192
    ds_read_b64_tr_b16 v[58:59], v12 offset:8704
    v_lshlrev_b32 v2, 16, v138
    v_and_b32 v3, 0xffff0000, v138
    v_add_f32 v30, v30, v2
    v_add_f32 v31, v31, v3
    v_mfma_f32_32x32x16_bf16 v[96:111], v[152:155], v[156:159], v[96:111]
    v_lshlrev_b32 v2, 16, v139
    v_and_b32 v3, 0xffff0000, v139
    v_add_f32 v30, v30, v2
    v_add_f32 v31, v31, v3
    s_waitcnt lgkmcnt(7)
    v_mfma_f32_32x32x16_bf16 v[64:79], v[32:35], v[44:47], v[64:79]
    ds_read_b128 v[140:143], v20
    ds_read_b64_tr_b16 v[128:129], v14 offset:0
    ds_read_b64_tr_b16 v[130:131], v14 offset:512
    ds_read_b64_tr_b16 v[132:133], v15 offset:0
    v_lshlrev_b32 v2, 16, v32
    v_and_b32 v3, 0xffff0000, v32
    v_add_f32 v26, v26, v2
    v_add_f32 v27, v27, v3
    v_mfma_f32_32x32x16_bf16 v[80:95], v[36:39], v[44:47], v[80:95]
    ds_read_b64_tr_b16 v[134:135], v15 offset:512
    ds_read_b64_tr_b16 v[136:137], v14 offset:8192
    ds_read_b64_tr_b16 v[138:139], v14 offset:8704
    v_lshlrev_b32 v2, 16, v33
    v_and_b32 v3, 0xffff0000, v33
    v_add_f32 v26, v26, v2
    v_add_f32 v27, v27, v3
    v_mfma_f32_32x32x16_bf16 v[96:111], v[40:43], v[44:47], v[96:111]
    v_lshlrev_b32 v2, 16, v34
    v_and_b32 v3, 0xffff0000, v34
    v_add_f32 v26, v26, v2
    v_add_f32 v27, v27, v3
    s_waitcnt lgkmcnt(7)
    v_mfma_f32_32x32x16_bf16 v[64:79], v[48:51], v[60:63], v[64:79]
    ds_read_b128 v[156:159], v21
    ds_read_b64_tr_b16 v[144:145], v16 offset:0
    ds_read_b64_tr_b16 v[146:147], v16 offset:512
    ds_read_b64_tr_b16 v[148:149], v17 offset:0
    v_lshlrev_b32 v2, 16, v35
    v_and_b32 v3, 0xffff0000, v35
    v_add_f32 v26, v26, v2
    v_add_f32 v27, v27, v3
    v_mfma_f32_32x32x16_bf16 v[80:95], v[52:55], v[60:63], v[80:95]
    ds_read_b64_tr_b16 v[150:151], v17 offset:512
    ds_read_b64_tr_b16 v[152:153], v16 offset:8192
    ds_read_b64_tr_b16 v[154:155], v16 offset:8704
    v_lshlrev_b32 v2, 16, v36
    v_and_b32 v3, 0xffff0000, v36
    v_add_f32 v28, v28, v2
    v_add_f32 v29, v29, v3
    v_mfma_f32_32x32x16_bf16 v[96:111], v[56:59], v[60:63], v[96:111]
    v_lshlrev_b32 v2, 16, v37
    v_and_b32 v3, 0xffff0000, v37
    v_add_f32 v28, v28, v2
    v_add_f32 v29, v29, v3
    s_waitcnt lgkmcnt(0)
    s_barrier
    v_mfma_f32_32x32x16_bf16 v[64:79], v[128:131], v[140:143], v[64:79]
    ds_read_b128 v[44:47], v216
    ds_read_b64_tr_b16 v[32:33], v208 offset:0
    ds_read_b64_tr_b16 v[34:35], v208 offset:512
    ds_read_b64_tr_b16 v[36:37], v209 offset:0
    v_lshlrev_b32 v2, 16, v134
    v_and_b32 v3, 0xffff0000, v134
    v_add_f32 v28, v28, v2
    v_add_f32 v29, v29, v3
    v_mfma_f32_32x32x16_bf16 v[80:95], v[132:135], v[140:143], v[80:95]
    ds_read_b64_tr_b16 v[38:39], v209 offset:512
    ds_read_b64_tr_b16 v[40:41], v208 offset:8192
    ds_read_b64_tr_b16 v[42:43], v208 offset:8704
    v_lshlrev_b32 v2, 16, v135
    v_and_b32 v3, 0xffff0000, v135
    v_add_f32 v28, v28, v2
    v_add_f32 v29, v29, v3
    v_mfma_f32_32x32x16_bf16 v[96:111], v[136:139], v[140:143], v[96:111]
    v_lshlrev_b32 v2, 16, v136
    v_and_b32 v3, 0xffff0000, v136
    v_add_f32 v30, v30, v2
    v_add_f32 v31, v31, v3
    v_mfma_f32_32x32x16_bf16 v[64:79], v[144:147], v[156:159], v[64:79]
    ds_read_b128 v[60:63], v217
    ds_read_b64_tr_b16 v[48:49], v210 offset:0
    ds_read_b64_tr_b16 v[50:51], v210 offset:512
    ds_read_b64_tr_b16 v[52:53], v211 offset:0
    v_lshlrev_b32 v2, 16, v137
    v_and_b32 v3, 0xffff0000, v137
    v_add_f32 v30, v30, v2
    v_add_f32 v31, v31, v3
    v_mfma_f32_32x32x16_bf16 v[80:95], v[148:151], v[156:159], v[80:95]
    ds_read_b64_tr_b16 v[54:55], v211 offset:512
    ds_read_b64_tr_b16 v[56:57], v210 offset:8192
    ds_read_b64_tr_b16 v[58:59], v210 offset:8704
    v_lshlrev_b32 v2, 16, v138
    v_and_b32 v3, 0xffff0000, v138
    v_add_f32 v30, v30, v2
    v_add_f32 v31, v31, v3
    v_mfma_f32_32x32x16_bf16 v[96:111], v[152:155], v[156:159], v[96:111]
    v_lshlrev_b32 v2, 16, v139
    v_and_b32 v3, 0xffff0000, v139
    v_add_f32 v30, v30, v2
    v_add_f32 v31, v31, v3
    s_waitcnt lgkmcnt(7)
    v_mfma_f32_32x32x16_bf16 v[64:79], v[32:35], v[44:47], v[64:79]
    ds_read_b128 v[140:143], v218
    ds_read_b64_tr_b16 v[128:129], v212 offset:0
    ds_read_b64_tr_b16 v[130:131], v212 offset:512
    ds_read_b64_tr_b16 v[132:133], v213 offset:0
    v_lshlrev_b32 v2, 16, v32
    v_and_b32 v3, 0xffff0000, v32
    v_add_f32 v26, v26, v2
    v_add_f32 v27, v27, v3
    v_xor_b32 v255, 8, v248
    v_mfma_f32_32x32x16_bf16 v[80:95], v[36:39], v[44:47], v[80:95]
    ds_read_b64_tr_b16 v[134:135], v213 offset:512
    ds_read_b64_tr_b16 v[136:137], v212 offset:8192
    ds_read_b64_tr_b16 v[138:139], v212 offset:8704
    v_lshlrev_b32 v2, 16, v33
    v_and_b32 v3, 0xffff0000, v33
    v_add_f32 v26, v26, v2
    v_add_f32 v27, v27, v3
    v_mfma_f32_32x32x16_bf16 v[96:111], v[40:43], v[44:47], v[96:111]
    v_lshlrev_b32 v2, 16, v34
    v_and_b32 v3, 0xffff0000, v34
    v_add_f32 v26, v26, v2
    v_add_f32 v27, v27, v3
    s_waitcnt lgkmcnt(7)
    v_mfma_f32_32x32x16_bf16 v[64:79], v[48:51], v[60:63], v[64:79]
    ds_read_b128 v[156:159], v219
    ds_read_b64_tr_b16 v[144:145], v214 offset:0
    ds_read_b64_tr_b16 v[146:147], v214 offset:512
    ds_read_b64_tr_b16 v[148:149], v215 offset:0
    v_lshlrev_b32 v2, 16, v35
    v_and_b32 v3, 0xffff0000, v35
    v_add_f32 v26, v26, v2
    v_add_f32 v27, v27, v3
    v_mfma_f32_32x32x16_bf16 v[80:95], v[52:55], v[60:63], v[80:95]
    ds_read_b64_tr_b16 v[150:151], v215 offset:512
    ds_read_b64_tr_b16 v[152:153], v214 offset:8192
    ds_read_b64_tr_b16 v[154:155], v214 offset:8704
    v_lshlrev_b32 v2, 16, v36
    v_and_b32 v3, 0xffff0000, v36
    v_add_f32 v28, v28, v2
    v_add_f32 v29, v29, v3
    v_mfma_f32_32x32x16_bf16 v[96:111], v[56:59], v[60:63], v[96:111]
    v_lshlrev_b32 v2, 16, v37
    v_and_b32 v3, 0xffff0000, v37
    v_add_f32 v28, v28, v2
    v_add_f32 v29, v29, v3
    s_waitcnt lgkmcnt(0)
    s_barrier
    v_mfma_f32_32x32x16_bf16 v[64:79], v[128:131], v[140:143], v[64:79]
    ds_read_b128 v[44:47], v228
    ds_read_b64_tr_b16 v[32:33], v220 offset:0
    ds_read_b64_tr_b16 v[34:35], v220 offset:512
    ds_read_b64_tr_b16 v[36:37], v221 offset:0
    v_lshlrev_b32 v2, 16, v134
    v_and_b32 v3, 0xffff0000, v134
    v_add_f32 v28, v28, v2
    v_add_f32 v29, v29, v3
    v_mfma_f32_32x32x16_bf16 v[80:95], v[132:135], v[140:143], v[80:95]
    ds_read_b64_tr_b16 v[38:39], v221 offset:512
    ds_read_b64_tr_b16 v[40:41], v220 offset:8192
    ds_read_b64_tr_b16 v[42:43], v220 offset:8704
    v_lshlrev_b32 v2, 16, v135
    v_and_b32 v3, 0xffff0000, v135
    v_add_f32 v28, v28, v2
    v_add_f32 v29, v29, v3
    v_mfma_f32_32x32x16_bf16 v[96:111], v[136:139], v[140:143], v[96:111]
    v_lshlrev_b32 v2, 16, v136
    v_and_b32 v3, 0xffff0000, v136
    v_add_f32 v30, v30, v2
    v_add_f32 v31, v31, v3
    v_mfma_f32_32x32x16_bf16 v[64:79], v[144:147], v[156:159], v[64:79]
    ds_read_b128 v[60:63], v229
    ds_read_b64_tr_b16 v[48:49], v222 offset:0
    ds_read_b64_tr_b16 v[50:51], v222 offset:512
    ds_read_b64_tr_b16 v[52:53], v223 offset:0
    v_lshlrev_b32 v2, 16, v137
    v_and_b32 v3, 0xffff0000, v137
    v_add_f32 v30, v30, v2
    v_add_f32 v31, v31, v3
    v_mfma_f32_32x32x16_bf16 v[80:95], v[148:151], v[156:159], v[80:95]
    ds_read_b64_tr_b16 v[54:55], v223 offset:512
    ds_read_b64_tr_b16 v[56:57], v222 offset:8192
    ds_read_b64_tr_b16 v[58:59], v222 offset:8704
    v_lshlrev_b32 v2, 16, v138
    v_and_b32 v3, 0xffff0000, v138
    v_add_f32 v30, v30, v2
    v_add_f32 v31, v31, v3
    v_mfma_f32_32x32x16_bf16 v[96:111], v[152:155], v[156:159], v[96:111]
    v_lshlrev_b32 v2, 16, v139
    v_and_b32 v3, 0xffff0000, v139
    v_add_f32 v30, v30, v2
    v_add_f32 v31, v31, v3
    s_waitcnt lgkmcnt(7)
    v_mfma_f32_32x32x16_bf16 v[64:79], v[32:35], v[44:47], v[64:79]
    ds_read_b128 v[140:143], v230
    ds_read_b64_tr_b16 v[128:129], v224 offset:0
    ds_read_b64_tr_b16 v[130:131], v224 offset:512
    ds_read_b64_tr_b16 v[132:133], v225 offset:0
    v_lshlrev_b32 v2, 16, v32
    v_and_b32 v3, 0xffff0000, v32
    v_add_f32 v26, v26, v2
    v_add_f32 v27, v27, v3
    v_mfma_f32_32x32x16_bf16 v[80:95], v[36:39], v[44:47], v[80:95]
    ds_read_b64_tr_b16 v[134:135], v225 offset:512
    ds_read_b64_tr_b16 v[136:137], v224 offset:8192
    ds_read_b64_tr_b16 v[138:139], v224 offset:8704
    v_lshlrev_b32 v2, 16, v33
    v_and_b32 v3, 0xffff0000, v33
    v_add_f32 v26, v26, v2
    v_add_f32 v27, v27, v3
    v_mfma_f32_32x32x16_bf16 v[96:111], v[40:43], v[44:47], v[96:111]
    v_lshlrev_b32 v2, 16, v34
    v_and_b32 v3, 0xffff0000, v34
    v_add_f32 v26, v26, v2
    v_add_f32 v27, v27, v3
    s_waitcnt lgkmcnt(7)
    v_mfma_f32_32x32x16_bf16 v[64:79], v[48:51], v[60:63], v[64:79]
    ds_read_b128 v[156:159], v231
    ds_read_b64_tr_b16 v[144:145], v226 offset:0
    ds_read_b64_tr_b16 v[146:147], v226 offset:512
    ds_read_b64_tr_b16 v[148:149], v227 offset:0
    v_lshlrev_b32 v2, 16, v35
    v_and_b32 v3, 0xffff0000, v35
    v_add_f32 v26, v26, v2
    v_add_f32 v27, v27, v3
    v_mfma_f32_32x32x16_bf16 v[80:95], v[52:55], v[60:63], v[80:95]
    ds_read_b64_tr_b16 v[150:151], v227 offset:512
    ds_read_b64_tr_b16 v[152:153], v226 offset:8192
    ds_read_b64_tr_b16 v[154:155], v226 offset:8704
    v_lshlrev_b32 v2, 16, v36
    v_and_b32 v3, 0xffff0000, v36
    v_add_f32 v28, v28, v2
    v_add_f32 v29, v29, v3
    v_mfma_f32_32x32x16_bf16 v[96:111], v[56:59], v[60:63], v[96:111]
    v_lshlrev_b32 v2, 16, v37
    v_and_b32 v3, 0xffff0000, v37
    v_add_f32 v28, v28, v2
    v_add_f32 v29, v29, v3
    s_waitcnt lgkmcnt(0)
    s_barrier
    v_mfma_f32_32x32x16_bf16 v[64:79], v[128:131], v[140:143], v[64:79]
    ds_read_b128 v[44:47], v18
    ds_read_b64_tr_b16 v[32:33], v10 offset:0
    ds_read_b64_tr_b16 v[34:35], v10 offset:512
    ds_read_b64_tr_b16 v[36:37], v11 offset:0
    v_lshlrev_b32 v2, 16, v134
    v_and_b32 v3, 0xffff0000, v134
    v_add_f32 v28, v28, v2
    v_add_f32 v29, v29, v3
    v_mfma_f32_32x32x16_bf16 v[80:95], v[132:135], v[140:143], v[80:95]
    ds_read_b64_tr_b16 v[38:39], v11 offset:512
    ds_read_b64_tr_b16 v[40:41], v10 offset:8192
    ds_read_b64_tr_b16 v[42:43], v10 offset:8704
    v_lshlrev_b32 v2, 16, v135
    v_and_b32 v3, 0xffff0000, v135
    v_add_f32 v28, v28, v2
    v_add_f32 v29, v29, v3
    v_mfma_f32_32x32x16_bf16 v[96:111], v[136:139], v[140:143], v[96:111]
    v_lshlrev_b32 v2, 16, v136
    v_and_b32 v3, 0xffff0000, v136
    v_add_f32 v30, v30, v2
    v_add_f32 v31, v31, v3
    v_mfma_f32_32x32x16_bf16 v[64:79], v[144:147], v[156:159], v[64:79]
    ds_read_b128 v[60:63], v19
    ds_read_b64_tr_b16 v[48:49], v12 offset:0
    ds_read_b64_tr_b16 v[50:51], v12 offset:512
    ds_read_b64_tr_b16 v[52:53], v13 offset:0
    v_lshlrev_b32 v2, 16, v137
    v_and_b32 v3, 0xffff0000, v137
    v_add_f32 v30, v30, v2
    v_add_f32 v31, v31, v3
    v_mfma_f32_32x32x16_bf16 v[80:95], v[148:151], v[156:159], v[80:95]
    ds_read_b64_tr_b16 v[54:55], v13 offset:512
    ds_read_b64_tr_b16 v[56:57], v12 offset:8192
    ds_read_b64_tr_b16 v[58:59], v12 offset:8704
    v_lshlrev_b32 v2, 16, v138
    v_and_b32 v3, 0xffff0000, v138
    v_add_f32 v30, v30, v2
    v_add_f32 v31, v31, v3
    v_mfma_f32_32x32x16_bf16 v[96:111], v[152:155], v[156:159], v[96:111]
    v_lshlrev_b32 v2, 16, v139
    v_and_b32 v3, 0xffff0000, v139
    v_add_f32 v30, v30, v2
    v_add_f32 v31, v31, v3
    s_waitcnt lgkmcnt(7)
    v_mfma_f32_32x32x16_bf16 v[64:79], v[32:35], v[44:47], v[64:79]
    ds_read_b128 v[140:143], v20
    ds_read_b64_tr_b16 v[128:129], v14 offset:0
    ds_read_b64_tr_b16 v[130:131], v14 offset:512
    ds_read_b64_tr_b16 v[132:133], v15 offset:0
    v_lshlrev_b32 v2, 16, v32
    v_and_b32 v3, 0xffff0000, v32
    v_add_f32 v26, v26, v2
    v_add_f32 v27, v27, v3
    v_mfma_f32_32x32x16_bf16 v[80:95], v[36:39], v[44:47], v[80:95]
    ds_read_b64_tr_b16 v[134:135], v15 offset:512
    ds_read_b64_tr_b16 v[136:137], v14 offset:8192
    ds_read_b64_tr_b16 v[138:139], v14 offset:8704
    v_lshlrev_b32 v2, 16, v33
    v_and_b32 v3, 0xffff0000, v33
    v_add_f32 v26, v26, v2
    v_add_f32 v27, v27, v3
    v_mfma_f32_32x32x16_bf16 v[96:111], v[40:43], v[44:47], v[96:111]
    v_lshlrev_b32 v2, 16, v34
    v_and_b32 v3, 0xffff0000, v34
    v_add_f32 v26, v26, v2
    v_add_f32 v27, v27, v3
    s_waitcnt lgkmcnt(7)
    v_mfma_f32_32x32x16_bf16 v[64:79], v[48:51], v[60:63], v[64:79]
    ds_read_b128 v[156:159], v21
    ds_read_b64_tr_b16 v[144:145], v16 offset:0
    ds_read_b64_tr_b16 v[146:147], v16 offset:512
    ds_read_b64_tr_b16 v[148:149], v17 offset:0
    v_lshlrev_b32 v2, 16, v35
    v_and_b32 v3, 0xffff0000, v35
    v_add_f32 v26, v26, v2
    v_add_f32 v27, v27, v3
    v_mfma_f32_32x32x16_bf16 v[80:95], v[52:55], v[60:63], v[80:95]
    ds_read_b64_tr_b16 v[150:151], v17 offset:512
    ds_read_b64_tr_b16 v[152:153], v16 offset:8192
    ds_read_b64_tr_b16 v[154:155], v16 offset:8704
    v_lshlrev_b32 v2, 16, v36
    v_and_b32 v3, 0xffff0000, v36
    v_add_f32 v28, v28, v2
    v_add_f32 v29, v29, v3
    v_mfma_f32_32x32x16_bf16 v[96:111], v[56:59], v[60:63], v[96:111]
    v_lshlrev_b32 v2, 16, v37
    v_and_b32 v3, 0xffff0000, v37
    v_add_f32 v28, v28, v2
    v_add_f32 v29, v29, v3
    s_waitcnt lgkmcnt(0)
    s_barrier
    v_mfma_f32_32x32x16_bf16 v[64:79], v[128:131], v[140:143], v[64:79]
    ds_read_b128 v[44:47], v216
    ds_read_b64_tr_b16 v[32:33], v208 offset:0
    ds_read_b64_tr_b16 v[34:35], v208 offset:512
    ds_read_b64_tr_b16 v[36:37], v209 offset:0
    v_lshlrev_b32 v2, 16, v134
    v_and_b32 v3, 0xffff0000, v134
    v_add_f32 v28, v28, v2
    v_add_f32 v29, v29, v3
    v_mfma_f32_32x32x16_bf16 v[80:95], v[132:135], v[140:143], v[80:95]
    ds_read_b64_tr_b16 v[38:39], v209 offset:512
    ds_read_b64_tr_b16 v[40:41], v208 offset:8192
    ds_read_b64_tr_b16 v[42:43], v208 offset:8704
    v_lshlrev_b32 v2, 16, v135
    v_and_b32 v3, 0xffff0000, v135
    v_add_f32 v28, v28, v2
    v_add_f32 v29, v29, v3
    v_mfma_f32_32x32x16_bf16 v[96:111], v[136:139], v[140:143], v[96:111]
    v_lshlrev_b32 v2, 16, v136
    v_and_b32 v3, 0xffff0000, v136
    v_add_f32 v30, v30, v2
    v_add_f32 v31, v31, v3
    v_mfma_f32_32x32x16_bf16 v[64:79], v[144:147], v[156:159], v[64:79]
    ds_read_b128 v[60:63], v217
    ds_read_b64_tr_b16 v[48:49], v210 offset:0
    ds_read_b64_tr_b16 v[50:51], v210 offset:512
    ds_read_b64_tr_b16 v[52:53], v211 offset:0
    v_lshlrev_b32 v2, 16, v137
    v_and_b32 v3, 0xffff0000, v137
    v_add_f32 v30, v30, v2
    v_add_f32 v31, v31, v3
    v_mfma_f32_32x32x16_bf16 v[80:95], v[148:151], v[156:159], v[80:95]
    ds_read_b64_tr_b16 v[54:55], v211 offset:512
    ds_read_b64_tr_b16 v[56:57], v210 offset:8192
    ds_read_b64_tr_b16 v[58:59], v210 offset:8704
    v_lshlrev_b32 v2, 16, v138
    v_and_b32 v3, 0xffff0000, v138
    v_add_f32 v30, v30, v2
    v_add_f32 v31, v31, v3
    v_mfma_f32_32x32x16_bf16 v[96:111], v[152:155], v[156:159], v[96:111]
    v_lshlrev_b32 v2, 16, v139
    v_and_b32 v3, 0xffff0000, v139
    v_add_f32 v30, v30, v2
    v_add_f32 v31, v31, v3
    s_waitcnt lgkmcnt(7)
    v_mfma_f32_32x32x16_bf16 v[64:79], v[32:35], v[44:47], v[64:79]
    ds_read_b128 v[140:143], v218
    ds_read_b64_tr_b16 v[128:129], v212 offset:0
    ds_read_b64_tr_b16 v[130:131], v212 offset:512
    ds_read_b64_tr_b16 v[132:133], v213 offset:0
    v_lshlrev_b32 v2, 16, v32
    v_and_b32 v3, 0xffff0000, v32
    v_add_f32 v26, v26, v2
    v_add_f32 v27, v27, v3
    v_mfma_f32_32x32x16_bf16 v[80:95], v[36:39], v[44:47], v[80:95]
    ds_read_b64_tr_b16 v[134:135], v213 offset:512
    ds_read_b64_tr_b16 v[136:137], v212 offset:8192
    ds_read_b64_tr_b16 v[138:139], v212 offset:8704
    v_lshlrev_b32 v2, 16, v33
    v_and_b32 v3, 0xffff0000, v33
    v_add_f32 v26, v26, v2
    v_add_f32 v27, v27, v3
    v_mfma_f32_32x32x16_bf16 v[96:111], v[40:43], v[44:47], v[96:111]
    v_lshlrev_b32 v2, 16, v34
    v_and_b32 v3, 0xffff0000, v34
    v_add_f32 v26, v26, v2
    v_add_f32 v27, v27, v3
    s_waitcnt lgkmcnt(7)
    v_mfma_f32_32x32x16_bf16 v[64:79], v[48:51], v[60:63], v[64:79]
    ds_read_b128 v[156:159], v219
    ds_read_b64_tr_b16 v[144:145], v214 offset:0
    ds_read_b64_tr_b16 v[146:147], v214 offset:512
    ds_read_b64_tr_b16 v[148:149], v215 offset:0
    v_lshlrev_b32 v2, 16, v35
    v_and_b32 v3, 0xffff0000, v35
    v_add_f32 v26, v26, v2
    v_add_f32 v27, v27, v3
    v_mfma_f32_32x32x16_bf16 v[80:95], v[52:55], v[60:63], v[80:95]
    ds_read_b64_tr_b16 v[150:151], v215 offset:512
    ds_read_b64_tr_b16 v[152:153], v214 offset:8192
    ds_read_b64_tr_b16 v[154:155], v214 offset:8704
    v_lshlrev_b32 v2, 16, v36
    v_and_b32 v3, 0xffff0000, v36
    v_add_f32 v28, v28, v2
    v_add_f32 v29, v29, v3
    v_mfma_f32_32x32x16_bf16 v[96:111], v[56:59], v[60:63], v[96:111]
    v_lshlrev_b32 v2, 16, v37
    v_and_b32 v3, 0xffff0000, v37
    v_add_f32 v28, v28, v2
    v_add_f32 v29, v29, v3
    s_waitcnt lgkmcnt(0)
    s_barrier
    s_cmp_lg_u32 s3, 4
    s_cbranch_scc1 L4_hk
    s_lshl_b32 s72, s71, 3
    s_add_u32 s83, s72, 3080192
    buffer_load_dwordx4 v[160:163], v253, s[44:47], s83 offen sc1
    buffer_load_dwordx4 v[164:167], v253, s[44:47], s83 offen offset:0 sc1
L4_hk:
    v_mfma_f32_32x32x16_bf16 v[64:79], v[128:131], v[140:143], v[64:79]
    ds_read_b128 v[44:47], v228
    ds_read_b64_tr_b16 v[32:33], v220 offset:0
    ds_read_b64_tr_b16 v[34:35], v220 offset:512
    ds_read_b64_tr_b16 v[36:37], v221 offset:0
    v_lshlrev_b32 v2, 16, v134
    v_and_b32 v3, 0xffff0000, v134
    v_add_f32 v28, v28, v2
    v_add_f32 v29, v29, v3
    v_mfma_f32_32x32x16_bf16 v[80:95], v[132:135], v[140:143], v[80:95]
    ds_read_b64_tr_b16 v[38:39], v221 offset:512
    ds_read_b64_tr_b16 v[40:41], v220 offset:8192
    ds_read_b64_tr_b16 v[42:43], v220 offset:8704
    v_lshlrev_b32 v2, 16, v135
    v_and_b32 v3, 0xffff0000, v135
    v_add_f32 v28, v28, v2
    v_add_f32 v29, v29, v3
    v_mfma_f32_32x32x16_bf16 v[96:111], v[136:139], v[140:143], v[96:111]
    v_lshlrev_b32 v2, 16, v136
    v_and_b32 v3, 0xffff0000, v136
    v_add_f32 v30, v30, v2
    v_add_f32 v31, v31, v3
    v_mfma_f32_32x32x16_bf16 v[64:79], v[144:147], v[156:159], v[64:79]
    ds_read_b128 v[60:63], v229
    ds_read_b64_tr_b16 v[48:49], v222 offset:0
    ds_read_b64_tr_b16 v[50:51], v222 offset:512
    ds_read_b64_tr_b16 v[52:53], v223 offset:0
    v_lshlrev_b32 v2, 16, v137
    v_and_b32 v3, 0xffff0000, v137
    v_add_f32 v30, v30, v2
    v_add_f32 v31, v31, v3
    v_mfma_f32_32x32x16_bf16 v[80:95], v[148:151], v[156:159], v[80:95]
    ds_read_b64_tr_b16 v[54:55], v223 offset:512
    ds_read_b64_tr_b16 v[56:57], v222 offset:8192
    ds_read_b64_tr_b16 v[58:59], v222 offset:8704
    v_lshlrev_b32 v2, 16, v138
    v_and_b32 v3, 0xffff0000, v138
    v_add_f32 v30, v30, v2
    v_add_f32 v31, v31, v3
    v_mfma_f32_32x32x16_bf16 v[96:111], v[152:155], v[156:159], v[96:111]
    v_lshlrev_b32 v2, 16, v139
    v_and_b32 v3, 0xffff0000, v139
    v_add_f32 v30, v30, v2
    v_add_f32 v31, v31, v3
    s_waitcnt lgkmcnt(7)
    v_mfma_f32_32x32x16_bf16 v[64:79], v[32:35], v[44:47], v[64:79]
    ds_read_b128 v[140:143], v230
    ds_read_b64_tr_b16 v[128:129], v224 offset:0
    ds_read_b64_tr_b16 v[130:131], v224 offset:512
    ds_read_b64_tr_b16 v[132:133], v225 offset:0
    v_lshlrev_b32 v2, 16, v32
    v_and_b32 v3, 0xffff0000, v32
    v_add_f32 v26, v26, v2
    v_add_f32 v27, v27, v3
    v_mfma_f32_32x32x16_bf16 v[80:95], v[36:39], v[44:47], v[80:95]
    ds_read_b64_tr_b16 v[134:135], v225 offset:512
    ds_read_b64_tr_b16 v[136:137], v224 offset:8192
    ds_read_b64_tr_b16 v[138:139], v224 offset:8704
    v_lshlrev_b32 v2, 16, v33
    v_and_b32 v3, 0xffff0000, v33
    v_add_f32 v26, v26, v2
    v_add_f32 v27, v27, v3
    v_mfma_f32_32x32x16_bf16 v[96:111], v[40:43], v[44:47], v[96:111]
    v_lshlrev_b32 v2, 16, v34
    v_and_b32 v3, 0xffff0000, v34
    v_add_f32 v26, v26, v2
    v_add_f32 v27, v27, v3
    s_waitcnt lgkmcnt(7)
    v_mfma_f32_32x32x16_bf16 v[64:79], v[48:51], v[60:63], v[64:79]
    ds_read_b128 v[156:159], v231
    ds_read_b64_tr_b16 v[144:145], v226 offset:0
    ds_read_b64_tr_b16 v[146:147], v226 offset:512
    ds_read_b64_tr_b16 v[148:149], v227 offset:0
    v_lshlrev_b32 v2, 16, v35
    v_and_b32 v3, 0xffff0000, v35
    v_add_f32 v26, v26, v2
    v_add_f32 v27, v27, v3
    v_mfma_f32_32x32x16_bf16 v[80:95], v[52:55], v[60:63], v[80:95]
    ds_read_b64_tr_b16 v[150:151], v227 offset:512
    ds_read_b64_tr_b16 v[152:153], v226 offset:8192
    ds_read_b64_tr_b16 v[154:155], v226 offset:8704
    v_lshlrev_b32 v2, 16, v36
    v_and_b32 v3, 0xffff0000, v36
    v_add_f32 v28, v28, v2
    v_add_f32 v29, v29, v3
    v_mfma_f32_32x32x16_bf16 v[96:111], v[56:59], v[60:63], v[96:111]
    v_lshlrev_b32 v2, 16, v37
    v_and_b32 v3, 0xffff0000, v37
    v_add_f32 v28, v28, v2
    v_add_f32 v29, v29, v3
    s_waitcnt lgkmcnt(0)
    s_barrier
    s_cmp_lg_u32 s3, 4
    s_cbranch_scc1 L5_hk
    s_call_b64 s[76:77], L_stats
L5_hk:
    v_mfma_f32_32x32x16_bf16 v[64:79], v[128:131], v[140:143], v[64:79]
    ds_read_b128 v[44:47], v18
    ds_read_b64_tr_b16 v[32:33], v10 offset:0
    ds_read_b64_tr_b16 v[34:35], v10 offset:512
    ds_read_b64_tr_b16 v[36:37], v11 offset:0
    v_lshlrev_b32 v2, 16, v134
    v_and_b32 v3, 0xffff0000, v134
    v_add_f32 v28, v28, v2
    v_add_f32 v29, v29, v3
    v_mfma_f32_32x32x16_bf16 v[80:95], v[132:135], v[140:143], v[80:95]
    ds_read_b64_tr_b16 v[38:39], v11 offset:512
    ds_read_b64_tr_b16 v[40:41], v10 offset:8192
    ds_read_b64_tr_b16 v[42:43], v10 offset:8704
    v_lshlrev_b32 v2, 16, v135
    v_and_b32 v3, 0xffff0000, v135
    v_add_f32 v28, v28, v2
    v_add_f32 v29, v29, v3
    v_mfma_f32_32x32x16_bf16 v[96:111], v[136:139], v[140:143], v[96:111]
    v_lshlrev_b32 v2, 16, v136
    v_and_b32 v3, 0xffff0000, v136
    v_add_f32 v30, v30, v2
    v_add_f32 v31, v31, v3
    v_mfma_f32_32x32x16_bf16 v[64:79], v[144:147], v[156:159], v[64:79]
    ds_read_b128 v[60:63], v19
    ds_read_b64_tr_b16 v[48:49], v12 offset:0
    ds_read_b64_tr_b16 v[50:51], v12 offset:512
    ds_read_b64_tr_b16 v[52:53], v13 offset:0
    v_lshlrev_b32 v2, 16, v137
    v_and_b32 v3, 0xffff0000, v137
    v_add_f32 v30, v30, v2
    v_add_f32 v31, v31, v3
    v_mfma_f32_32x32x16_bf16 v[80:95], v[148:151], v[156:159], v[80:95]
    ds_read_b64_tr_b16 v[54:55], v13 offset:512
    ds_read_b64_tr_b16 v[56:57], v12 offset:8192
    ds_read_b64_tr_b16 v[58:59], v12 offset:8704
    v_lshlrev_b32 v2, 16, v138
    v_and_b32 v3, 0xffff0000, v138
    v_add_f32 v30, v30, v2
    v_add_f32 v31, v31, v3
    v_mfma_f32_32x32x16_bf16 v[96:111], v[152:155], v[156:159], v[96:111]
    v_lshlrev_b32 v2, 16, v139
    v_and_b32 v3, 0xffff0000, v139
    v_add_f32 v30, v30, v2
    v_add_f32 v31, v31, v3
    s_waitcnt lgkmcnt(7)
    v_mfma_f32_32x32x16_bf16 v[64:79], v[32:35], v[44:47], v[64:79]
    ds_read_b128 v[140:143], v20
    ds_read_b64_tr_b16 v[128:129], v14 offset:0
    ds_read_b64_tr_b16 v[130:131], v14 offset:512
    ds_read_b64_tr_b16 v[132:133], v15 offset:0
    v_lshlrev_b32 v2, 16, v32
    v_and_b32 v3, 0xffff0000, v32
    v_add_f32 v26, v26, v2
    v_add_f32 v27, v27, v3
    v_mfma_f32_32x32x16_bf16 v[80:95], v[36:39], v[44:47], v[80:95]
    ds_read_b64_tr_b16 v[134:135], v15 offset:512
    ds_read_b64_tr_b16 v[136:137], v14 offset:8192
    ds_read_b64_tr_b16 v[138:139], v14 offset:8704
    v_lshlrev_b32 v2, 16, v33
    v_and_b32 v3, 0xffff0000, v33
    v_add_f32 v26, v26, v2
    v_add_f32 v27, v27, v3
    v_mfma_f32_32x32x16_bf16 v[96:111], v[40:43], v[44:47], v[96:111]
    v_lshlrev_b32 v2, 16, v34
    v_and_b32 v3, 0xffff0000, v34
    v_add_f32 v26, v26, v2
    v_add_f32 v27, v27, v3
    s_waitcnt lgkmcnt(7)
    v_mfma_f32_32x32x16_bf16 v[64:79], v[48:51], v[60:63], v[64:79]
    ds_read_b128 v[156:159], v21
    ds_read_b64_tr_b16 v[144:145], v16 offset:0
    ds_read_b64_tr_b16 v[146:147], v16 offset:512
    ds_read_b64_tr_b16 v[148:149], v17 offset:0
    v_lshlrev_b32 v2, 16, v35
    v_and_b32 v3, 0xffff0000, v35
    v_add_f32 v26, v26, v2
    v_add_f32 v27, v27, v3
    v_mfma_f32_32x32x16_bf16 v[80:95], v[52:55], v[60:63], v[80:95]
    ds_read_b64_tr_b16 v[150:151], v17 offset:512
    ds_read_b64_tr_b16 v[152:153], v16 offset:8192
    ds_read_b64_tr_b16 v[154:155], v16 offset:8704
    v_lshlrev_b32 v2, 16, v36
    v_and_b32 v3, 0xffff0000, v36
    v_add_f32 v28, v28, v2
    v_add_f32 v29, v29, v3
    v_mfma_f32_32x32x16_bf16 v[96:111], v[56:59], v[60:63], v[96:111]
    v_lshlrev_b32 v2, 16, v37
    v_and_b32 v3, 0xffff0000, v37
    v_add_f32 v28, v28, v2
    v_add_f32 v29, v29, v3
    s_waitcnt lgkmcnt(0)
L_q_fin:
    v_mfma_f32_32x32x16_bf16 v[64:79], v[128:131], v[140:143], v[64:79]
    v_lshlrev_b32 v2, 16, v134
    v_and_b32 v3, 0xffff0000, v134
    v_add_f32 v28, v28, v2
    v_add_f32 v29, v29, v3
    v_lshlrev_b32 v2, 16, v135
    v_and_b32 v3, 0xffff0000, v135
    v_add_f32 v28, v28, v2
    v_add_f32 v29, v29, v3
    v_mfma_f32_32x32x16_bf16 v[80:95], v[132:135], v[140:143], v[80:95]
    v_lshlrev_b32 v2, 16, v136
    v_and_b32 v3, 0xffff0000, v136
    v_add_f32 v30, v30, v2
    v_add_f32 v31, v31, v3
    v_lshlrev_b32 v2, 16, v137
    v_and_b32 v3, 0xffff0000, v137
    v_add_f32 v30, v30, v2
    v_add_f32 v31, v31, v3
    v_mfma_f32_32x32x16_bf16 v[96:111], v[136:139], v[140:143], v[96:111]
    v_lshlrev_b32 v2, 16, v138
    v_and_b32 v3, 0xffff0000, v138
    v_add_f32 v30, v30, v2
    v_add_f32 v31, v31, v3
    v_lshlrev_b32 v2, 16, v139
    v_and_b32 v3, 0xffff0000, v139
    v_add_f32 v30, v30, v2
    v_add_f32 v31, v31, v3
    v_mfma_f32_32x32x16_bf16 v[64:79], v[144:147], v[156:159], v[64:79]
    v_mfma_f32_32x32x16_bf16 v[80:95], v[148:151], v[156:159], v[80:95]
    v_mfma_f32_32x32x16_bf16 v[96:111], v[152:155], v[156:159], v[96:111]
    s_mul_i32 s74, s101, 3
    s_lshl_b32 s72, s74, 10
    s_add_u32 s72, s72, 122880
    v_add_u32 v1, s72, v253
    s_lshl_b32 s73, s100, 2
    v_add_u32 v9, s73, v1
    v_add_f32 v2, v26, v27
    v_add_f32 v3, v28, v29
    v_add_f32 v4, v30, v31
    v_cvt_pk_bf16_f32 v5, v2, v2
    v_cvt_pk_bf16_f32 v6, v3, v3
    v_cvt_pk_bf16_f32 v7, v4, v4
    v_lshlrev_b32 v5, 16, v5
    v_lshlrev_b32 v6, 16, v6
    v_lshlrev_b32 v7, 16, v7
    v_sub_f32 v5, v2, v5
    v_sub_f32 v6, v3, v6
    v_sub_f32 v7, v4, v7
    v_cvt_pk_bf16_f32 v5, v2, v5
    ds_write_b32 v9, v5 offset:0
    v_cvt_pk_bf16_f32 v6, v3, v6
    ds_write_b32 v9, v6 offset:1024
    v_cvt_pk_bf16_f32 v7, v4, v7
    ds_write_b32 v9, v7 offset:2048
    s_lshl_b32 s73, s100, 8
    s_add_u32 s73, s73, 148224
    v_lshl_add_u32 v5, v251, 3, s73
    v_mov_b32 v6, 155712
    s_waitcnt lgkmcnt(0)
    s_barrier
    ds_read_b64 v[160:161], v5 offset:0
    ds_read_b128 v[10:13], v1 offset:0
    ds_read_b128 v[14:17], v1 offset:1024
    ds_read_b128 v[18:21], v1 offset:2048
    s_cmp_eq_u32 s68, 0
    s_cbranch_scc1 L_q_np
    s_setprio 2
L_q_np:
    s_waitcnt lgkmcnt(3)
    v_mov_b32 v26, v161
    v_mov_b32 v161, v160
    v_mov_b32 v162, v160
    v_mov_b32 v163, v160
    s_waitcnt lgkmcnt(0)
    s_nop 0
    v_mfma_f32_32x32x16_bf16 v[64:79], v[10:13], v[160:163], v[64:79]
    v_mfma_f32_32x32x16_bf16 v[80:95], v[14:17], v[160:163], v[80:95]
    v_mfma_f32_32x32x16_bf16 v[96:111], v[18:21], v[160:163], v[96:111]
    s_lshr_b32 s72, s71, 5
    s_add_u32 s72, s72, s100
    s_mul_i32 s73, s72, 2688
    s_add_u32 s73, s73, 2621440
    s_mul_i32 s72, s72, 40960
    s_mul_i32 s75, s87, 6
    s_add_u32 s74, s74, s75
    s_lshl_b32 s75, s74, 11
    s_add_u32 s72, s72, s75
    v_mul_f32 v28, 0x3ea52b5c, v26
    s_nop 1
    s_cmp_lt_u32 s74, 20
    s_cbranch_scc0 L6_kv
    v_pk_mul_f32 v[64:65], v[64:65], v[28:29] op_sel_hi:[1,0]
    v_pk_mul_f32 v[66:67], v[66:67], v[28:29] op_sel_hi:[1,0]
    v_pk_mul_f32 v[68:69], v[68:69], v[28:29] op_sel_hi:[1,0]
    v_pk_mul_f32 v[70:71], v[70:71], v[28:29] op_sel_hi:[1,0]
    v_pk_mul_f32 v[72:73], v[72:73], v[28:29] op_sel_hi:[1,0]
    v_pk_mul_f32 v[74:75], v[74:75], v[28:29] op_sel_hi:[1,0]
    v_pk_mul_f32 v[76:77], v[76:77], v[28:29] op_sel_hi:[1,0]
    v_pk_mul_f32 v[78:79], v[78:79], v[28:29] op_sel_hi:[1,0]
    v_cvt_pk_bf16_f32 v64, v64, v65
    v_cvt_pk_bf16_f32 v65, v66, v67
    v_cvt_pk_bf16_f32 v66, v68, v69
    v_cvt_pk_bf16_f32 v67, v70, v71
    v_cvt_pk_bf16_f32 v68, v72, v73
    v_cvt_pk_bf16_f32 v69, v74, v75
    v_cvt_pk_bf16_f32 v70, v76, v77
    v_cvt_pk_bf16_f32 v71, v78, v79
    buffer_store_dwordx4 v[64:67], v253, s[44:47], s72 offen offset:0 sc1
    buffer_store_dwordx4 v[68:71], v253, s[44:47], s72 offen offset:1024 sc1
    s_branch L7_sd
L6_kv:
    v_pk_mul_f32 v[64:65], v[64:65], v[26:27] op_sel_hi:[1,0]
    v_pk_mul_f32 v[66:67], v[66:67], v[26:27] op_sel_hi:[1,0]
    v_pk_mul_f32 v[68:69], v[68:69], v[26:27] op_sel_hi:[1,0]
    v_pk_mul_f32 v[70:71], v[70:71], v[26:27] op_sel_hi:[1,0]
    v_pk_mul_f32 v[72:73], v[72:73], v[26:27] op_sel_hi:[1,0]
    v_pk_mul_f32 v[74:75], v[74:75], v[26:27] op_sel_hi:[1,0]
    s_mul_i32 s75, s100, 2304
    s_add_u32 s75, s75, 131072
    v_mul_u32_u24 v1, 288, v252
    v_lshl_add_u32 v1, v251, 1, v1
    v_add_u32 v1, s75, v1
    v_mul_u32_u24 v2, 72, v251
    v_lshl_add_u32 v2, v252, 3, v2
    v_add_u32 v2, s75, v2
    v_cndmask_b32 v72, v72, 1.0, s[92:93]
    v_cndmask_b32 v73, v73, 0, s[92:93]
    v_cndmask_b32 v74, v74, 0, s[92:93]
    v_cndmask_b32 v75, v75, 0, s[92:93]
    v_cvt_pk_bf16_f32 v64, v64, v65
    v_cvt_pk_bf16_f32 v65, v66, v67
    v_cvt_pk_bf16_f32 v66, v68, v69
    v_cvt_pk_bf16_f32 v67, v70, v71
    v_cvt_pk_bf16_f32 v68, v72, v73
    v_cvt_pk_bf16_f32 v69, v74, v75
    ds_write_b16 v1, v64 offset:0
    ds_write_b16_d16_hi v1, v64 offset:72
    ds_write_b16 v1, v65 offset:144
    ds_write_b16_d16_hi v1, v65 offset:216
    ds_write_b16 v1, v66 offset:576
    ds_write_b16_d16_hi v1, v66 offset:648
    ds_write_b16 v1, v67 offset:720
    ds_write_b16_d16_hi v1, v67 offset:792
    ds_write_b16 v1, v68 offset:1152
    ds_write_b16_d16_hi v1, v68 offset:1224
    ds_write_b16 v1, v69 offset:1296
    ds_write_b16_d16_hi v1, v69 offset:1368
    ds_read2_b64 v[72:75], v2 offset0:0 offset1:2
    ds_read2_b64 v[76:79], v2 offset0:4 offset1:6
    s_waitcnt lgkmcnt(0)
    buffer_store_dwordx4 v[72:75], v0, s[44:47], s73 offen offset:1280 sc1
    buffer_store_dwordx4 v[76:79], v0, s[44:47], s73 offen offset:1952 sc1
L7_sd:
    s_cmp_lt_u32 s74, 19
    s_cbranch_scc0 L8_kv
    v_pk_mul_f32 v[80:81], v[80:81], v[28:29] op_sel_hi:[1,0]
    v_pk_mul_f32 v[82:83], v[82:83], v[28:29] op_sel_hi:[1,0]
    v_pk_mul_f32 v[84:85], v[84:85], v[28:29] op_sel_hi:[1,0]
    v_pk_mul_f32 v[86:87], v[86:87], v[28:29] op_sel_hi:[1,0]
    v_pk_mul_f32 v[88:89], v[88:89], v[28:29] op_sel_hi:[1,0]
    v_pk_mul_f32 v[90:91], v[90:91], v[28:29] op_sel_hi:[1,0]
    v_pk_mul_f32 v[92:93], v[92:93], v[28:29] op_sel_hi:[1,0]
    v_pk_mul_f32 v[94:95], v[94:95], v[28:29] op_sel_hi:[1,0]
    v_cvt_pk_bf16_f32 v80, v80, v81
    v_cvt_pk_bf16_f32 v81, v82, v83
    v_cvt_pk_bf16_f32 v82, v84, v85
    v_cvt_pk_bf16_f32 v83, v86, v87
    v_cvt_pk_bf16_f32 v84, v88, v89
    v_cvt_pk_bf16_f32 v85, v90, v91
    v_cvt_pk_bf16_f32 v86, v92, v93
    v_cvt_pk_bf16_f32 v87, v94, v95
    buffer_store_dwordx4 v[80:83], v253, s[44:47], s72 offen offset:2048 sc1
    buffer_store_dwordx4 v[84:87], v253, s[44:47], s72 offen offset:3072 sc1
    s_add_u32 s72, s72, 4096
    s_branch L9_sd
L8_kv:
L9_sd:
    s_cmp_lt_u32 s74, 18
    s_cbranch_scc0 L10_kv
    v_pk_mul_f32 v[96:97], v[96:97], v[28:29] op_sel_hi:[1,0]
    v_pk_mul_f32 v[98:99], v[98:99], v[28:29] op_sel_hi:[1,0]
    v_pk_mul_f32 v[100:101], v[100:101], v[28:29] op_sel_hi:[1,0]
    v_pk_mul_f32 v[102:103], v[102:103], v[28:29] op_sel_hi:[1,0]
    v_pk_mul_f32 v[104:105], v[104:105], v[28:29] op_sel_hi:[1,0]
    v_pk_mul_f32 v[106:107], v[106:107], v[28:29] op_sel_hi:[1,0]
    v_pk_mul_f32 v[108:109], v[108:109], v[28:29] op_sel_hi:[1,0]
    v_pk_mul_f32 v[110:111], v[110:111], v[28:29] op_sel_hi:[1,0]
    v_cvt_pk_bf16_f32 v96, v96, v97
    v_cvt_pk_bf16_f32 v97, v98, v99
    v_cvt_pk_bf16_f32 v98, v100, v101
    v_cvt_pk_bf16_f32 v99, v102, v103
    v_cvt_pk_bf16_f32 v100, v104, v105
    v_cvt_pk_bf16_f32 v101, v106, v107
    v_cvt_pk_bf16_f32 v102, v108, v109
    v_cvt_pk_bf16_f32 v103, v110, v111
    buffer_store_dwordx4 v[96:99], v253, s[44:47], s72 offen offset:0 sc1
    buffer_store_dwordx4 v[100:103], v253, s[44:47], s72 offen offset:1024 sc1
    s_branch L11_sd
L10_kv:
    s_cmp_eq_u32 s74, 18
    s_cbranch_scc0 L11_sd
    v_pk_mul_f32 v[96:97], v[96:97], v[26:27] op_sel_hi:[1,0]
    v_pk_mul_f32 v[98:99], v[98:99], v[26:27] op_sel_hi:[1,0]
    v_pk_mul_f32 v[100:101], v[100:101], v[26:27] op_sel_hi:[1,0]
    v_pk_mul_f32 v[102:103], v[102:103], v[26:27] op_sel_hi:[1,0]
    v_pk_mul_f32 v[104:105], v[104:105], v[26:27] op_sel_hi:[1,0]
    v_pk_mul_f32 v[106:107], v[106:107], v[26:27] op_sel_hi:[1,0]
    v_cvt_pk_bf16_f32 v96, v96, v97
    v_cvt_pk_bf16_f32 v97, v98, v99
    v_cvt_pk_bf16_f32 v98, v100, v101
    v_cvt_pk_bf16_f32 v99, v102, v103
    v_cvt_pk_bf16_f32 v100, v104, v105
    v_cvt_pk_bf16_f32 v101, v106, v107
    buffer_store_dwordx4 v[96:99], v253, s[44:47], s73 offen sc1
    buffer_store_dwordx2 v[100:101], v254, s[44:47], s73 offen offset:1024 sc1
L11_sd:
    s_cmp_lg_u32 s68, 0
    s_cbranch_scc1 L_q_lh
    v_mov_b32 v246, 0
    v_mov_b32 v247, 0
    s_mul_i32 s72, s70, 320
    v_add_u32 v6, 0, v250
    v_mul_u32_u24 v4, 3277, v6
    v_lshrrev_b32 v4, 16, v4
    v_mul_u32_u24 v5, 20, v4
    v_sub_u32 v5, v6, v5
    v_mul_u32_u24 v4, 1280, v4
    v_lshl_add_u32 v4, v5, 4, v4
    v_add_u32 v168, s72, v4
    v_add_u32 v6, 64, v250
    v_mul_u32_u24 v4, 3277, v6
    v_lshrrev_b32 v4, 16, v4
    v_mul_u32_u24 v5, 20, v4
    v_sub_u32 v5, v6, v5
    v_mul_u32_u24 v4, 1280, v4
    v_lshl_add_u32 v4, v5, 4, v4
    v_add_u32 v169, s72, v4
    v_subrev_u32 v169, 1024, v169
    v_add_u32 v6, 128, v250
    v_mul_u32_u24 v4, 3277, v6
    v_lshrrev_b32 v4, 16, v4
    v_mul_u32_u24 v5, 20, v4
    v_sub_u32 v5, v6, v5
    v_mul_u32_u24 v4, 1280, v4
    v_lshl_add_u32 v4, v5, 4, v4
    v_add_u32 v170, s72, v4
    v_subrev_u32 v170, 2048, v170
    v_add_u32 v6, 192, v250
    v_mul_u32_u24 v4, 3277, v6
    v_lshrrev_b32 v4, 16, v4
    v_mul_u32_u24 v5, 20, v4
    v_sub_u32 v5, v6, v5
    v_mul_u32_u24 v4, 1280, v4
    v_lshl_add_u32 v4, v5, 4, v4
    v_add_u32 v171, s72, v4
    v_subrev_u32 v171, 3072, v171
    v_add_u32 v6, 256, v250
    v_mul_u32_u24 v4, 3277, v6
    v_lshrrev_b32 v4, 16, v4
    v_mul_u32_u24 v5, 20, v4
    v_sub_u32 v5, v6, v5
    v_mul_u32_u24 v4, 1280, v4
    v_lshl_add_u32 v4, v5, 4, v4
    v_add_u32 v172, s72, v4
    s_mul_i32 s72, s67, 30720
    v_bfe_u32 v6, v250, 2, 2
    v_bfe_u32 v4, v250, 4, 1
    v_and_b32 v5, 3, v250
    v_lshl_add_u32 v4, v4, 2, v5
    s_lshl_b32 s73, s67, 1
    v_xor_b32 v4, s73, v4
    v_lshl_add_u32 v4, v4, 3, s72
    v_lshl_add_u32 v5, v252, 2, v6
    v_mul_u32_u24 v5, 320, v5
    v_add_u32 v173, v4, v5
    v_lshl_add_u32 v5, v252, 3, v6
    v_mul_u32_u24 v5, 320, v5
    v_add_u32 v174, v4, v5
    v_add_u32 v178, s72, v253
    s_xor_b32 s73, s67, 1
    s_mul_i32 s73, s73, 30720
    v_add_u32 v175, s73, v253
    s_xor_b32 s73, s67, 2
    s_mul_i32 s73, s73, 30720
    v_add_u32 v176, s73, v253
    s_xor_b32 s73, s67, 3
    s_mul_i32 s73, s73, 30720
    v_add_u32 v179, s73, v253
    s_branch L_q_lx
L_q_lh:
    s_lshl_b32 s72, s69, 5
    s_lshl_b32 s73, s70, 2
    s_add_u32 s72, s72, s73
    s_add_u32 s72, s72, s67
    s_lshl_b32 s72, s72, 2
    s_add_u32 s52, s72, 3112960
    s_and_b32 s55, s67, 2
    s_mul_i32 s53, s55, 43008
    s_add_u32 s53, s53, 2621440
    s_lshl_b32 s54, s70, 3
    s_and_b32 s72, s67, 1
    s_lshl_b32 s72, s72, 2
    s_add_u32 s54, s54, s72
    v_lshlrev_b32 v7, 4, v251
    v_mov_b32 v8, 0x80000000
    s_xor_b32 s72, s55, 0
    s_add_u32 s72, s72, s54
    s_mul_i32 s72, s72, 5
    v_add_u32 v4, s72, v252
    v_lshrrev_b32 v5, 2, v4
    v_lshl_add_u32 v5, v5, 10, v7
    v_and_b32 v6, 1, v4
    v_lshl_add_u32 v5, v6, 9, v5
    v_and_b32 v6, 2, v4
    v_lshl_add_u32 v168, v6, 2, v5
    v_add_u32 v4, s72, v252
    v_add_u32 v4, 2, v4
    v_lshrrev_b32 v5, 2, v4
    v_lshl_add_u32 v5, v5, 10, v7
    v_and_b32 v6, 1, v4
    v_lshl_add_u32 v5, v6, 9, v5
    v_and_b32 v6, 2, v4
    v_lshl_add_u32 v170, v6, 2, v5
    v_add_u32 v4, s72, v252
    v_add_u32 v4, 4, v4
    v_lshrrev_b32 v5, 2, v4
    v_lshl_add_u32 v5, v5, 10, v7
    v_and_b32 v6, 1, v4
    v_lshl_add_u32 v5, v6, 9, v5
    v_and_b32 v6, 2, v4
    v_lshl_add_u32 v184, v6, 2, v5
    v_cndmask_b32 v184, v184, v8, s[92:93]
    s_xor_b32 s72, s55, 1
    s_add_u32 s72, s72, s54
    s_mul_i32 s72, s72, 5
    v_add_u32 v4, s72, v252
    v_lshrrev_b32 v5, 2, v4
    v_lshl_add_u32 v5, v5, 10, v7
    v_and_b32 v6, 1, v4
    v_lshl_add_u32 v5, v6, 9, v5
    v_and_b32 v6, 2, v4
    v_lshl_add_u32 v172, v6, 2, v5
    v_add_u32 v4, s72, v252
    v_add_u32 v4, 2, v4
    v_lshrrev_b32 v5, 2, v4
    v_lshl_add_u32 v5, v5, 10, v7
    v_and_b32 v6, 1, v4
    v_lshl_add_u32 v5, v6, 9, v5
    v_and_b32 v6, 2, v4
    v_lshl_add_u32 v174, v6, 2, v5
    v_add_u32 v4, s72, v252
    v_add_u32 v4, 4, v4
    v_lshrrev_b32 v5, 2, v4
    v_lshl_add_u32 v5, v5, 10, v7
    v_and_b32 v6, 1, v4
    v_lshl_add_u32 v5, v6, 9, v5
    v_and_b32 v6, 2, v4
    v_lshl_add_u32 v186, v6, 2, v5
    v_cndmask_b32 v186, v186, v8, s[92:93]
    s_xor_b32 s72, s55, 2
    s_add_u32 s72, s72, s54
    s_mul_i32 s72, s72, 5
    v_add_u32 v4, s72, v252
    v_lshrrev_b32 v5, 2, v4
    v_lshl_add_u32 v5, v5, 10, v7
    v_and_b32 v6, 1, v4
    v_lshl_add_u32 v5, v6, 9, v5
    v_and_b32 v6, 2, v4
    v_lshl_add_u32 v176, v6, 2, v5
    v_add_u32 v4, s72, v252
    v_add_u32 v4, 2, v4
    v_lshrrev_b32 v5, 2, v4
    v_lshl_add_u32 v5, v5, 10, v7
    v_and_b32 v6, 1, v4
    v_lshl_add_u32 v5, v6, 9, v5
    v_and_b32 v6, 2, v4
    v_lshl_add_u32 v178, v6, 2, v5
    v_add_u32 v4, s72, v252
    v_add_u32 v4, 4, v4
    v_lshrrev_b32 v5, 2, v4
    v_lshl_add_u32 v5, v5, 10, v7
    v_and_b32 v6, 1, v4
    v_lshl_add_u32 v5, v6, 9, v5
    v_and_b32 v6, 2, v4
    v_lshl_add_u32 v188, v6, 2, v5
    v_cndmask_b32 v188, v188, v8, s[92:93]
    s_xor_b32 s72, s55, 3
    s_add_u32 s72, s72, s54
    s_mul_i32 s72, s72, 5
    v_add_u32 v4, s72, v252
    v_lshrrev_b32 v5, 2, v4
    v_lshl_add_u32 v5, v5, 10, v7
    v_and_b32 v6, 1, v4
    v_lshl_add_u32 v5, v6, 9, v5
    v_and_b32 v6, 2, v4
    v_lshl_add_u32 v180, v6, 2, v5
    v_add_u32 v4, s72, v252
    v_add_u32 v4, 2, v4
    v_lshrrev_b32 v5, 2, v4
    v_lshl_add_u32 v5, v5, 10, v7
    v_and_b32 v6, 1, v4
    v_lshl_add_u32 v5, v6, 9, v5
    v_and_b32 v6, 2, v4
    v_lshl_add_u32 v182, v6, 2, v5
    v_add_u32 v4, s72, v252
    v_add_u32 v4, 4, v4
    v_lshrrev_b32 v5, 2, v4
    v_lshl_add_u32 v5, v5, 10, v7
    v_and_b32 v6, 1, v4
    v_lshl_add_u32 v5, v6, 9, v5
    v_and_b32 v6, 2, v4
    v_lshl_add_u32 v190, v6, 2, v5
    v_cndmask_b32 v190, v190, v8, s[92:93]
    s_lshl_b32 s72, s67, 13
    s_add_u32 s72, s72, 122880
    s_xor_b32 s73, s67, 2
    s_lshl_b32 s73, s73, 13
    s_add_u32 s73, s73, 122880
    v_add_u32 v22, s72, v253
    v_add_u32 v23, s73, v253
L_q_lx:
    s_waitcnt vmcnt(0)
    s_barrier
    s_cmp_eq_u32 s68, 0
    s_cbranch_scc1 L_p2
    s_cmp_lg_u32 s3, 4
    s_cbranch_scc1 L_q_po
    s_lshl_b32 s72, s71, 2
    s_lshl_b32 s73, s87, 7
    s_add_u32 s72, s72, s73
    s_add_u32 s72, s72, 2949120
    s_mov_b64 exec, 1
    v_mov_b32 v2, s79
    buffer_store_dword v2, v244, s[44:47], s72 offen sc1
    s_mov_b64 exec, -1
L_q_po:
    s_add_u32 s73, s54, s55
    s_mul_i32 s73, s73, 5
    s_mul_i32 s56, s69, 160
    s_add_u32 s56, s56, s73
    s_lshl_b32 s56, s56, 8
    s_add_u32 s56, s56, 9437184
    v_mov_b32 v204, -1
    v_mov_b32 v205, -1
    v_mov_b32 v206, -1
    v_mov_b32 v207, -1
    buffer_store_dwordx4 v[204:207], v253, s[44:47], s56 offen sc1
    buffer_store_dwordx4 v[204:207], v253, s[44:47], s56 offen offset:1024 sc1
    buffer_store_dwordx4 v[204:207], v253, s[44:47], s56 offen offset:1536 sc1
    v_mov_b32 v2, s79
    s_waitcnt vmcnt(0)
    s_mov_b64 exec, 1
    buffer_store_dword v2, v244, s[44:47], s52 offen sc1
    s_mov_b64 exec, -1
    s_branch L_p2
L_stats:
    s_mov_b32 s73, 0
L_stats_l:
    s_waitcnt vmcnt(0)
    v_xor_b32 v4, s79, v161
    v_xor_b32 v5, s79, v163
    v_xor_b32 v6, s79, v165
    v_xor_b32 v7, s79, v167
    v_or3_b32 v4, v4, v5, v6
    v_or_b32 v4, v4, v7
    v_cmp_ne_u32 vcc, 0, v4
    s_add_u32 s73, s73, 1
    s_cmp_eq_u64 vcc, 0
    s_cbranch_scc1 L_stats_d
    s_sleep 8
    s_cmp_lt_u32 s66, 24
    s_cselect_b32 s72, 1024, 0
    s_add_u32 s72, s72, s83
    buffer_load_dwordx4 v[160:163], v253, s[44:47], s83 offen sc1
    buffer_load_dwordx4 v[164:167], v253, s[44:47], s72 offen sc1
    s_cmp_lt_u32 s73, 262144
    s_cbranch_scc1 L_stats_l
L_stats_d:
    s_mov_b32 s72, 0x01000100
    v_and_b32 v161, 0xffff0000, v160
    v_rcp_f32 v161, v161
    v_perm_b32 v160, v160, v160, s72
    v_and_b32 v163, 0xffff0000, v162
    v_rcp_f32 v163, v163
    v_perm_b32 v162, v162, v162, s72
    v_and_b32 v165, 0xffff0000, v164
    v_rcp_f32 v165, v165
    v_perm_b32 v164, v164, v164, s72
    v_and_b32 v167, 0xffff0000, v166
    v_rcp_f32 v167, v167
    v_perm_b32 v166, v166, v166, s72
    v_add_u32 v4, 148224, v253
    ds_write_b128 v4, v[160:163]
    ds_write_b128 v4, v[164:167] offset:1024
    s_setpc_b64 s[76:77]
L_g_l:
    v_and_b32 v2, 1, v2
    v_lshlrev_b32 v2, 1, v2
    v_xor_b32 v4, v4, v2
    s_lshl_b32 s74, s67, 4
    v_add_u32 v1, s74, v1
    v_mul_u32_u24 v1, 3072, v1
    v_lshl_add_u32 v1, v4, 4, v1
    s_lshl_b32 s74, s87, 7
    v_add_u32 v24, s74, v1
    s_lshl_b32 s81, s67, 13
    s_lshl_b32 s80, s67, 11
    s_mul_i32 s99, s99, 196608
    s_waitcnt lgkmcnt(0)
    s_mov_b32 s40, s16
    s_mov_b32 s41, s17
    s_mov_b32 s42, 2621440
    s_mov_b32 s43, 0x00020000
    s_mov_b32 s52, s28
    s_mov_b32 s53, s29
    s_mov_b32 s54, 1966080
    s_mov_b32 s55, 0x00020000
    s_mov_b32 s56, s30
    s_mov_b32 s57, s31
    s_mov_b32 s58, 1966080
    s_mov_b32 s59, 0x00020000
    s_add_u32 m0, s81, 0
    s_add_u32 s75, s82, 0
    buffer_load_dwordx4 v22, s[40:43], s75 offen offset:0 lds
    s_add_u32 s75, s82, 9216
    buffer_load_dwordx4 v23, s[40:43], s75 offen offset:1024 lds
    s_add_u32 s75, s82, 18432
    buffer_load_dwordx4 v22, s[40:43], s75 offen offset:2048 lds
    s_add_u32 s75, s82, 27648
    buffer_load_dwordx4 v23, s[40:43], s75 offen offset:3072 lds
    s_add_u32 m0, s80, 32768
    s_add_u32 s75, s99, 0
    buffer_load_dwordx4 v24, s[52:55], s75 offen offset:0 lds
    s_add_u32 s75, s99, 23552
    buffer_load_dwordx4 v24, s[52:55], s75 offen offset:1024 lds
    s_add_u32 m0, s81, 4096
    s_add_u32 s75, s82, 40960
    buffer_load_dwordx4 v22, s[40:43], s75 offen offset:0 lds
    s_add_u32 s75, s82, 50176
    buffer_load_dwordx4 v23, s[40:43], s75 offen offset:1024 lds
    s_add_u32 s75, s82, 59392
    buffer_load_dwordx4 v22, s[40:43], s75 offen offset:2048 lds
    s_add_u32 s75, s82, 68608
    buffer_load_dwordx4 v23, s[40:43], s75 offen offset:3072 lds
    s_add_u32 m0, s80, 41024
    s_add_u32 s75, s99, 0
    buffer_load_dwordx4 v24, s[56:59], s75 offen offset:0 lds
    s_add_u32 s75, s99, 23552
    buffer_load_dwordx4 v24, s[56:59], s75 offen offset:1024 lds
    s_add_u32 s82, s82, 128
    s_add_u32 s99, s99, 196608
    s_cmp_eq_u32 s82, 1280
    s_cselect_b32 s82, 0, s82
    s_cselect_b32 s99, 0, s99
    s_branch L_common
L_g_rd:
    v_lshlrev_b32 v2, 7, v2
    v_mul_u32_u24 v3, 8256, v3
    v_add_u32 v2, v2, v3
    v_and_b32 v1, 2, v1
    v_bfe_u32 v3, v250, 1, 1
    v_add_u32 v1, v1, v3
    v_lshl_add_u32 v2, v1, 4, v2
    v_and_b32 v3, 1, v250
    v_lshl_add_u32 v2, v3, 3, v2
    s_lshl_b32 s72, s101, 6
    s_add_u32 s72, s72, 32768
    s_xor_b32 s73, s100, 0
    s_lshl_b32 s73, s73, 11
    s_add_u32 s73, s73, s72
    v_add_u32 v10, s73, v2
    v_xor_b32 v11, 32, v10
    s_xor_b32 s73, s100, 1
    s_lshl_b32 s73, s73, 11
    s_add_u32 s73, s73, s72
    v_add_u32 v12, s73, v2
    v_xor_b32 v13, 32, v12
    s_xor_b32 s73, s100, 2
    s_lshl_b32 s73, s73, 11
    s_add_u32 s73, s73, s72
    v_add_u32 v14, s73, v2
    v_xor_b32 v15, 32, v14
    s_xor_b32 s73, s100, 3
    s_lshl_b32 s73, s73, 11
    s_add_u32 s73, s73, s72
    v_add_u32 v16, s73, v2
    v_xor_b32 v17, 32, v16
    s_cmp_lg_u32 s68, 0
    s_cbranch_scc1 L_gu_h
    v_add_u32 v208, 49408, v10
    v_add_u32 v209, 49408, v11
    v_add_u32 v210, 49408, v12
    v_add_u32 v211, 49408, v13
    v_add_u32 v212, 49408, v14
    v_add_u32 v213, 49408, v15
    v_add_u32 v214, 49408, v16
    v_add_u32 v215, 49408, v17
    v_add_u32 v216, 49408, v18
    v_add_u32 v217, 49408, v19
    v_add_u32 v218, 49408, v20
    v_add_u32 v219, 49408, v21
    v_add_u32 v220, 98816, v10
    v_add_u32 v221, 98816, v11
    v_add_u32 v222, 98816, v12
    v_add_u32 v223, 98816, v13
    v_add_u32 v224, 98816, v14
    v_add_u32 v225, 98816, v15
    v_add_u32 v226, 98816, v16
    v_add_u32 v227, 98816, v17
    v_add_u32 v228, 98816, v18
    v_add_u32 v229, 98816, v19
    v_add_u32 v230, 98816, v20
    v_add_u32 v231, 98816, v21
    s_add_u32 m0, s81, 49408
    s_add_u32 s75, s82, 0
    buffer_load_dwordx4 v22, s[40:43], s75 offen offset:0 lds
    s_add_u32 s75, s82, 9216
    buffer_load_dwordx4 v23, s[40:43], s75 offen offset:1024 lds
    s_add_u32 s75, s82, 18432
    buffer_load_dwordx4 v22, s[40:43], s75 offen offset:2048 lds
    s_add_u32 s75, s82, 27648
    buffer_load_dwordx4 v23, s[40:43], s75 offen offset:3072 lds
    s_add_u32 m0, s80, 82176
    s_add_u32 s75, s99, 0
    buffer_load_dwordx4 v24, s[52:55], s75 offen offset:0 lds
    s_add_u32 s75, s99, 23552
    buffer_load_dwordx4 v24, s[52:55], s75 offen offset:1024 lds
    s_add_u32 m0, s81, 53504
    s_add_u32 s75, s82, 40960
    buffer_load_dwordx4 v22, s[40:43], s75 offen offset:0 lds
    s_add_u32 s75, s82, 50176
    buffer_load_dwordx4 v23, s[40:43], s75 offen offset:1024 lds
    s_add_u32 s75, s82, 59392
    buffer_load_dwordx4 v22, s[40:43], s75 offen offset:2048 lds
    s_add_u32 s75, s82, 68608
    buffer_load_dwordx4 v23, s[40:43], s75 offen offset:3072 lds
    s_add_u32 m0, s80, 90432
    s_add_u32 s75, s99, 0
    buffer_load_dwordx4 v24, s[56:59], s75 offen offset:0 lds
    s_add_u32 s75, s99, 23552
    buffer_load_dwordx4 v24, s[56:59], s75 offen offset:1024 lds
    s_add_u32 s82, s82, 128
    s_add_u32 s99, s99, 196608
    s_cmp_eq_u32 s82, 1280
    s_cselect_b32 s82, 0, s82
    s_cselect_b32 s99, 0, s99
    s_waitcnt vmcnt(12)
    s_barrier
    ds_read_b64_tr_b16 v[32:33], v10 offset:0
    ds_read_b64_tr_b16 v[34:35], v10 offset:512
    ds_read_b128 v[40:43], v18 offset:0
    s_add_u32 m0, s81, 98816
    s_add_u32 s75, s82, 0
    buffer_load_dwordx4 v22, s[40:43], s75 offen offset:0 lds
    ds_read_b64_tr_b16 v[36:37], v11 offset:0
    ds_read_b64_tr_b16 v[38:39], v11 offset:512
    ds_read_b128 v[44:47], v18 offset:4096
    s_add_u32 s75, s82, 9216
    buffer_load_dwordx4 v23, s[40:43], s75 offen offset:1024 lds
    s_add_u32 s75, s82, 18432
    buffer_load_dwordx4 v22, s[40:43], s75 offen offset:2048 lds
    ds_read_b64_tr_b16 v[48:49], v12 offset:0
    ds_read_b64_tr_b16 v[50:51], v12 offset:512
    ds_read_b128 v[56:59], v19 offset:0
    s_add_u32 s75, s82, 27648
    buffer_load_dwordx4 v23, s[40:43], s75 offen offset:3072 lds
    ds_read_b64_tr_b16 v[52:53], v13 offset:0
    ds_read_b64_tr_b16 v[54:55], v13 offset:512
    ds_read_b128 v[60:63], v19 offset:4096
    s_add_u32 m0, s80, 131584
    s_add_u32 s75, s99, 0
    buffer_load_dwordx4 v24, s[52:55], s75 offen offset:0 lds
    s_add_u32 s75, s99, 23552
    buffer_load_dwordx4 v24, s[52:55], s75 offen offset:1024 lds
    s_waitcnt lgkmcnt(6)
    v_mfma_f32_32x32x16_bf16 v[64:79], v[32:35], v[40:43], 0
    ds_read_b64_tr_b16 v[128:129], v14 offset:0
    ds_read_b64_tr_b16 v[130:131], v14 offset:512
    ds_read_b128 v[136:139], v20 offset:0
    s_add_u32 m0, s81, 102912
    s_add_u32 s75, s82, 40960
    buffer_load_dwordx4 v22, s[40:43], s75 offen offset:0 lds
    v_lshlrev_b32 v2, 16, v32
    v_and_b32 v3, 0xffff0000, v32
    v_mfma_f32_32x32x16_bf16 v[80:95], v[32:35], v[44:47], 0
    ds_read_b64_tr_b16 v[132:133], v15 offset:0
    ds_read_b64_tr_b16 v[134:135], v15 offset:512
    ds_read_b128 v[140:143], v20 offset:4096
    s_add_u32 s75, s82, 50176
    buffer_load_dwordx4 v23, s[40:43], s75 offen offset:1024 lds
    v_add_f32 v26, v26, v2
    v_add_f32 v27, v27, v3
    v_mfma_f32_32x32x16_bf16 v[96:111], v[36:39], v[40:43], 0
    s_add_u32 s75, s82, 59392
    buffer_load_dwordx4 v22, s[40:43], s75 offen offset:2048 lds
    v_lshlrev_b32 v2, 16, v33
    v_and_b32 v3, 0xffff0000, v33
    v_mfma_f32_32x32x16_bf16 v[112:127], v[36:39], v[44:47], 0
    v_add_f32 v26, v26, v2
    v_add_f32 v27, v27, v3
    s_waitcnt lgkmcnt(6)
    v_mfma_f32_32x32x16_bf16 v[64:79], v[48:51], v[56:59], v[64:79]
    ds_read_b64_tr_b16 v[144:145], v16 offset:0
    ds_read_b64_tr_b16 v[146:147], v16 offset:512
    ds_read_b128 v[152:155], v21 offset:0
    s_add_u32 s75, s82, 68608
    buffer_load_dwordx4 v23, s[40:43], s75 offen offset:3072 lds
    v_lshlrev_b32 v2, 16, v34
    v_and_b32 v3, 0xffff0000, v34
    v_mfma_f32_32x32x16_bf16 v[80:95], v[48:51], v[60:63], v[80:95]
    ds_read_b64_tr_b16 v[148:149], v17 offset:0
    ds_read_b64_tr_b16 v[150:151], v17 offset:512
    ds_read_b128 v[156:159], v21 offset:4096
    s_add_u32 m0, s80, 139840
    s_add_u32 s75, s99, 0
    buffer_load_dwordx4 v24, s[56:59], s75 offen offset:0 lds
    v_add_f32 v26, v26, v2
    v_add_f32 v27, v27, v3
    v_mfma_f32_32x32x16_bf16 v[96:111], v[52:55], v[56:59], v[96:111]
    s_add_u32 s75, s99, 23552
    buffer_load_dwordx4 v24, s[56:59], s75 offen offset:1024 lds
    s_add_u32 s82, s82, 128
    s_add_u32 s99, s99, 196608
    s_cmp_eq_u32 s82, 1280
    s_cselect_b32 s82, 0, s82
    s_cselect_b32 s99, 0, s99
    v_lshlrev_b32 v2, 16, v35
    v_and_b32 v3, 0xffff0000, v35
    v_mfma_f32_32x32x16_bf16 v[112:127], v[52:55], v[60:63], v[112:127]
    v_add_f32 v26, v26, v2
    v_add_f32 v27, v27, v3
    s_waitcnt lgkmcnt(0)
    s_waitcnt vmcnt(12)
    s_barrier
    v_mfma_f32_32x32x16_bf16 v[64:79], v[128:131], v[136:139], v[64:79]
    ds_read_b64_tr_b16 v[32:33], v208 offset:0
    ds_read_b64_tr_b16 v[34:35], v208 offset:512
    ds_read_b128 v[40:43], v216 offset:0
    s_add_u32 m0, s81, 0
    s_add_u32 s75, s82, 0
    buffer_load_dwordx4 v22, s[40:43], s75 offen offset:0 lds
    v_lshlrev_b32 v2, 16, v132
    v_and_b32 v3, 0xffff0000, v132
    v_lshlrev_b32 v254, 3, v250
    v_mov_b32 v4, 0x80000000
    v_mfma_f32_32x32x16_bf16 v[80:95], v[128:131], v[140:143], v[80:95]
    ds_read_b64_tr_b16 v[36:37], v209 offset:0
    ds_read_b64_tr_b16 v[38:39], v209 offset:512
    ds_read_b128 v[44:47], v216 offset:4096
    s_add_u32 s75, s82, 9216
    buffer_load_dwordx4 v23, s[40:43], s75 offen offset:1024 lds
    v_add_f32 v28, v28, v2
    v_add_f32 v29, v29, v3
    v_cndmask_b32 v254, v254, v4, s[92:93]
    v_mul_u32_u24 v5, 21, v252
    v_mfma_f32_32x32x16_bf16 v[96:111], v[132:135], v[136:139], v[96:111]
    s_add_u32 s75, s82, 18432
    buffer_load_dwordx4 v22, s[40:43], s75 offen offset:2048 lds
    v_lshlrev_b32 v2, 16, v133
    v_and_b32 v3, 0xffff0000, v133
    v_add_lshl_u32 v5, v5, v251, 4
    v_mfma_f32_32x32x16_bf16 v[112:127], v[132:135], v[140:143], v[112:127]
    v_add_f32 v28, v28, v2
    v_add_f32 v29, v29, v3
    v_mfma_f32_32x32x16_bf16 v[64:79], v[144:147], v[152:155], v[64:79]
    ds_read_b64_tr_b16 v[48:49], v210 offset:0
    ds_read_b64_tr_b16 v[50:51], v210 offset:512
    ds_read_b128 v[56:59], v217 offset:0
    s_add_u32 s75, s82, 27648
    buffer_load_dwordx4 v23, s[40:43], s75 offen offset:3072 lds
    v_lshlrev_b32 v2, 16, v134
    v_and_b32 v3, 0xffff0000, v134
    v_cmp_gt_u32 vcc, 21, v251
    s_nop 1
    v_mfma_f32_32x32x16_bf16 v[80:95], v[144:147], v[156:159], v[80:95]
    ds_read_b64_tr_b16 v[52:53], v211 offset:0
    ds_read_b64_tr_b16 v[54:55], v211 offset:512
    ds_read_b128 v[60:63], v217 offset:4096
    s_add_u32 m0, s80, 32768
    s_add_u32 s75, s99, 0
    buffer_load_dwordx4 v24, s[52:55], s75 offen offset:0 lds
    v_add_f32 v28, v28, v2
    v_add_f32 v29, v29, v3
    v_cndmask_b32 v0, v4, v5, vcc
    s_lshl_b32 s72, s3, 2
    v_mfma_f32_32x32x16_bf16 v[96:111], v[148:151], v[152:155], v[96:111]
    s_add_u32 s75, s99, 23552
    buffer_load_dwordx4 v24, s[52:55], s75 offen offset:1024 lds
    v_lshlrev_b32 v2, 16, v135
    v_and_b32 v3, 0xffff0000, v135
    s_add_u32 s72, s72, 155648
    v_mfma_f32_32x32x16_bf16 v[112:127], v[148:151], v[156:159], v[112:127]
    v_add_f32 v28, v28, v2
    v_add_f32 v29, v29, v3
    s_waitcnt lgkmcnt(6)
    v_mfma_f32_32x32x16_bf16 v[64:79], v[32:35], v[40:43], v[64:79]
    ds_read_b64_tr_b16 v[128:129], v212 offset:0
    ds_read_b64_tr_b16 v[130:131], v212 offset:512
    ds_read_b128 v[136:139], v218 offset:0
    s_add_u32 m0, s81, 4096
    s_add_u32 s75, s82, 40960
    buffer_load_dwordx4 v22, s[40:43], s75 offen offset:0 lds
    v_lshlrev_b32 v2, 16, v32
    v_and_b32 v3, 0xffff0000, v32
    v_mov_b32 v248, s72
    v_mov_b32 v243, 0
    v_mfma_f32_32x32x16_bf16 v[80:95], v[32:35], v[44:47], v[80:95]
    ds_read_b64_tr_b16 v[132:133], v213 offset:0
    ds_read_b64_tr_b16 v[134:135], v213 offset:512
    ds_read_b128 v[140:143], v218 offset:4096
    s_add_u32 s75, s82, 50176
    buffer_load_dwordx4 v23, s[40:43], s75 offen offset:1024 lds
    v_add_f32 v26, v26, v2
    v_add_f32 v27, v27, v3
    v_mov_b32 v244, 0
    v_mov_b32 v245, 0
    v_mfma_f32_32x32x16_bf16 v[96:111], v[36:39], v[40:43], v[96:111]
    s_add_u32 s75, s82, 59392
    buffer_load_dwordx4 v22, s[40:43], s75 offen offset:2048 lds
    v_lshlrev_b32 v2, 16, v33
    v_and_b32 v3, 0xffff0000, v33
    v_mov_b32 v246, 0
    v_mfma_f32_32x32x16_bf16 v[112:127], v[36:39], v[44:47], v[112:127]
    v_add_f32 v26, v26, v2
    v_add_f32 v27, v27, v3
    s_waitcnt lgkmcnt(6)
    v_mfma_f32_32x32x16_bf16 v[64:79], v[48:51], v[56:59], v[64:79]
    ds_read_b64_tr_b16 v[144:145], v214 offset:0
    ds_read_b64_tr_b16 v[146:147], v214 offset:512
    ds_read_b128 v[152:155], v219 offset:0
    s_add_u32 s75, s82, 68608
    buffer_load_dwordx4 v23, s[40:43], s75 offen offset:3072 lds
    v_lshlrev_b32 v2, 16, v34
    v_and_b32 v3, 0xffff0000, v34
    v_mov_b32 v247, 0
    v_mfma_f32_32x32x16_bf16 v[80:95], v[48:51], v[60:63], v[80:95]
    ds_read_b64_tr_b16 v[148:149], v215 offset:0
    ds_read_b64_tr_b16 v[150:151], v215 offset:512
    ds_read_b128 v[156:159], v219 offset:4096
    s_add_u32 m0, s80, 41024
    s_add_u32 s75, s99, 0
    buffer_load_dwordx4 v24, s[56:59], s75 offen offset:0 lds
    v_add_f32 v26, v26, v2
    v_add_f32 v27, v27, v3
    s_mul_i32 s72, s70, 320
    v_mfma_f32_32x32x16_bf16 v[96:111], v[52:55], v[56:59], v[96:111]
    s_add_u32 s75, s99, 23552
    buffer_load_dwordx4 v24, s[56:59], s75 offen offset:1024 lds
    s_add_u32 s82, s82, 128
    s_add_u32 s99, s99, 196608
    s_cmp_eq_u32 s82, 1280
    s_cselect_b32 s82, 0, s82
    s_cselect_b32 s99, 0, s99
    v_lshlrev_b32 v2, 16, v35
    v_and_b32 v3, 0xffff0000, v35
    v_mfma_f32_32x32x16_bf16 v[112:127], v[52:55], v[60:63], v[112:127]
    v_add_f32 v26, v26, v2
    v_add_f32 v27, v27, v3
    s_waitcnt lgkmcnt(0)
    s_waitcnt vmcnt(12)
    s_barrier
    v_mfma_f32_32x32x16_bf16 v[64:79], v[128:131], v[136:139], v[64:79]
    ds_read_b64_tr_b16 v[32:33], v220 offset:0
    ds_read_b64_tr_b16 v[34:35], v220 offset:512
    ds_read_b128 v[40:43], v228 offset:0
    s_add_u32 m0, s81, 49408
    s_add_u32 s75, s82, 0
    buffer_load_dwordx4 v22, s[40:43], s75 offen offset:0 lds
    v_lshlrev_b32 v2, 16, v132
    v_and_b32 v3, 0xffff0000, v132
    v_add_u32 v6, 0, v250
    v_mul_u32_u24 v4, 3277, v6
    v_mfma_f32_32x32x16_bf16 v[80:95], v[128:131], v[140:143], v[80:95]
    ds_read_b64_tr_b16 v[36:37], v221 offset:0
    ds_read_b64_tr_b16 v[38:39], v221 offset:512
    ds_read_b128 v[44:47], v228 offset:4096
    s_add_u32 s75, s82, 9216
    buffer_load_dwordx4 v23, s[40:43], s75 offen offset:1024 lds
    v_add_f32 v28, v28, v2
    v_add_f32 v29, v29, v3
    v_lshrrev_b32 v4, 16, v4
    v_mul_u32_u24 v5, 20, v4
    v_mfma_f32_32x32x16_bf16 v[96:111], v[132:135], v[136:139], v[96:111]
    s_add_u32 s75, s82, 18432
    buffer_load_dwordx4 v22, s[40:43], s75 offen offset:2048 lds
    v_lshlrev_b32 v2, 16, v133
    v_and_b32 v3, 0xffff0000, v133
    v_sub_u32 v5, v6, v5
    v_mfma_f32_32x32x16_bf16 v[112:127], v[132:135], v[140:143], v[112:127]
    v_add_f32 v28, v28, v2
    v_add_f32 v29, v29, v3
    v_mfma_f32_32x32x16_bf16 v[64:79], v[144:147], v[152:155], v[64:79]
    ds_read_b64_tr_b16 v[48:49], v222 offset:0
    ds_read_b64_tr_b16 v[50:51], v222 offset:512
    ds_read_b128 v[56:59], v229 offset:0
    s_add_u32 s75, s82, 27648
    buffer_load_dwordx4 v23, s[40:43], s75 offen offset:3072 lds
    v_lshlrev_b32 v2, 16, v134
    v_and_b32 v3, 0xffff0000, v134
    v_mul_u32_u24 v4, 1280, v4
    v_lshl_add_u32 v4, v5, 4, v4
    v_mfma_f32_32x32x16_bf16 v[80:95], v[144:147], v[156:159], v[80:95]
    ds_read_b64_tr_b16 v[52:53], v223 offset:0
    ds_read_b64_tr_b16 v[54:55], v223 offset:512
    ds_read_b128 v[60:63], v229 offset:4096
    s_add_u32 m0, s80, 82176
    s_add_u32 s75, s99, 0
    buffer_load_dwordx4 v24, s[52:55], s75 offen offset:0 lds
    v_add_f32 v28, v28, v2
    v_add_f32 v29, v29, v3
    v_add_u32 v168, s72, v4
    v_add_u32 v6, 64, v250
    v_mfma_f32_32x32x16_bf16 v[96:111], v[148:151], v[152:155], v[96:111]
    s_add_u32 s75, s99, 23552
    buffer_load_dwordx4 v24, s[52:55], s75 offen offset:1024 lds
    v_lshlrev_b32 v2, 16, v135
    v_and_b32 v3, 0xffff0000, v135
    v_mul_u32_u24 v4, 3277, v6
    v_mfma_f32_32x32x16_bf16 v[112:127], v[148:151], v[156:159], v[112:127]
    v_add_f32 v28, v28, v2
    v_add_f32 v29, v29, v3
    s_waitcnt lgkmcnt(6)
    v_mfma_f32_32x32x16_bf16 v[64:79], v[32:35], v[40:43], v[64:79]
    ds_read_b64_tr_b16 v[128:129], v224 offset:0
    ds_read_b64_tr_b16 v[130:131], v224 offset:512
    ds_read_b128 v[136:139], v230 offset:0
    s_add_u32 m0, s81, 53504
    s_add_u32 s75, s82, 40960
    buffer_load_dwordx4 v22, s[40:43], s75 offen offset:0 lds
    v_lshlrev_b32 v2, 16, v32
    v_and_b32 v3, 0xffff0000, v32
    v_lshrrev_b32 v4, 16, v4
    v_mul_u32_u24 v5, 20, v4
    v_mfma_f32_32x32x16_bf16 v[80:95], v[32:35], v[44:47], v[80:95]
    ds_read_b64_tr_b16 v[132:133], v225 offset:0
    ds_read_b64_tr_b16 v[134:135], v225 offset:512
    ds_read_b128 v[140:143], v230 offset:4096
    s_add_u32 s75, s82, 50176
    buffer_load_dwordx4 v23, s[40:43], s75 offen offset:1024 lds
    v_add_f32 v26, v26, v2
    v_add_f32 v27, v27, v3
    v_sub_u32 v5, v6, v5
    v_mul_u32_u24 v4, 1280, v4
    v_mfma_f32_32x32x16_bf16 v[96:111], v[36:39], v[40:43], v[96:111]
    s_add_u32 s75, s82, 59392
    buffer_load_dwordx4 v22, s[40:43], s75 offen offset:2048 lds
    v_lshlrev_b32 v2, 16, v33
    v_and_b32 v3, 0xffff0000, v33
    v_lshl_add_u32 v4, v5, 4, v4
    v_mfma_f32_32x32x16_bf16 v[112:127], v[36:39], v[44:47], v[112:127]
    v_add_f32 v26, v26, v2
    v_add_f32 v27, v27, v3
    s_waitcnt lgkmcnt(6)
    v_mfma_f32_32x32x16_bf16 v[64:79], v[48:51], v[56:59], v[64:79]
    ds_read_b64_tr_b16 v[144:145], v226 offset:0
    ds_read_b64_tr_b16 v[146:147], v226 offset:512
    ds_read_b128 v[152:155], v231 offset:0
    s_add_u32 s75, s82, 68608
    buffer_load_dwordx4 v23, s[40:43], s75 offen offset:3072 lds
    v_lshlrev_b32 v2, 16, v34
    v_and_b32 v3, 0xffff0000, v34
    v_add_u32 v169, s72, v4
    v_mfma_f32_32x32x16_bf16 v[80:95], v[48:51], v[60:63], v[80:95]
    ds_read_b64_tr_b16 v[148:149], v227 offset:0
    ds_read_b64_tr_b16 v[150:151], v227 offset:512
    ds_read_b128 v[156:159], v231 offset:4096
    s_add_u32 m0, s80, 90432
    s_add_u32 s75, s99, 0
    buffer_load_dwordx4 v24, s[56:59], s75 offen offset:0 lds
    v_add_f32 v26, v26, v2
    v_add_f32 v27, v27, v3
    v_subrev_u32 v169, 1024, v169
    v_mfma_f32_32x32x16_bf16 v[96:111], v[52:55], v[56:59], v[96:111]
    s_add_u32 s75, s99, 23552
    buffer_load_dwordx4 v24, s[56:59], s75 offen offset:1024 lds
    s_add_u32 s82, s82, 128
    s_add_u32 s99, s99, 196608
    s_cmp_eq_u32 s82, 1280
    s_cselect_b32 s82, 0, s82
    s_cselect_b32 s99, 0, s99
    v_lshlrev_b32 v2, 16, v35
    v_and_b32 v3, 0xffff0000, v35
    v_mfma_f32_32x32x16_bf16 v[112:127], v[52:55], v[60:63], v[112:127]
    v_add_f32 v26, v26, v2
    v_add_f32 v27, v27, v3
    s_waitcnt lgkmcnt(0)
    s_waitcnt vmcnt(12)
    s_barrier
    v_mfma_f32_32x32x16_bf16 v[64:79], v[128:131], v[136:139], v[64:79]
    ds_read_b64_tr_b16 v[32:33], v10 offset:0
    ds_read_b64_tr_b16 v[34:35], v10 offset:512
    ds_read_b128 v[40:43], v18 offset:0
    s_add_u32 m0, s81, 98816
    s_add_u32 s75, s82, 0
    buffer_load_dwordx4 v22, s[40:43], s75 offen offset:0 lds
    v_lshlrev_b32 v2, 16, v132
    v_and_b32 v3, 0xffff0000, v132
    v_add_u32 v6, 128, v250
    v_mul_u32_u24 v4, 3277, v6
    v_mfma_f32_32x32x16_bf16 v[80:95], v[128:131], v[140:143], v[80:95]
    ds_read_b64_tr_b16 v[36:37], v11 offset:0
    ds_read_b64_tr_b16 v[38:39], v11 offset:512
    ds_read_b128 v[44:47], v18 offset:4096
    s_add_u32 s75, s82, 9216
    buffer_load_dwordx4 v23, s[40:43], s75 offen offset:1024 lds
    v_add_f32 v28, v28, v2
    v_add_f32 v29, v29, v3
    v_lshrrev_b32 v4, 16, v4
    v_mul_u32_u24 v5, 20, v4
    v_mfma_f32_32x32x16_bf16 v[96:111], v[132:135], v[136:139], v[96:111]
    s_add_u32 s75, s82, 18432
    buffer_load_dwordx4 v22, s[40:43], s75 offen offset:2048 lds
    v_lshlrev_b32 v2, 16, v133
    v_and_b32 v3, 0xffff0000, v133
    v_sub_u32 v5, v6, v5
    v_mfma_f32_32x32x16_bf16 v[112:127], v[132:135], v[140:143], v[112:127]
    v_add_f32 v28, v28, v2
    v_add_f32 v29, v29, v3
    v_mfma_f32_32x32x16_bf16 v[64:79], v[144:147], v[152:155], v[64:79]
    ds_read_b64_tr_b16 v[48:49], v12 offset:0
    ds_read_b64_tr_b16 v[50:51], v12 offset:512
    ds_read_b128 v[56:59], v19 offset:0
    s_add_u32 s75, s82, 27648
    buffer_load_dwordx4 v23, s[40:43], s75 offen offset:3072 lds
    v_lshlrev_b32 v2, 16, v134
    v_and_b32 v3, 0xffff0000, v134
    v_mul_u32_u24 v4, 1280, v4
    v_lshl_add_u32 v4, v5, 4, v4
    v_mfma_f32_32x32x16_bf16 v[80:95], v[144:147], v[156:159], v[80:95]
    ds_read_b64_tr_b16 v[52:53], v13 offset:0
    ds_read_b64_tr_b16 v[54:55], v13 offset:512
    ds_read_b128 v[60:63], v19 offset:4096
    s_add_u32 m0, s80, 131584
    s_add_u32 s75, s99, 0
    buffer_load_dwordx4 v24, s[52:55], s75 offen offset:0 lds
    v_add_f32 v28, v28, v2
    v_add_f32 v29, v29, v3
    v_add_u32 v170, s72, v4
    v_subrev_u32 v170, 2048, v170
    v_mfma_f32_32x32x16_bf16 v[96:111], v[148:151], v[152:155], v[96:111]
    s_add_u32 s75, s99, 23552
    buffer_load_dwordx4 v24, s[52:55], s75 offen offset:1024 lds
    v_lshlrev_b32 v2, 16, v135
    v_and_b32 v3, 0xffff0000, v135
    v_add_u32 v6, 192, v250
    v_mfma_f32_32x32x16_bf16 v[112:127], v[148:151], v[156:159], v[112:127]
    v_add_f32 v28, v28, v2
    v_add_f32 v29, v29, v3
    s_waitcnt lgkmcnt(6)
    v_mfma_f32_32x32x16_bf16 v[64:79], v[32:35], v[40:43], v[64:79]
    ds_read_b64_tr_b16 v[128:129], v14 offset:0
    ds_read_b64_tr_b16 v[130:131], v14 offset:512
    ds_read_b128 v[136:139], v20 offset:0
    s_add_u32 m0, s81, 102912
    s_add_u32 s75, s82, 40960
    buffer_load_dwordx4 v22, s[40:43], s75 offen offset:0 lds
    v_lshlrev_b32 v2, 16, v32
    v_and_b32 v3, 0xffff0000, v32
    v_mul_u32_u24 v4, 3277, v6
    v_lshrrev_b32 v4, 16, v4
    v_mfma_f32_32x32x16_bf16 v[80:95], v[32:35], v[44:47], v[80:95]
    ds_read_b64_tr_b16 v[132:133], v15 offset:0
    ds_read_b64_tr_b16 v[134:135], v15 offset:512
    ds_read_b128 v[140:143], v20 offset:4096
    s_add_u32 s75, s82, 50176
    buffer_load_dwordx4 v23, s[40:43], s75 offen offset:1024 lds
    v_add_f32 v26, v26, v2
    v_add_f32 v27, v27, v3
    v_mul_u32_u24 v5, 20, v4
    v_sub_u32 v5, v6, v5
    v_mfma_f32_32x32x16_bf16 v[96:111], v[36:39], v[40:43], v[96:111]
    s_add_u32 s75, s82, 59392
    buffer_load_dwordx4 v22, s[40:43], s75 offen offset:2048 lds
    v_lshlrev_b32 v2, 16, v33
    v_and_b32 v3, 0xffff0000, v33
    v_mul_u32_u24 v4, 1280, v4
    v_mfma_f32_32x32x16_bf16 v[112:127], v[36:39], v[44:47], v[112:127]
    v_add_f32 v26, v26, v2
    v_add_f32 v27, v27, v3
    s_waitcnt lgkmcnt(6)
    v_mfma_f32_32x32x16_bf16 v[64:79], v[48:51], v[56:59], v[64:79]
    ds_read_b64_tr_b16 v[144:145], v16 offset:0
    ds_read_b64_tr_b16 v[146:147], v16 offset:512
    ds_read_b128 v[152:155], v21 offset:0
    s_add_u32 s75, s82, 68608
    buffer_load_dwordx4 v23, s[40:43], s75 offen offset:3072 lds
    v_lshlrev_b32 v2, 16, v34
    v_and_b32 v3, 0xffff0000, v34
    v_lshl_add_u32 v4, v5, 4, v4
    v_mfma_f32_32x32x16_bf16 v[80:95], v[48:51], v[60:63], v[80:95]
    ds_read_b64_tr_b16 v[148:149], v17 offset:0
    ds_read_b64_tr_b16 v[150:151], v17 offset:512
    ds_read_b128 v[156:159], v21 offset:4096
    s_add_u32 m0, s80, 139840
    s_add_u32 s75, s99, 0
    buffer_load_dwordx4 v24, s[56:59], s75 offen offset:0 lds
    v_add_f32 v26, v26, v2
    v_add_f32 v27, v27, v3
    v_add_u32 v171, s72, v4
    v_mfma_f32_32x32x16_bf16 v[96:111], v[52:55], v[56:59], v[96:111]
    s_add_u32 s75, s99, 23552
    buffer_load_dwordx4 v24, s[56:59], s75 offen offset:1024 lds
    s_add_u32 s82, s82, 128
    s_add_u32 s99, s99, 196608
    s_cmp_eq_u32 s82, 1280
    s_cselect_b32 s82, 0, s82
    s_cselect_b32 s99, 0, s99
    v_lshlrev_b32 v2, 16, v35
    v_and_b32 v3, 0xffff0000, v35
    v_mfma_f32_32x32x16_bf16 v[112:127], v[52:55], v[60:63], v[112:127]
    v_add_f32 v26, v26, v2
    v_add_f32 v27, v27, v3
    s_waitcnt lgkmcnt(0)
    s_waitcnt vmcnt(12)
    s_barrier
    v_mfma_f32_32x32x16_bf16 v[64:79], v[128:131], v[136:139], v[64:79]
    ds_read_b64_tr_b16 v[32:33], v208 offset:0
    ds_read_b64_tr_b16 v[34:35], v208 offset:512
    ds_read_b128 v[40:43], v216 offset:0
    s_add_u32 m0, s81, 0
    s_add_u32 s75, s82, 0
    buffer_load_dwordx4 v22, s[40:43], s75 offen offset:0 lds
    v_lshlrev_b32 v2, 16, v132
    v_and_b32 v3, 0xffff0000, v132
    v_subrev_u32 v171, 3072, v171
    v_add_u32 v6, 256, v250
    v_mfma_f32_32x32x16_bf16 v[80:95], v[128:131], v[140:143], v[80:95]
    ds_read_b64_tr_b16 v[36:37], v209 offset:0
    ds_read_b64_tr_b16 v[38:39], v209 offset:512
    ds_read_b128 v[44:47], v216 offset:4096
    s_add_u32 s75, s82, 9216
    buffer_load_dwordx4 v23, s[40:43], s75 offen offset:1024 lds
    v_add_f32 v28, v28, v2
    v_add_f32 v29, v29, v3
    v_mul_u32_u24 v4, 3277, v6
    v_lshrrev_b32 v4, 16, v4
    v_mfma_f32_32x32x16_bf16 v[96:111], v[132:135], v[136:139], v[96:111]
    s_add_u32 s75, s82, 18432
    buffer_load_dwordx4 v22, s[40:43], s75 offen offset:2048 lds
    v_lshlrev_b32 v2, 16, v133
    v_and_b32 v3, 0xffff0000, v133
    v_mul_u32_u24 v5, 20, v4
    v_mfma_f32_32x32x16_bf16 v[112:127], v[132:135], v[140:143], v[112:127]
    v_add_f32 v28, v28, v2
    v_add_f32 v29, v29, v3
    v_mfma_f32_32x32x16_bf16 v[64:79], v[144:147], v[152:155], v[64:79]
    ds_read_b64_tr_b16 v[48:49], v210 offset:0
    ds_read_b64_tr_b16 v[50:51], v210 offset:512
    ds_read_b128 v[56:59], v217 offset:0
    s_add_u32 s75, s82, 27648
    buffer_load_dwordx4 v23, s[40:43], s75 offen offset:3072 lds
    v_lshlrev_b32 v2, 16, v134
    v_and_b32 v3, 0xffff0000, v134
    v_sub_u32 v5, v6, v5
    v_mul_u32_u24 v4, 1280, v4
    v_mfma_f32_32x32x16_bf16 v[80:95], v[144:147], v[156:159], v[80:95]
    ds_read_b64_tr_b16 v[52:53], v211 offset:0
    ds_read_b64_tr_b16 v[54:55], v211 offset:512
    ds_read_b128 v[60:63], v217 offset:4096
    s_add_u32 m0, s80, 32768
    s_add_u32 s75, s99, 0
    buffer_load_dwordx4 v24, s[52:55], s75 offen offset:0 lds
    v_add_f32 v28, v28, v2
    v_add_f32 v29, v29, v3
    v_lshl_add_u32 v4, v5, 4, v4
    v_add_u32 v172, s72, v4
    v_mfma_f32_32x32x16_bf16 v[96:111], v[148:151], v[152:155], v[96:111]
    s_add_u32 s75, s99, 23552
    buffer_load_dwordx4 v24, s[52:55], s75 offen offset:1024 lds
    v_lshlrev_b32 v2, 16, v135
    v_and_b32 v3, 0xffff0000, v135
    s_mul_i32 s72, s67, 30720
    v_mfma_f32_32x32x16_bf16 v[112:127], v[148:151], v[156:159], v[112:127]
    v_add_f32 v28, v28, v2
    v_add_f32 v29, v29, v3
    s_waitcnt lgkmcnt(6)
    v_mfma_f32_32x32x16_bf16 v[64:79], v[32:35], v[40:43], v[64:79]
    ds_read_b64_tr_b16 v[128:129], v212 offset:0
    ds_read_b64_tr_b16 v[130:131], v212 offset:512
    ds_read_b128 v[136:139], v218 offset:0
    s_add_u32 m0, s81, 4096
    s_add_u32 s75, s82, 40960
    buffer_load_dwordx4 v22, s[40:43], s75 offen offset:0 lds
    v_lshlrev_b32 v2, 16, v32
    v_and_b32 v3, 0xffff0000, v32
    v_bfe_u32 v6, v250, 2, 2
    v_bfe_u32 v4, v250, 4, 1
    v_mfma_f32_32x32x16_bf16 v[80:95], v[32:35], v[44:47], v[80:95]
    ds_read_b64_tr_b16 v[132:133], v213 offset:0
    ds_read_b64_tr_b16 v[134:135], v213 offset:512
    ds_read_b128 v[140:143], v218 offset:4096
    s_add_u32 s75, s82, 50176
    buffer_load_dwordx4 v23, s[40:43], s75 offen offset:1024 lds
    v_add_f32 v26, v26, v2
    v_add_f32 v27, v27, v3
    v_and_b32 v5, 3, v250
    v_lshl_add_u32 v4, v4, 2, v5
    v_mfma_f32_32x32x16_bf16 v[96:111], v[36:39], v[40:43], v[96:111]
    s_add_u32 s75, s82, 59392
    buffer_load_dwordx4 v22, s[40:43], s75 offen offset:2048 lds
    v_lshlrev_b32 v2, 16, v33
    v_and_b32 v3, 0xffff0000, v33
    s_lshl_b32 s73, s67, 1
    v_mfma_f32_32x32x16_bf16 v[112:127], v[36:39], v[44:47], v[112:127]
    v_add_f32 v26, v26, v2
    v_add_f32 v27, v27, v3
    s_waitcnt lgkmcnt(6)
    v_mfma_f32_32x32x16_bf16 v[64:79], v[48:51], v[56:59], v[64:79]
    ds_read_b64_tr_b16 v[144:145], v214 offset:0
    ds_read_b64_tr_b16 v[146:147], v214 offset:512
    ds_read_b128 v[152:155], v219 offset:0
    s_add_u32 s75, s82, 68608
    buffer_load_dwordx4 v23, s[40:43], s75 offen offset:3072 lds
    v_lshlrev_b32 v2, 16, v34
    v_and_b32 v3, 0xffff0000, v34
    v_xor_b32 v4, s73, v4
    v_mfma_f32_32x32x16_bf16 v[80:95], v[48:51], v[60:63], v[80:95]
    ds_read_b64_tr_b16 v[148:149], v215 offset:0
    ds_read_b64_tr_b16 v[150:151], v215 offset:512
    ds_read_b128 v[156:159], v219 offset:4096
    s_add_u32 m0, s80, 41024
    s_add_u32 s75, s99, 0
    buffer_load_dwordx4 v24, s[56:59], s75 offen offset:0 lds
    v_add_f32 v26, v26, v2
    v_add_f32 v27, v27, v3
    v_lshl_add_u32 v4, v4, 3, s72
    v_mfma_f32_32x32x16_bf16 v[96:111], v[52:55], v[56:59], v[96:111]
    s_add_u32 s75, s99, 23552
    buffer_load_dwordx4 v24, s[56:59], s75 offen offset:1024 lds
    s_add_u32 s82, s82, 128
    s_add_u32 s99, s99, 196608
    s_cmp_eq_u32 s82, 1280
    s_cselect_b32 s82, 0, s82
    s_cselect_b32 s99, 0, s99
    v_lshlrev_b32 v2, 16, v35
    v_and_b32 v3, 0xffff0000, v35
    v_mfma_f32_32x32x16_bf16 v[112:127], v[52:55], v[60:63], v[112:127]
    v_add_f32 v26, v26, v2
    v_add_f32 v27, v27, v3
    s_waitcnt lgkmcnt(0)
    s_waitcnt vmcnt(12)
    s_barrier
    v_mfma_f32_32x32x16_bf16 v[64:79], v[128:131], v[136:139], v[64:79]
    ds_read_b64_tr_b16 v[32:33], v220 offset:0
    ds_read_b64_tr_b16 v[34:35], v220 offset:512
    ds_read_b128 v[40:43], v228 offset:0
    s_add_u32 m0, s81, 49408
    s_add_u32 s75, s82, 0
    buffer_load_dwordx4 v22, s[40:43], s75 offen offset:0 lds
    v_lshlrev_b32 v2, 16, v132
    v_and_b32 v3, 0xffff0000, v132
    v_lshl_add_u32 v5, v252, 2, v6
    v_mfma_f32_32x32x16_bf16 v[80:95], v[128:131], v[140:143], v[80:95]
    ds_read_b64_tr_b16 v[36:37], v221 offset:0
    ds_read_b64_tr_b16 v[38:39], v221 offset:512
    ds_read_b128 v[44:47], v228 offset:4096
    s_add_u32 s75, s82, 9216
    buffer_load_dwordx4 v23, s[40:43], s75 offen offset:1024 lds
    v_add_f32 v28, v28, v2
    v_add_f32 v29, v29, v3
    v_mul_u32_u24 v5, 320, v5
    v_mfma_f32_32x32x16_bf16 v[96:111], v[132:135], v[136:139], v[96:111]
    s_add_u32 s75, s82, 18432
    buffer_load_dwordx4 v22, s[40:43], s75 offen offset:2048 lds
    v_lshlrev_b32 v2, 16, v133
    v_and_b32 v3, 0xffff0000, v133
    v_add_u32 v173, v4, v5
    v_mfma_f32_32x32x16_bf16 v[112:127], v[132:135], v[140:143], v[112:127]
    v_add_f32 v28, v28, v2
    v_add_f32 v29, v29, v3
    v_lshl_add_u32 v5, v252, 3, v6
    v_mfma_f32_32x32x16_bf16 v[64:79], v[144:147], v[152:155], v[64:79]
    ds_read_b64_tr_b16 v[48:49], v222 offset:0
    ds_read_b64_tr_b16 v[50:51], v222 offset:512
    ds_read_b128 v[56:59], v229 offset:0
    s_add_u32 s75, s82, 27648
    buffer_load_dwordx4 v23, s[40:43], s75 offen offset:3072 lds
    v_lshlrev_b32 v2, 16, v134
    v_and_b32 v3, 0xffff0000, v134
    v_mul_u32_u24 v5, 320, v5
    v_mfma_f32_32x32x16_bf16 v[80:95], v[144:147], v[156:159], v[80:95]
    ds_read_b64_tr_b16 v[52:53], v223 offset:0
    ds_read_b64_tr_b16 v[54:55], v223 offset:512
    ds_read_b128 v[60:63], v229 offset:4096
    s_add_u32 m0, s80, 82176
    s_add_u32 s75, s99, 0
    buffer_load_dwordx4 v24, s[52:55], s75 offen offset:0 lds
    v_add_f32 v28, v28, v2
    v_add_f32 v29, v29, v3
    v_add_u32 v174, v4, v5
    v_mfma_f32_32x32x16_bf16 v[96:111], v[148:151], v[152:155], v[96:111]
    s_add_u32 s75, s99, 23552
    buffer_load_dwordx4 v24, s[52:55], s75 offen offset:1024 lds
    v_lshlrev_b32 v2, 16, v135
    v_and_b32 v3, 0xffff0000, v135
    v_add_u32 v178, s72, v253
    v_mfma_f32_32x32x16_bf16 v[112:127], v[148:151], v[156:159], v[112:127]
    v_add_f32 v28, v28, v2
    v_add_f32 v29, v29, v3
    s_xor_b32 s73, s67, 1
    s_waitcnt lgkmcnt(6)
    v_mfma_f32_32x32x16_bf16 v[64:79], v[32:35], v[40:43], v[64:79]
    ds_read_b64_tr_b16 v[128:129], v224 offset:0
    ds_read_b64_tr_b16 v[130:131], v224 offset:512
    ds_read_b128 v[136:139], v230 offset:0
    s_add_u32 m0, s81, 53504
    s_add_u32 s75, s82, 40960
    buffer_load_dwordx4 v22, s[40:43], s75 offen offset:0 lds
    v_lshlrev_b32 v2, 16, v32
    v_and_b32 v3, 0xffff0000, v32
    s_mul_i32 s73, s73, 30720
    v_mfma_f32_32x32x16_bf16 v[80:95], v[32:35], v[44:47], v[80:95]
    ds_read_b64_tr_b16 v[132:133], v225 offset:0
    ds_read_b64_tr_b16 v[134:135], v225 offset:512
    ds_read_b128 v[140:143], v230 offset:4096
    s_add_u32 s75, s82, 50176
    buffer_load_dwordx4 v23, s[40:43], s75 offen offset:1024 lds
    v_add_f32 v26, v26, v2
    v_add_f32 v27, v27, v3
    v_add_u32 v175, s73, v253
    v_mfma_f32_32x32x16_bf16 v[96:111], v[36:39], v[40:43], v[96:111]
    s_add_u32 s75, s82, 59392
    buffer_load_dwordx4 v22, s[40:43], s75 offen offset:2048 lds
    v_lshlrev_b32 v2, 16, v33
    v_and_b32 v3, 0xffff0000, v33
    s_xor_b32 s73, s67, 2
    v_mfma_f32_32x32x16_bf16 v[112:127], v[36:39], v[44:47], v[112:127]
    v_add_f32 v26, v26, v2
    v_add_f32 v27, v27, v3
    s_mul_i32 s73, s73, 30720
    s_waitcnt lgkmcnt(6)
    v_mfma_f32_32x32x16_bf16 v[64:79], v[48:51], v[56:59], v[64:79]
    ds_read_b64_tr_b16 v[144:145], v226 offset:0
    ds_read_b64_tr_b16 v[146:147], v226 offset:512
    ds_read_b128 v[152:155], v231 offset:0
    s_add_u32 s75, s82, 68608
    buffer_load_dwordx4 v23, s[40:43], s75 offen offset:3072 lds
    v_lshlrev_b32 v2, 16, v34
    v_and_b32 v3, 0xffff0000, v34
    v_add_u32 v176, s73, v253
    v_mfma_f32_32x32x16_bf16 v[80:95], v[48:51], v[60:63], v[80:95]
    ds_read_b64_tr_b16 v[148:149], v227 offset:0
    ds_read_b64_tr_b16 v[150:151], v227 offset:512
    ds_read_b128 v[156:159], v231 offset:4096
    s_add_u32 m0, s80, 90432
    s_add_u32 s75, s99, 0
    buffer_load_dwordx4 v24, s[56:59], s75 offen offset:0 lds
    v_add_f32 v26, v26, v2
    v_add_f32 v27, v27, v3
    s_xor_b32 s73, s67, 3
    v_mfma_f32_32x32x16_bf16 v[96:111], v[52:55], v[56:59], v[96:111]
    s_add_u32 s75, s99, 23552
    buffer_load_dwordx4 v24, s[56:59], s75 offen offset:1024 lds
    s_add_u32 s82, s82, 128
    s_add_u32 s99, s99, 196608
    s_cmp_eq_u32 s82, 1280
    s_cselect_b32 s82, 0, s82
    s_cselect_b32 s99, 0, s99
    v_lshlrev_b32 v2, 16, v35
    v_and_b32 v3, 0xffff0000, v35
    s_mul_i32 s73, s73, 30720
    v_mfma_f32_32x32x16_bf16 v[112:127], v[52:55], v[60:63], v[112:127]
    v_add_f32 v26, v26, v2
    v_add_f32 v27, v27, v3
    v_add_u32 v179, s73, v253
    s_waitcnt lgkmcnt(0)
    s_waitcnt vmcnt(12)
    s_barrier
    v_mfma_f32_32x32x16_bf16 v[64:79], v[128:131], v[136:139], v[64:79]
    ds_read_b64_tr_b16 v[32:33], v10 offset:0
    ds_read_b64_tr_b16 v[34:35], v10 offset:512
    ds_read_b128 v[40:43], v18 offset:0
    s_add_u32 m0, s81, 98816
    s_add_u32 s75, s82, 0
    buffer_load_dwordx4 v22, s[40:43], s75 offen offset:0 lds
    v_lshlrev_b32 v2, 16, v132
    v_and_b32 v3, 0xffff0000, v132
    v_mfma_f32_32x32x16_bf16 v[80:95], v[128:131], v[140:143], v[80:95]
    ds_read_b64_tr_b16 v[36:37], v11 offset:0
    ds_read_b64_tr_b16 v[38:39], v11 offset:512
    ds_read_b128 v[44:47], v18 offset:4096
    s_add_u32 s75, s82, 9216
    buffer_load_dwordx4 v23, s[40:43], s75 offen offset:1024 lds
    v_add_f32 v28, v28, v2
    v_add_f32 v29, v29, v3
    v_mfma_f32_32x32x16_bf16 v[96:111], v[132:135], v[136:139], v[96:111]
    s_add_u32 s75, s82, 18432
    buffer_load_dwordx4 v22, s[40:43], s75 offen offset:2048 lds
    v_lshlrev_b32 v2, 16, v133
    v_and_b32 v3, 0xffff0000, v133
    v_mfma_f32_32x32x16_bf16 v[112:127], v[132:135], v[140:143], v[112:127]
    v_add_f32 v28, v28, v2
    v_add_f32 v29, v29, v3
    v_mfma_f32_32x32x16_bf16 v[64:79], v[144:147], v[152:155], v[64:79]
    ds_read_b64_tr_b16 v[48:49], v12 offset:0
    ds_read_b64_tr_b16 v[50:51], v12 offset:512
    ds_read_b128 v[56:59], v19 offset:0
    s_add_u32 s75, s82, 27648
    buffer_load_dwordx4 v23, s[40:43], s75 offen offset:3072 lds
    v_lshlrev_b32 v2, 16, v134
    v_and_b32 v3, 0xffff0000, v134
    v_mfma_f32_32x32x16_bf16 v[80:95], v[144:147], v[156:159], v[80:95]
    ds_read_b64_tr_b16 v[52:53], v13 offset:0
    ds_read_b64_tr_b16 v[54:55], v13 offset:512
    ds_read_b128 v[60:63], v19 offset:4096
    s_add_u32 m0, s80, 131584
    s_add_u32 s75, s99, 0
    buffer_load_dwordx4 v24, s[52:55], s75 offen offset:0 lds
    v_add_f32 v28, v28, v2
    v_add_f32 v29, v29, v3
    v_mfma_f32_32x32x16_bf16 v[96:111], v[148:151], v[152:155], v[96:111]
    s_add_u32 s75, s99, 23552
    buffer_load_dwordx4 v24, s[52:55], s75 offen offset:1024 lds
    v_lshlrev_b32 v2, 16, v135
    v_and_b32 v3, 0xffff0000, v135
    v_mfma_f32_32x32x16_bf16 v[112:127], v[148:151], v[156:159], v[112:127]
    v_add_f32 v28, v28, v2
    v_add_f32 v29, v29, v3
    s_waitcnt lgkmcnt(6)
    v_mfma_f32_32x32x16_bf16 v[64:79], v[32:35], v[40:43], v[64:79]
    ds_read_b64_tr_b16 v[128:129], v14 offset:0
    ds_read_b64_tr_b16 v[130:131], v14 offset:512
    ds_read_b128 v[136:139], v20 offset:0
    s_add_u32 m0, s81, 102912
    s_add_u32 s75, s82, 40960
    buffer_load_dwordx4 v22, s[40:43], s75 offen offset:0 lds
    v_lshlrev_b32 v2, 16, v32
    v_and_b32 v3, 0xffff0000, v32
    v_mfma_f32_32x32x16_bf16 v[80:95], v[32:35], v[44:47], v[80:95]
    ds_read_b64_tr_b16 v[132:133], v15 offset:0
    ds_read_b64_tr_b16 v[134:135], v15 offset:512
    ds_read_b128 v[140:143], v20 offset:4096
    s_add_u32 s75, s82, 50176
    buffer_load_dwordx4 v23, s[40:43], s75 offen offset:1024 lds
    v_add_f32 v26, v26, v2
    v_add_f32 v27, v27, v3
    v_mfma_f32_32x32x16_bf16 v[96:111], v[36:39], v[40:43], v[96:111]
    s_add_u32 s75, s82, 59392
    buffer_load_dwordx4 v22, s[40:43], s75 offen offset:2048 lds
    v_lshlrev_b32 v2, 16, v33
    v_and_b32 v3, 0xffff0000, v33
    v_mfma_f32_32x32x16_bf16 v[112:127], v[36:39], v[44:47], v[112:127]
    v_add_f32 v26, v26, v2
    v_add_f32 v27, v27, v3
    s_waitcnt lgkmcnt(6)
    v_mfma_f32_32x32x16_bf16 v[64:79], v[48:51], v[56:59], v[64:79]
    ds_read_b64_tr_b16 v[144:145], v16 offset:0
    ds_read_b64_tr_b16 v[146:147], v16 offset:512
    ds_read_b128 v[152:155], v21 offset:0
    s_add_u32 s75, s82, 68608
    buffer_load_dwordx4 v23, s[40:43], s75 offen offset:3072 lds
    v_lshlrev_b32 v2, 16, v34
    v_and_b32 v3, 0xffff0000, v34
    v_mfma_f32_32x32x16_bf16 v[80:95], v[48:51], v[60:63], v[80:95]
    ds_read_b64_tr_b16 v[148:149], v17 offset:0
    ds_read_b64_tr_b16 v[150:151], v17 offset:512
    ds_read_b128 v[156:159], v21 offset:4096
    s_add_u32 m0, s80, 139840
    s_add_u32 s75, s99, 0
    buffer_load_dwordx4 v24, s[56:59], s75 offen offset:0 lds
    v_add_f32 v26, v26, v2
    v_add_f32 v27, v27, v3
    v_mfma_f32_32x32x16_bf16 v[96:111], v[52:55], v[56:59], v[96:111]
    s_add_u32 s75, s99, 23552
    buffer_load_dwordx4 v24, s[56:59], s75 offen offset:1024 lds
    s_add_u32 s82, s82, 128
    s_add_u32 s99, s99, 196608
    s_cmp_eq_u32 s82, 1280
    s_cselect_b32 s82, 0, s82
    s_cselect_b32 s99, 0, s99
    v_lshlrev_b32 v2, 16, v35
    v_and_b32 v3, 0xffff0000, v35
    v_mfma_f32_32x32x16_bf16 v[112:127], v[52:55], v[60:63], v[112:127]
    v_add_f32 v26, v26, v2
    v_add_f32 v27, v27, v3
    s_waitcnt lgkmcnt(0)
    s_waitcnt vmcnt(12)
    s_barrier
    v_mfma_f32_32x32x16_bf16 v[64:79], v[128:131], v[136:139], v[64:79]
    ds_read_b64_tr_b16 v[32:33], v208 offset:0
    ds_read_b64_tr_b16 v[34:35], v208 offset:512
    ds_read_b128 v[40:43], v216 offset:0
    s_add_u32 m0, s81, 0
    s_add_u32 s75, s82, 0
    buffer_load_dwordx4 v22, s[40:43], s75 offen offset:0 lds
    v_lshlrev_b32 v2, 16, v132
    v_and_b32 v3, 0xffff0000, v132
    v_mfma_f32_32x32x16_bf16 v[80:95], v[128:131], v[140:143], v[80:95]
    ds_read_b64_tr_b16 v[36:37], v209 offset:0
    ds_read_b64_tr_b16 v[38:39], v209 offset:512
    ds_read_b128 v[44:47], v216 offset:4096
    s_add_u32 s75, s82, 9216
    buffer_load_dwordx4 v23, s[40:43], s75 offen offset:1024 lds
    v_add_f32 v28, v28, v2
    v_add_f32 v29, v29, v3
    v_mfma_f32_32x32x16_bf16 v[96:111], v[132:135], v[136:139], v[96:111]
    s_add_u32 s75, s82, 18432
    buffer_load_dwordx4 v22, s[40:43], s75 offen offset:2048 lds
    v_lshlrev_b32 v2, 16, v133
    v_and_b32 v3, 0xffff0000, v133
    v_mfma_f32_32x32x16_bf16 v[112:127], v[132:135], v[140:143], v[112:127]
    v_add_f32 v28, v28, v2
    v_add_f32 v29, v29, v3
    v_mfma_f32_32x32x16_bf16 v[64:79], v[144:147], v[152:155], v[64:79]
    ds_read_b64_tr_b16 v[48:49], v210 offset:0
    ds_read_b64_tr_b16 v[50:51], v210 offset:512
    ds_read_b128 v[56:59], v217 offset:0
    s_add_u32 s75, s82, 27648
    buffer_load_dwordx4 v23, s[40:43], s75 offen offset:3072 lds
    v_lshlrev_b32 v2, 16, v134
    v_and_b32 v3, 0xffff0000, v134
    v_mfma_f32_32x32x16_bf16 v[80:95], v[144:147], v[156:159], v[80:95]
    ds_read_b64_tr_b16 v[52:53], v211 offset:0
    ds_read_b64_tr_b16 v[54:55], v211 offset:512
    ds_read_b128 v[60:63], v217 offset:4096
    s_add_u32 m0, s80, 32768
    s_add_u32 s75, s99, 0
    buffer_load_dwordx4 v24, s[52:55], s75 offen offset:0 lds
    v_add_f32 v28, v28, v2
    v_add_f32 v29, v29, v3
    v_mfma_f32_32x32x16_bf16 v[96:111], v[148:151], v[152:155], v[96:111]
    s_add_u32 s75, s99, 23552
    buffer_load_dwordx4 v24, s[52:55], s75 offen offset:1024 lds
    v_lshlrev_b32 v2, 16, v135
    v_and_b32 v3, 0xffff0000, v135
    v_mfma_f32_32x32x16_bf16 v[112:127], v[148:151], v[156:159], v[112:127]
    v_add_f32 v28, v28, v2
    v_add_f32 v29, v29, v3
    s_waitcnt lgkmcnt(6)
    v_mfma_f32_32x32x16_bf16 v[64:79], v[32:35], v[40:43], v[64:79]
    ds_read_b64_tr_b16 v[128:129], v212 offset:0
    ds_read_b64_tr_b16 v[130:131], v212 offset:512
    ds_read_b128 v[136:139], v218 offset:0
    s_add_u32 m0, s81, 4096
    s_add_u32 s75, s82, 40960
    buffer_load_dwordx4 v22, s[40:43], s75 offen offset:0 lds
    v_lshlrev_b32 v2, 16, v32
    v_and_b32 v3, 0xffff0000, v32
    v_mfma_f32_32x32x16_bf16 v[80:95], v[32:35], v[44:47], v[80:95]
    ds_read_b64_tr_b16 v[132:133], v213 offset:0
    ds_read_b64_tr_b16 v[134:135], v213 offset:512
    ds_read_b128 v[140:143], v218 offset:4096
    s_add_u32 s75, s82, 50176
    buffer_load_dwordx4 v23, s[40:43], s75 offen offset:1024 lds
    v_add_f32 v26, v26, v2
    v_add_f32 v27, v27, v3
    v_mfma_f32_32x32x16_bf16 v[96:111], v[36:39], v[40:43], v[96:111]
    s_add_u32 s75, s82, 59392
    buffer_load_dwordx4 v22, s[40:43], s75 offen offset:2048 lds
    v_lshlrev_b32 v2, 16, v33
    v_and_b32 v3, 0xffff0000, v33
    v_mfma_f32_32x32x16_bf16 v[112:127], v[36:39], v[44:47], v[112:127]
    v_add_f32 v26, v26, v2
    v_add_f32 v27, v27, v3
    s_waitcnt lgkmcnt(6)
    v_mfma_f32_32x32x16_bf16 v[64:79], v[48:51], v[56:59], v[64:79]
    ds_read_b64_tr_b16 v[144:145], v214 offset:0
    ds_read_b64_tr_b16 v[146:147], v214 offset:512
    ds_read_b128 v[152:155], v219 offset:0
    s_add_u32 s75, s82, 68608
    buffer_load_dwordx4 v23, s[40:43], s75 offen offset:3072 lds
    v_lshlrev_b32 v2, 16, v34
    v_and_b32 v3, 0xffff0000, v34
    v_mfma_f32_32x32x16_bf16 v[80:95], v[48:51], v[60:63], v[80:95]
    ds_read_b64_tr_b16 v[148:149], v215 offset:0
    ds_read_b64_tr_b16 v[150:151], v215 offset:512
    ds_read_b128 v[156:159], v219 offset:4096
    s_add_u32 m0, s80, 41024
    s_add_u32 s75, s99, 0
    buffer_load_dwordx4 v24, s[56:59], s75 offen offset:0 lds
    v_add_f32 v26, v26, v2
    v_add_f32 v27, v27, v3
    v_mfma_f32_32x32x16_bf16 v[96:111], v[52:55], v[56:59], v[96:111]
    s_add_u32 s75, s99, 23552
    buffer_load_dwordx4 v24, s[56:59], s75 offen offset:1024 lds
    s_add_u32 s82, s82, 128
    s_add_u32 s99, s99, 196608
    s_cmp_eq_u32 s82, 1280
    s_cselect_b32 s82, 0, s82
    s_cselect_b32 s99, 0, s99
    v_lshlrev_b32 v2, 16, v35
    v_and_b32 v3, 0xffff0000, v35
    v_mfma_f32_32x32x16_bf16 v[112:127], v[52:55], v[60:63], v[112:127]
    v_add_f32 v26, v26, v2
    v_add_f32 v27, v27, v3
    s_waitcnt lgkmcnt(0)
    s_waitcnt vmcnt(12)
    s_barrier
    v_mfma_f32_32x32x16_bf16 v[64:79], v[128:131], v[136:139], v[64:79]
    ds_read_b64_tr_b16 v[32:33], v220 offset:0
    ds_read_b64_tr_b16 v[34:35], v220 offset:512
    ds_read_b128 v[40:43], v228 offset:0
    v_lshlrev_b32 v2, 16, v132
    v_and_b32 v3, 0xffff0000, v132
    v_mfma_f32_32x32x16_bf16 v[80:95], v[128:131], v[140:143], v[80:95]
    ds_read_b64_tr_b16 v[36:37], v221 offset:0
    ds_read_b64_tr_b16 v[38:39], v221 offset:512
    ds_read_b128 v[44:47], v228 offset:4096
    v_add_f32 v28, v28, v2
    v_add_f32 v29, v29, v3
    v_mfma_f32_32x32x16_bf16 v[96:111], v[132:135], v[136:139], v[96:111]
    v_lshlrev_b32 v2, 16, v133
    v_and_b32 v3, 0xffff0000, v133
    v_mfma_f32_32x32x16_bf16 v[112:127], v[132:135], v[140:143], v[112:127]
    v_add_f32 v28, v28, v2
    v_add_f32 v29, v29, v3
    v_mfma_f32_32x32x16_bf16 v[64:79], v[144:147], v[152:155], v[64:79]
    ds_read_b64_tr_b16 v[48:49], v222 offset:0
    ds_read_b64_tr_b16 v[50:51], v222 offset:512
    ds_read_b128 v[56:59], v229 offset:0
    v_lshlrev_b32 v2, 16, v134
    v_and_b32 v3, 0xffff0000, v134
    v_mfma_f32_32x32x16_bf16 v[80:95], v[144:147], v[156:159], v[80:95]
    ds_read_b64_tr_b16 v[52:53], v223 offset:0
    ds_read_b64_tr_b16 v[54:55], v223 offset:512
    ds_read_b128 v[60:63], v229 offset:4096
    v_add_f32 v28, v28, v2
    v_add_f32 v29, v29, v3
    v_mfma_f32_32x32x16_bf16 v[96:111], v[148:151], v[152:155], v[96:111]
    v_lshlrev_b32 v2, 16, v135
    v_and_b32 v3, 0xffff0000, v135
    v_mfma_f32_32x32x16_bf16 v[112:127], v[148:151], v[156:159], v[112:127]
    v_add_f32 v28, v28, v2
    v_add_f32 v29, v29, v3
    s_waitcnt lgkmcnt(6)
    v_mfma_f32_32x32x16_bf16 v[64:79], v[32:35], v[40:43], v[64:79]
    ds_read_b64_tr_b16 v[128:129], v224 offset:0
    ds_read_b64_tr_b16 v[130:131], v224 offset:512
    ds_read_b128 v[136:139], v230 offset:0
    v_lshlrev_b32 v2, 16, v32
    v_and_b32 v3, 0xffff0000, v32
    v_mfma_f32_32x32x16_bf16 v[80:95], v[32:35], v[44:47], v[80:95]
    ds_read_b64_tr_b16 v[132:133], v225 offset:0
    ds_read_b64_tr_b16 v[134:135], v225 offset:512
    ds_read_b128 v[140:143], v230 offset:4096
    v_add_f32 v26, v26, v2
    v_add_f32 v27, v27, v3
    v_mfma_f32_32x32x16_bf16 v[96:111], v[36:39], v[40:43], v[96:111]
    v_lshlrev_b32 v2, 16, v33
    v_and_b32 v3, 0xffff0000, v33
    v_mfma_f32_32x32x16_bf16 v[112:127], v[36:39], v[44:47], v[112:127]
    v_add_f32 v26, v26, v2
    v_add_f32 v27, v27, v3
    s_waitcnt lgkmcnt(6)
    v_mfma_f32_32x32x16_bf16 v[64:79], v[48:51], v[56:59], v[64:79]
    ds_read_b64_tr_b16 v[144:145], v226 offset:0
    ds_read_b64_tr_b16 v[146:147], v226 offset:512
    ds_read_b128 v[152:155], v231 offset:0
    v_lshlrev_b32 v2, 16, v34
    v_and_b32 v3, 0xffff0000, v34
    v_mfma_f32_32x32x16_bf16 v[80:95], v[48:51], v[60:63], v[80:95]
    ds_read_b64_tr_b16 v[148:149], v227 offset:0
    ds_read_b64_tr_b16 v[150:151], v227 offset:512
    ds_read_b128 v[156:159], v231 offset:4096
    v_add_f32 v26, v26, v2
    v_add_f32 v27, v27, v3
    v_mfma_f32_32x32x16_bf16 v[96:111], v[52:55], v[56:59], v[96:111]
    v_lshlrev_b32 v2, 16, v35
    v_and_b32 v3, 0xffff0000, v35
    v_mfma_f32_32x32x16_bf16 v[112:127], v[52:55], v[60:63], v[112:127]
    v_add_f32 v26, v26, v2
    v_add_f32 v27, v27, v3
    s_waitcnt lgkmcnt(0)
    s_waitcnt vmcnt(0)
    s_barrier
    v_mov_b32 v4, 155776
    ds_read_b32 v5, v4
    v_mfma_f32_32x32x16_bf16 v[64:79], v[128:131], v[136:139], v[64:79]
    ds_read_b64_tr_b16 v[32:33], v10 offset:0
    ds_read_b64_tr_b16 v[34:35], v10 offset:512
    ds_read_b128 v[40:43], v18 offset:0
    v_lshlrev_b32 v2, 16, v132
    v_and_b32 v3, 0xffff0000, v132
    v_mfma_f32_32x32x16_bf16 v[80:95], v[128:131], v[140:143], v[80:95]
    ds_read_b64_tr_b16 v[36:37], v11 offset:0
    ds_read_b64_tr_b16 v[38:39], v11 offset:512
    ds_read_b128 v[44:47], v18 offset:4096
    v_add_f32 v28, v28, v2
    v_add_f32 v29, v29, v3
    v_mfma_f32_32x32x16_bf16 v[96:111], v[132:135], v[136:139], v[96:111]
    v_lshlrev_b32 v2, 16, v133
    v_and_b32 v3, 0xffff0000, v133
    v_mfma_f32_32x32x16_bf16 v[112:127], v[132:135], v[140:143], v[112:127]
    v_add_f32 v28, v28, v2
    v_add_f32 v29, v29, v3
    v_mfma_f32_32x32x16_bf16 v[64:79], v[144:147], v[152:155], v[64:79]
    ds_read_b64_tr_b16 v[48:49], v12 offset:0
    ds_read_b64_tr_b16 v[50:51], v12 offset:512
    ds_read_b128 v[56:59], v19 offset:0
    v_lshlrev_b32 v2, 16, v134
    v_and_b32 v3, 0xffff0000, v134
    v_mfma_f32_32x32x16_bf16 v[80:95], v[144:147], v[156:159], v[80:95]
    ds_read_b64_tr_b16 v[52:53], v13 offset:0
    ds_read_b64_tr_b16 v[54:55], v13 offset:512
    ds_read_b128 v[60:63], v19 offset:4096
    v_add_f32 v28, v28, v2
    v_add_f32 v29, v29, v3
    v_mfma_f32_32x32x16_bf16 v[96:111], v[148:151], v[152:155], v[96:111]
    v_lshlrev_b32 v2, 16, v135
    v_and_b32 v3, 0xffff0000, v135
    v_mfma_f32_32x32x16_bf16 v[112:127], v[148:151], v[156:159], v[112:127]
    v_add_f32 v28, v28, v2
    v_add_f32 v29, v29, v3
    s_waitcnt lgkmcnt(6)
    v_mfma_f32_32x32x16_bf16 v[64:79], v[32:35], v[40:43], v[64:79]
    ds_read_b64_tr_b16 v[128:129], v14 offset:0
    ds_read_b64_tr_b16 v[130:131], v14 offset:512
    ds_read_b128 v[136:139], v20 offset:0
    v_lshlrev_b32 v2, 16, v32
    v_and_b32 v3, 0xffff0000, v32
    v_readfirstlane_b32 s79, v5
    v_mfma_f32_32x32x16_bf16 v[80:95], v[32:35], v[44:47], v[80:95]
    ds_read_b64_tr_b16 v[132:133], v15 offset:0
    ds_read_b64_tr_b16 v[134:135], v15 offset:512
    ds_read_b128 v[140:143], v20 offset:4096
    v_add_f32 v26, v26, v2
    v_add_f32 v27, v27, v3
    v_mfma_f32_32x32x16_bf16 v[96:111], v[36:39], v[40:43], v[96:111]
    v_lshlrev_b32 v2, 16, v33
    v_and_b32 v3, 0xffff0000, v33
    v_mfma_f32_32x32x16_bf16 v[112:127], v[36:39], v[44:47], v[112:127]
    v_add_f32 v26, v26, v2
    v_add_f32 v27, v27, v3
    s_waitcnt lgkmcnt(6)
    v_mfma_f32_32x32x16_bf16 v[64:79], v[48:51], v[56:59], v[64:79]
    ds_read_b64_tr_b16 v[144:145], v16 offset:0
    ds_read_b64_tr_b16 v[146:147], v16 offset:512
    ds_read_b128 v[152:155], v21 offset:0
    v_lshlrev_b32 v2, 16, v34
    v_and_b32 v3, 0xffff0000, v34
    v_mfma_f32_32x32x16_bf16 v[80:95], v[48:51], v[60:63], v[80:95]
    ds_read_b64_tr_b16 v[148:149], v17 offset:0
    ds_read_b64_tr_b16 v[150:151], v17 offset:512
    ds_read_b128 v[156:159], v21 offset:4096
    v_add_f32 v26, v26, v2
    v_add_f32 v27, v27, v3
    v_mfma_f32_32x32x16_bf16 v[96:111], v[52:55], v[56:59], v[96:111]
    v_lshlrev_b32 v2, 16, v35
    v_and_b32 v3, 0xffff0000, v35
    v_mfma_f32_32x32x16_bf16 v[112:127], v[52:55], v[60:63], v[112:127]
    v_add_f32 v26, v26, v2
    v_add_f32 v27, v27, v3
    s_waitcnt lgkmcnt(0)
    s_branch L_gu_fin
L_gu_h:
    v_lshlrev_b32 v1, 2, v250
    v_add_u32 v1, 155648, v1
    ds_write_b32 v1, v242
    s_waitcnt lgkmcnt(0)
    v_add_u32 v208, 49408, v10
    v_add_u32 v209, 49408, v11
    v_add_u32 v210, 49408, v12
    v_add_u32 v211, 49408, v13
    v_add_u32 v212, 49408, v14
    v_add_u32 v213, 49408, v15
    v_add_u32 v214, 49408, v16
    v_add_u32 v215, 49408, v17
    v_add_u32 v216, 49408, v18
    v_add_u32 v217, 49408, v19
    v_add_u32 v218, 49408, v20
    v_add_u32 v219, 49408, v21
    v_add_u32 v220, 98816, v10
    v_add_u32 v221, 98816, v11
    v_add_u32 v222, 98816, v12
    v_add_u32 v223, 98816, v13
    v_add_u32 v224, 98816, v14
    v_add_u32 v225, 98816, v15
    v_add_u32 v226, 98816, v16
    v_add_u32 v227, 98816, v17
    v_add_u32 v228, 98816, v18
    v_add_u32 v229, 98816, v19
    v_add_u32 v230, 98816, v20
    v_add_u32 v231, 98816, v21
    s_barrier
    ds_read_b64_tr_b16 v[32:33], v10 offset:0
    ds_read_b64_tr_b16 v[34:35], v10 offset:512
    ds_read_b128 v[40:43], v18 offset:0
    ds_read_b64_tr_b16 v[36:37], v11 offset:0
    ds_read_b64_tr_b16 v[38:39], v11 offset:512
    ds_read_b128 v[44:47], v18 offset:4096
    ds_read_b64_tr_b16 v[48:49], v12 offset:0
    ds_read_b64_tr_b16 v[50:51], v12 offset:512
    ds_read_b128 v[56:59], v19 offset:0
    ds_read_b64_tr_b16 v[52:53], v13 offset:0
    ds_read_b64_tr_b16 v[54:55], v13 offset:512
    ds_read_b128 v[60:63], v19 offset:4096
    s_waitcnt lgkmcnt(6)
    v_mfma_f32_32x32x16_bf16 v[64:79], v[32:35], v[40:43], 0
    ds_read_b64_tr_b16 v[128:129], v14 offset:0
    ds_read_b64_tr_b16 v[130:131], v14 offset:512
    ds_read_b128 v[136:139], v20 offset:0
    v_lshlrev_b32 v2, 16, v32
    v_and_b32 v3, 0xffff0000, v32
    s_waitcnt vmcnt(0)
    v_add_u32 v203, 1, v203
    v_or_b32 v203, 0x80000000, v203
    v_mov_b32 v4, 155776
    ds_write_b32 v4, v203
    v_readfirstlane_b32 s79, v203
    v_mfma_f32_32x32x16_bf16 v[80:95], v[32:35], v[44:47], 0
    ds_read_b64_tr_b16 v[132:133], v15 offset:0
    ds_read_b64_tr_b16 v[134:135], v15 offset:512
    ds_read_b128 v[140:143], v20 offset:4096
    v_add_f32 v26, v26, v2
    v_add_f32 v27, v27, v3
    v_mov_b32 v8, 0
    v_mov_b32 v9, 0
    v_lshlrev_b32 v4, 16, v192
    v_and_b32 v5, 0xffff0000, v192
    v_mfma_f32_32x32x16_bf16 v[96:111], v[36:39], v[40:43], 0
    v_lshlrev_b32 v2, 16, v33
    v_and_b32 v3, 0xffff0000, v33
    v_add_f32 v8, v8, v4
    v_fmac_f32 v9, v4, v4
    v_add_f32 v8, v8, v5
    v_fmac_f32 v9, v5, v5
    v_mfma_f32_32x32x16_bf16 v[112:127], v[36:39], v[44:47], 0
    v_add_f32 v26, v26, v2
    v_add_f32 v27, v27, v3
    v_lshlrev_b32 v4, 16, v193
    v_and_b32 v5, 0xffff0000, v193
    s_waitcnt lgkmcnt(6)
    v_mfma_f32_32x32x16_bf16 v[64:79], v[48:51], v[56:59], v[64:79]
    ds_read_b64_tr_b16 v[144:145], v16 offset:0
    ds_read_b64_tr_b16 v[146:147], v16 offset:512
    ds_read_b128 v[152:155], v21 offset:0
    v_lshlrev_b32 v2, 16, v34
    v_and_b32 v3, 0xffff0000, v34
    v_add_f32 v8, v8, v4
    v_fmac_f32 v9, v4, v4
    v_add_f32 v8, v8, v5
    v_fmac_f32 v9, v5, v5
    v_mfma_f32_32x32x16_bf16 v[80:95], v[48:51], v[60:63], v[80:95]
    ds_read_b64_tr_b16 v[148:149], v17 offset:0
    ds_read_b64_tr_b16 v[150:151], v17 offset:512
    ds_read_b128 v[156:159], v21 offset:4096
    v_add_f32 v26, v26, v2
    v_add_f32 v27, v27, v3
    v_lshlrev_b32 v4, 16, v194
    v_and_b32 v5, 0xffff0000, v194
    v_add_f32 v8, v8, v4
    v_fmac_f32 v9, v4, v4
    v_mfma_f32_32x32x16_bf16 v[96:111], v[52:55], v[56:59], v[96:111]
    v_lshlrev_b32 v2, 16, v35
    v_and_b32 v3, 0xffff0000, v35
    v_add_f32 v8, v8, v5
    v_fmac_f32 v9, v5, v5
    v_lshlrev_b32 v4, 16, v195
    v_and_b32 v5, 0xffff0000, v195
    v_mfma_f32_32x32x16_bf16 v[112:127], v[52:55], v[60:63], v[112:127]
    v_add_f32 v26, v26, v2
    v_add_f32 v27, v27, v3
    v_add_f32 v8, v8, v4
    v_fmac_f32 v9, v4, v4
    s_waitcnt lgkmcnt(0)
    s_barrier
    v_mfma_f32_32x32x16_bf16 v[64:79], v[128:131], v[136:139], v[64:79]
    ds_read_b64_tr_b16 v[32:33], v208 offset:0
    ds_read_b64_tr_b16 v[34:35], v208 offset:512
    ds_read_b128 v[40:43], v216 offset:0
    v_lshlrev_b32 v2, 16, v132
    v_and_b32 v3, 0xffff0000, v132
    v_add_f32 v8, v8, v5
    v_fmac_f32 v9, v5, v5
    v_lshlrev_b32 v4, 16, v196
    v_and_b32 v5, 0xffff0000, v196
    v_add_f32 v8, v8, v4
    v_mfma_f32_32x32x16_bf16 v[80:95], v[128:131], v[140:143], v[80:95]
    ds_read_b64_tr_b16 v[36:37], v209 offset:0
    ds_read_b64_tr_b16 v[38:39], v209 offset:512
    ds_read_b128 v[44:47], v216 offset:4096
    v_add_f32 v28, v28, v2
    v_add_f32 v29, v29, v3
    v_fmac_f32 v9, v4, v4
    v_add_f32 v8, v8, v5
    v_fmac_f32 v9, v5, v5
    v_lshlrev_b32 v4, 16, v197
    v_and_b32 v5, 0xffff0000, v197
    v_mfma_f32_32x32x16_bf16 v[96:111], v[132:135], v[136:139], v[96:111]
    v_lshlrev_b32 v2, 16, v133
    v_and_b32 v3, 0xffff0000, v133
    v_add_f32 v8, v8, v4
    v_fmac_f32 v9, v4, v4
    v_add_f32 v8, v8, v5
    v_fmac_f32 v9, v5, v5
    v_lshlrev_b32 v4, 16, v198
    v_mfma_f32_32x32x16_bf16 v[112:127], v[132:135], v[140:143], v[112:127]
    v_add_f32 v28, v28, v2
    v_add_f32 v29, v29, v3
    v_and_b32 v5, 0xffff0000, v198
    v_add_f32 v8, v8, v4
    v_fmac_f32 v9, v4, v4
    v_mfma_f32_32x32x16_bf16 v[64:79], v[144:147], v[152:155], v[64:79]
    ds_read_b64_tr_b16 v[48:49], v210 offset:0
    ds_read_b64_tr_b16 v[50:51], v210 offset:512
    ds_read_b128 v[56:59], v217 offset:0
    v_lshlrev_b32 v2, 16, v134
    v_and_b32 v3, 0xffff0000, v134
    v_add_f32 v8, v8, v5
    v_fmac_f32 v9, v5, v5
    v_lshlrev_b32 v4, 16, v199
    v_and_b32 v5, 0xffff0000, v199
    v_add_f32 v8, v8, v4
    v_mfma_f32_32x32x16_bf16 v[80:95], v[144:147], v[156:159], v[80:95]
    ds_read_b64_tr_b16 v[52:53], v211 offset:0
    ds_read_b64_tr_b16 v[54:55], v211 offset:512
    ds_read_b128 v[60:63], v217 offset:4096
    v_add_f32 v28, v28, v2
    v_add_f32 v29, v29, v3
    v_fmac_f32 v9, v4, v4
    v_add_f32 v8, v8, v5
    v_fmac_f32 v9, v5, v5
    v_lshlrev_b32 v4, 16, v200
    v_and_b32 v5, 0xffff0000, v200
    v_mfma_f32_32x32x16_bf16 v[96:111], v[148:151], v[152:155], v[96:111]
    v_lshlrev_b32 v2, 16, v135
    v_and_b32 v3, 0xffff0000, v135
    v_add_f32 v8, v8, v4
    v_fmac_f32 v9, v4, v4
    v_add_f32 v8, v8, v5
    v_fmac_f32 v9, v5, v5
    v_lshlrev_b32 v4, 16, v201
    v_mfma_f32_32x32x16_bf16 v[112:127], v[148:151], v[156:159], v[112:127]
    v_add_f32 v28, v28, v2
    v_add_f32 v29, v29, v3
    v_and_b32 v5, 0xffff0000, v201
    v_add_f32 v8, v8, v4
    v_fmac_f32 v9, v4, v4
    s_waitcnt lgkmcnt(6)
    v_mfma_f32_32x32x16_bf16 v[64:79], v[32:35], v[40:43], v[64:79]
    ds_read_b64_tr_b16 v[128:129], v212 offset:0
    ds_read_b64_tr_b16 v[130:131], v212 offset:512
    ds_read_b128 v[136:139], v218 offset:0
    v_lshlrev_b32 v2, 16, v32
    v_and_b32 v3, 0xffff0000, v32
    v_add_f32 v8, v8, v5
    v_fmac_f32 v9, v5, v5
    s_nop 0
    v_add_f32_dpp v8, v8, v8 row_ror:8 row_mask:0xf bank_mask:0xf
    v_add_f32_dpp v9, v9, v9 row_ror:8 row_mask:0xf bank_mask:0xf
    v_mfma_f32_32x32x16_bf16 v[80:95], v[32:35], v[44:47], v[80:95]
    ds_read_b64_tr_b16 v[132:133], v213 offset:0
    ds_read_b64_tr_b16 v[134:135], v213 offset:512
    ds_read_b128 v[140:143], v218 offset:4096
    v_add_f32 v26, v26, v2
    v_add_f32 v27, v27, v3
    s_nop 0
    v_add_f32_dpp v8, v8, v8 row_ror:4 row_mask:0xf bank_mask:0xf
    v_add_f32_dpp v9, v9, v9 row_ror:4 row_mask:0xf bank_mask:0xf
    s_nop 0
    v_add_f32_dpp v8, v8, v8 row_ror:2 row_mask:0xf bank_mask:0xf
    v_mfma_f32_32x32x16_bf16 v[96:111], v[36:39], v[40:43], v[96:111]
    v_lshlrev_b32 v2, 16, v33
    v_and_b32 v3, 0xffff0000, v33
    v_add_f32_dpp v9, v9, v9 row_ror:2 row_mask:0xf bank_mask:0xf
    s_nop 0
    v_add_f32_dpp v8, v8, v8 row_ror:1 row_mask:0xf bank_mask:0xf
    v_add_f32_dpp v9, v9, v9 row_ror:1 row_mask:0xf bank_mask:0xf
    v_mov_b32 v4, v8
    v_mfma_f32_32x32x16_bf16 v[112:127], v[36:39], v[44:47], v[112:127]
    v_add_f32 v26, v26, v2
    v_add_f32 v27, v27, v3
    v_mov_b32 v5, v9
    s_nop 1
    v_permlane16_swap_b32 v4, v8
    s_waitcnt lgkmcnt(6)
    v_mfma_f32_32x32x16_bf16 v[64:79], v[48:51], v[56:59], v[64:79]
    ds_read_b64_tr_b16 v[144:145], v214 offset:0
    ds_read_b64_tr_b16 v[146:147], v214 offset:512
    ds_read_b128 v[152:155], v219 offset:0
    v_lshlrev_b32 v2, 16, v34
    v_and_b32 v3, 0xffff0000, v34
    v_permlane16_swap_b32 v5, v9
    s_nop 1
    v_add_f32 v4, v4, v8
    v_add_f32 v5, v5, v9
    v_mul_f32 v4, 0xbacccccd, v4
    v_mfma_f32_32x32x16_bf16 v[80:95], v[48:51], v[60:63], v[80:95]
    ds_read_b64_tr_b16 v[148:149], v215 offset:0
    ds_read_b64_tr_b16 v[150:151], v215 offset:512
    ds_read_b128 v[156:159], v219 offset:4096
    v_add_f32 v26, v26, v2
    v_add_f32 v27, v27, v3
    v_mul_f32 v5, 0x3acccccd, v5
    v_fma_f32 v5, -v4, v4, v5
    v_max_f32 v5, 0, v5
    v_cvt_pk_bf16_f32 v5, v5, v5
    v_lshlrev_b32 v5, 16, v5
    v_mfma_f32_32x32x16_bf16 v[96:111], v[52:55], v[56:59], v[96:111]
    v_lshlrev_b32 v2, 16, v35
    v_and_b32 v3, 0xffff0000, v35
    v_add_f32 v5, 0x3727c5ac, v5
    v_cvt_pk_bf16_f32 v5, v5, v5
    v_lshlrev_b32 v5, 16, v5
    v_sqrt_f32 v5, v5
    s_nop 0
    v_mfma_f32_32x32x16_bf16 v[112:127], v[52:55], v[60:63], v[112:127]
    v_add_f32 v26, v26, v2
    v_add_f32 v27, v27, v3
    v_cvt_pk_bf16_f32 v202, v4, v5
    s_mov_b32 exec_lo, 1
    s_mov_b32 exec_hi, 1
    s_mov_b32 s72, 3080192
    buffer_store_dwordx2 v[202:203], v255, s[44:47], s72 offen sc1
    s_mov_b64 exec, -1
    s_waitcnt lgkmcnt(0)
    s_barrier
    v_mfma_f32_32x32x16_bf16 v[64:79], v[128:131], v[136:139], v[64:79]
    ds_read_b64_tr_b16 v[32:33], v220 offset:0
    ds_read_b64_tr_b16 v[34:35], v220 offset:512
    ds_read_b128 v[40:43], v228 offset:0
    v_lshlrev_b32 v2, 16, v132
    v_and_b32 v3, 0xffff0000, v132
    v_lshlrev_b32 v254, 3, v250
    v_mfma_f32_32x32x16_bf16 v[80:95], v[128:131], v[140:143], v[80:95]
    ds_read_b64_tr_b16 v[36:37], v221 offset:0
    ds_read_b64_tr_b16 v[38:39], v221 offset:512
    ds_read_b128 v[44:47], v228 offset:4096
    v_add_f32 v28, v28, v2
    v_add_f32 v29, v29, v3
    v_mov_b32 v4, 0x80000000
    v_mfma_f32_32x32x16_bf16 v[96:111], v[132:135], v[136:139], v[96:111]
    v_lshlrev_b32 v2, 16, v133
    v_and_b32 v3, 0xffff0000, v133
    v_cndmask_b32 v254, v254, v4, s[92:93]
    v_mfma_f32_32x32x16_bf16 v[112:127], v[132:135], v[140:143], v[112:127]
    v_add_f32 v28, v28, v2
    v_add_f32 v29, v29, v3
    v_mul_u32_u24 v5, 21, v252
    v_mfma_f32_32x32x16_bf16 v[64:79], v[144:147], v[152:155], v[64:79]
    ds_read_b64_tr_b16 v[48:49], v222 offset:0
    ds_read_b64_tr_b16 v[50:51], v222 offset:512
    ds_read_b128 v[56:59], v229 offset:0
    v_lshlrev_b32 v2, 16, v134
    v_and_b32 v3, 0xffff0000, v134
    v_add_lshl_u32 v5, v5, v251, 4
    v_mfma_f32_32x32x16_bf16 v[80:95], v[144:147], v[156:159], v[80:95]
    ds_read_b64_tr_b16 v[52:53], v223 offset:0
    ds_read_b64_tr_b16 v[54:55], v223 offset:512
    ds_read_b128 v[60:63], v229 offset:4096
    v_add_f32 v28, v28, v2
    v_add_f32 v29, v29, v3
    v_cmp_gt_u32 vcc, 21, v251
    v_mfma_f32_32x32x16_bf16 v[96:111], v[148:151], v[152:155], v[96:111]
    v_lshlrev_b32 v2, 16, v135
    v_and_b32 v3, 0xffff0000, v135
    s_nop 1
    v_mfma_f32_32x32x16_bf16 v[112:127], v[148:151], v[156:159], v[112:127]
    v_add_f32 v28, v28, v2
    v_add_f32 v29, v29, v3
    v_cndmask_b32 v0, v4, v5, vcc
    s_waitcnt lgkmcnt(6)
    v_mfma_f32_32x32x16_bf16 v[64:79], v[32:35], v[40:43], v[64:79]
    ds_read_b64_tr_b16 v[128:129], v224 offset:0
    ds_read_b64_tr_b16 v[130:131], v224 offset:512
    ds_read_b128 v[136:139], v230 offset:0
    v_lshlrev_b32 v2, 16, v32
    v_and_b32 v3, 0xffff0000, v32
    s_lshl_b32 s72, s3, 2
    v_mfma_f32_32x32x16_bf16 v[80:95], v[32:35], v[44:47], v[80:95]
    ds_read_b64_tr_b16 v[132:133], v225 offset:0
    ds_read_b64_tr_b16 v[134:135], v225 offset:512
    ds_read_b128 v[140:143], v230 offset:4096
    v_add_f32 v26, v26, v2
    v_add_f32 v27, v27, v3
    s_add_u32 s72, s72, 155648
    v_mfma_f32_32x32x16_bf16 v[96:111], v[36:39], v[40:43], v[96:111]
    v_lshlrev_b32 v2, 16, v33
    v_and_b32 v3, 0xffff0000, v33
    v_mov_b32 v248, s72
    v_mfma_f32_32x32x16_bf16 v[112:127], v[36:39], v[44:47], v[112:127]
    v_add_f32 v26, v26, v2
    v_add_f32 v27, v27, v3
    v_mov_b32 v243, 0
    s_waitcnt lgkmcnt(6)
    v_mfma_f32_32x32x16_bf16 v[64:79], v[48:51], v[56:59], v[64:79]
    ds_read_b64_tr_b16 v[144:145], v226 offset:0
    ds_read_b64_tr_b16 v[146:147], v226 offset:512
    ds_read_b128 v[152:155], v231 offset:0
    v_lshlrev_b32 v2, 16, v34
    v_and_b32 v3, 0xffff0000, v34
    v_mov_b32 v244, 0
    v_mfma_f32_32x32x16_bf16 v[80:95], v[48:51], v[60:63], v[80:95]
    ds_read_b64_tr_b16 v[148:149], v227 offset:0
    ds_read_b64_tr_b16 v[150:151], v227 offset:512
    ds_read_b128 v[156:159], v231 offset:4096
    v_add_f32 v26, v26, v2
    v_add_f32 v27, v27, v3
    v_mov_b32 v245, 0
    v_mfma_f32_32x32x16_bf16 v[96:111], v[52:55], v[56:59], v[96:111]
    v_lshlrev_b32 v2, 16, v35
    v_and_b32 v3, 0xffff0000, v35
    v_mfma_f32_32x32x16_bf16 v[112:127], v[52:55], v[60:63], v[112:127]
    v_add_f32 v26, v26, v2
    v_add_f32 v27, v27, v3
    s_waitcnt lgkmcnt(0)
    s_barrier
    v_mfma_f32_32x32x16_bf16 v[64:79], v[128:131], v[136:139], v[64:79]
    ds_read_b64_tr_b16 v[32:33], v10 offset:0
    ds_read_b64_tr_b16 v[34:35], v10 offset:512
    ds_read_b128 v[40:43], v18 offset:0
    v_lshlrev_b32 v2, 16, v132
    v_and_b32 v3, 0xffff0000, v132
    v_mfma_f32_32x32x16_bf16 v[80:95], v[128:131], v[140:143], v[80:95]
    ds_read_b64_tr_b16 v[36:37], v11 offset:0
    ds_read_b64_tr_b16 v[38:39], v11 offset:512
    ds_read_b128 v[44:47], v18 offset:4096
    v_add_f32 v28, v28, v2
    v_add_f32 v29, v29, v3
    v_mfma_f32_32x32x16_bf16 v[96:111], v[132:135], v[136:139], v[96:111]
    v_lshlrev_b32 v2, 16, v133
    v_and_b32 v3, 0xffff0000, v133
    v_mfma_f32_32x32x16_bf16 v[112:127], v[132:135], v[140:143], v[112:127]
    v_add_f32 v28, v28, v2
    v_add_f32 v29, v29, v3
    v_mfma_f32_32x32x16_bf16 v[64:79], v[144:147], v[152:155], v[64:79]
    ds_read_b64_tr_b16 v[48:49], v12 offset:0
    ds_read_b64_tr_b16 v[50:51], v12 offset:512
    ds_read_b128 v[56:59], v19 offset:0
    v_lshlrev_b32 v2, 16, v134
    v_and_b32 v3, 0xffff0000, v134
    v_mfma_f32_32x32x16_bf16 v[80:95], v[144:147], v[156:159], v[80:95]
    ds_read_b64_tr_b16 v[52:53], v13 offset:0
    ds_read_b64_tr_b16 v[54:55], v13 offset:512
    ds_read_b128 v[60:63], v19 offset:4096
    v_add_f32 v28, v28, v2
    v_add_f32 v29, v29, v3
    v_mfma_f32_32x32x16_bf16 v[96:111], v[148:151], v[152:155], v[96:111]
    v_lshlrev_b32 v2, 16, v135
    v_and_b32 v3, 0xffff0000, v135
    v_mfma_f32_32x32x16_bf16 v[112:127], v[148:151], v[156:159], v[112:127]
    v_add_f32 v28, v28, v2
    v_add_f32 v29, v29, v3
    s_waitcnt lgkmcnt(6)
    v_mfma_f32_32x32x16_bf16 v[64:79], v[32:35], v[40:43], v[64:79]
    ds_read_b64_tr_b16 v[128:129], v14 offset:0
    ds_read_b64_tr_b16 v[130:131], v14 offset:512
    ds_read_b128 v[136:139], v20 offset:0
    v_lshlrev_b32 v2, 16, v32
    v_and_b32 v3, 0xffff0000, v32
    v_mfma_f32_32x32x16_bf16 v[80:95], v[32:35], v[44:47], v[80:95]
    ds_read_b64_tr_b16 v[132:133], v15 offset:0
    ds_read_b64_tr_b16 v[134:135], v15 offset:512
    ds_read_b128 v[140:143], v20 offset:4096
    v_add_f32 v26, v26, v2
    v_add_f32 v27, v27, v3
    v_mfma_f32_32x32x16_bf16 v[96:111], v[36:39], v[40:43], v[96:111]
    v_lshlrev_b32 v2, 16, v33
    v_and_b32 v3, 0xffff0000, v33
    v_mfma_f32_32x32x16_bf16 v[112:127], v[36:39], v[44:47], v[112:127]
    v_add_f32 v26, v26, v2
    v_add_f32 v27, v27, v3
    s_waitcnt lgkmcnt(6)
    v_mfma_f32_32x32x16_bf16 v[64:79], v[48:51], v[56:59], v[64:79]
    ds_read_b64_tr_b16 v[144:145], v16 offset:0
    ds_read_b64_tr_b16 v[146:147], v16 offset:512
    ds_read_b128 v[152:155], v21 offset:0
    v_lshlrev_b32 v2, 16, v34
    v_and_b32 v3, 0xffff0000, v34
    v_mfma_f32_32x32x16_bf16 v[80:95], v[48:51], v[60:63], v[80:95]
    ds_read_b64_tr_b16 v[148:149], v17 offset:0
    ds_read_b64_tr_b16 v[150:151], v17 offset:512
    ds_read_b128 v[156:159], v21 offset:4096
    v_add_f32 v26, v26, v2
    v_add_f32 v27, v27, v3
    v_mfma_f32_32x32x16_bf16 v[96:111], v[52:55], v[56:59], v[96:111]
    v_lshlrev_b32 v2, 16, v35
    v_and_b32 v3, 0xffff0000, v35
    v_mfma_f32_32x32x16_bf16 v[112:127], v[52:55], v[60:63], v[112:127]
    v_add_f32 v26, v26, v2
    v_add_f32 v27, v27, v3
    s_waitcnt lgkmcnt(0)
    s_barrier
    v_mfma_f32_32x32x16_bf16 v[64:79], v[128:131], v[136:139], v[64:79]
    ds_read_b64_tr_b16 v[32:33], v208 offset:0
    ds_read_b64_tr_b16 v[34:35], v208 offset:512
    ds_read_b128 v[40:43], v216 offset:0
    v_lshlrev_b32 v2, 16, v132
    v_and_b32 v3, 0xffff0000, v132
    v_mfma_f32_32x32x16_bf16 v[80:95], v[128:131], v[140:143], v[80:95]
    ds_read_b64_tr_b16 v[36:37], v209 offset:0
    ds_read_b64_tr_b16 v[38:39], v209 offset:512
    ds_read_b128 v[44:47], v216 offset:4096
    v_add_f32 v28, v28, v2
    v_add_f32 v29, v29, v3
    v_mfma_f32_32x32x16_bf16 v[96:111], v[132:135], v[136:139], v[96:111]
    v_lshlrev_b32 v2, 16, v133
    v_and_b32 v3, 0xffff0000, v133
    v_mfma_f32_32x32x16_bf16 v[112:127], v[132:135], v[140:143], v[112:127]
    v_add_f32 v28, v28, v2
    v_add_f32 v29, v29, v3
    v_mfma_f32_32x32x16_bf16 v[64:79], v[144:147], v[152:155], v[64:79]
    ds_read_b64_tr_b16 v[48:49], v210 offset:0
    ds_read_b64_tr_b16 v[50:51], v210 offset:512
    ds_read_b128 v[56:59], v217 offset:0
    v_lshlrev_b32 v2, 16, v134
    v_and_b32 v3, 0xffff0000, v134
    v_mfma_f32_32x32x16_bf16 v[80:95], v[144:147], v[156:159], v[80:95]
    ds_read_b64_tr_b16 v[52:53], v211 offset:0
    ds_read_b64_tr_b16 v[54:55], v211 offset:512
    ds_read_b128 v[60:63], v217 offset:4096
    v_add_f32 v28, v28, v2
    v_add_f32 v29, v29, v3
    v_mfma_f32_32x32x16_bf16 v[96:111], v[148:151], v[152:155], v[96:111]
    v_lshlrev_b32 v2, 16, v135
    v_and_b32 v3, 0xffff0000, v135
    v_mfma_f32_32x32x16_bf16 v[112:127], v[148:151], v[156:159], v[112:127]
    v_add_f32 v28, v28, v2
    v_add_f32 v29, v29, v3
    s_waitcnt lgkmcnt(6)
    v_mfma_f32_32x32x16_bf16 v[64:79], v[32:35], v[40:43], v[64:79]
    ds_read_b64_tr_b16 v[128:129], v212 offset:0
    ds_read_b64_tr_b16 v[130:131], v212 offset:512
    ds_read_b128 v[136:139], v218 offset:0
    v_lshlrev_b32 v2, 16, v32
    v_and_b32 v3, 0xffff0000, v32
    v_xor_b32 v255, 8, v248
    v_mfma_f32_32x32x16_bf16 v[80:95], v[32:35], v[44:47], v[80:95]
    ds_read_b64_tr_b16 v[132:133], v213 offset:0
    ds_read_b64_tr_b16 v[134:135], v213 offset:512
    ds_read_b128 v[140:143], v218 offset:4096
    v_add_f32 v26, v26, v2
    v_add_f32 v27, v27, v3
    v_mfma_f32_32x32x16_bf16 v[96:111], v[36:39], v[40:43], v[96:111]
    v_lshlrev_b32 v2, 16, v33
    v_and_b32 v3, 0xffff0000, v33
    v_mfma_f32_32x32x16_bf16 v[112:127], v[36:39], v[44:47], v[112:127]
    v_add_f32 v26, v26, v2
    v_add_f32 v27, v27, v3
    s_waitcnt lgkmcnt(6)
    v_mfma_f32_32x32x16_bf16 v[64:79], v[48:51], v[56:59], v[64:79]
    ds_read_b64_tr_b16 v[144:145], v214 offset:0
    ds_read_b64_tr_b16 v[146:147], v214 offset:512
    ds_read_b128 v[152:155], v219 offset:0
    v_lshlrev_b32 v2, 16, v34
    v_and_b32 v3, 0xffff0000, v34
    v_mfma_f32_32x32x16_bf16 v[80:95], v[48:51], v[60:63], v[80:95]
    ds_read_b64_tr_b16 v[148:149], v215 offset:0
    ds_read_b64_tr_b16 v[150:151], v215 offset:512
    ds_read_b128 v[156:159], v219 offset:4096
    v_add_f32 v26, v26, v2
    v_add_f32 v27, v27, v3
    v_mfma_f32_32x32x16_bf16 v[96:111], v[52:55], v[56:59], v[96:111]
    v_lshlrev_b32 v2, 16, v35
    v_and_b32 v3, 0xffff0000, v35
    v_mfma_f32_32x32x16_bf16 v[112:127], v[52:55], v[60:63], v[112:127]
    v_add_f32 v26, v26, v2
    v_add_f32 v27, v27, v3
    s_waitcnt lgkmcnt(0)
    s_barrier
    v_mfma_f32_32x32x16_bf16 v[64:79], v[128:131], v[136:139], v[64:79]
    ds_read_b64_tr_b16 v[32:33], v220 offset:0
    ds_read_b64_tr_b16 v[34:35], v220 offset:512
    ds_read_b128 v[40:43], v228 offset:0
    v_lshlrev_b32 v2, 16, v132
    v_and_b32 v3, 0xffff0000, v132
    s_lshl_b32 s72, s69, 5
    s_lshl_b32 s73, s70, 2
    s_add_u32 s72, s72, s73
    v_mfma_f32_32x32x16_bf16 v[80:95], v[128:131], v[140:143], v[80:95]
    ds_read_b64_tr_b16 v[36:37], v221 offset:0
    ds_read_b64_tr_b16 v[38:39], v221 offset:512
    ds_read_b128 v[44:47], v228 offset:4096
    v_add_f32 v28, v28, v2
    v_add_f32 v29, v29, v3
    s_add_u32 s72, s72, s67
    s_lshl_b32 s72, s72, 2
    s_add_u32 s52, s72, 3112960
    v_mfma_f32_32x32x16_bf16 v[96:111], v[132:135], v[136:139], v[96:111]
    v_lshlrev_b32 v2, 16, v133
    v_and_b32 v3, 0xffff0000, v133
    s_and_b32 s55, s67, 2
    s_mul_i32 s53, s55, 43008
    s_add_u32 s53, s53, 2621440
    v_mfma_f32_32x32x16_bf16 v[112:127], v[132:135], v[140:143], v[112:127]
    v_add_f32 v28, v28, v2
    v_add_f32 v29, v29, v3
    s_lshl_b32 s54, s70, 3
    s_and_b32 s72, s67, 1
    v_mfma_f32_32x32x16_bf16 v[64:79], v[144:147], v[152:155], v[64:79]
    ds_read_b64_tr_b16 v[48:49], v222 offset:0
    ds_read_b64_tr_b16 v[50:51], v222 offset:512
    ds_read_b128 v[56:59], v229 offset:0
    v_lshlrev_b32 v2, 16, v134
    v_and_b32 v3, 0xffff0000, v134
    s_lshl_b32 s72, s72, 2
    s_add_u32 s54, s54, s72
    v_lshlrev_b32 v7, 4, v251
    v_mfma_f32_32x32x16_bf16 v[80:95], v[144:147], v[156:159], v[80:95]
    ds_read_b64_tr_b16 v[52:53], v223 offset:0
    ds_read_b64_tr_b16 v[54:55], v223 offset:512
    ds_read_b128 v[60:63], v229 offset:4096
    v_add_f32 v28, v28, v2
    v_add_f32 v29, v29, v3
    v_mov_b32 v8, 0x80000000
    s_xor_b32 s72, s55, 0
    s_add_u32 s72, s72, s54
    v_mfma_f32_32x32x16_bf16 v[96:111], v[148:151], v[152:155], v[96:111]
    v_lshlrev_b32 v2, 16, v135
    v_and_b32 v3, 0xffff0000, v135
    s_mul_i32 s72, s72, 5
    v_add_u32 v4, s72, v252
    v_lshrrev_b32 v5, 2, v4
    v_mfma_f32_32x32x16_bf16 v[112:127], v[148:151], v[156:159], v[112:127]
    v_add_f32 v28, v28, v2
    v_add_f32 v29, v29, v3
    v_lshl_add_u32 v5, v5, 10, v7
    v_and_b32 v6, 1, v4
    s_waitcnt lgkmcnt(6)
    v_mfma_f32_32x32x16_bf16 v[64:79], v[32:35], v[40:43], v[64:79]
    ds_read_b64_tr_b16 v[128:129], v224 offset:0
    ds_read_b64_tr_b16 v[130:131], v224 offset:512
    ds_read_b128 v[136:139], v230 offset:0
    v_lshlrev_b32 v2, 16, v32
    v_and_b32 v3, 0xffff0000, v32
    v_lshl_add_u32 v5, v6, 9, v5
    v_and_b32 v6, 2, v4
    v_lshl_add_u32 v168, v6, 2, v5
    v_mfma_f32_32x32x16_bf16 v[80:95], v[32:35], v[44:47], v[80:95]
    ds_read_b64_tr_b16 v[132:133], v225 offset:0
    ds_read_b64_tr_b16 v[134:135], v225 offset:512
    ds_read_b128 v[140:143], v230 offset:4096
    v_add_f32 v26, v26, v2
    v_add_f32 v27, v27, v3
    v_add_u32 v4, s72, v252
    v_add_u32 v4, 2, v4
    v_lshrrev_b32 v5, 2, v4
    v_mfma_f32_32x32x16_bf16 v[96:111], v[36:39], v[40:43], v[96:111]
    v_lshlrev_b32 v2, 16, v33
    v_and_b32 v3, 0xffff0000, v33
    v_lshl_add_u32 v5, v5, 10, v7
    v_and_b32 v6, 1, v4
    v_lshl_add_u32 v5, v6, 9, v5
    v_mfma_f32_32x32x16_bf16 v[112:127], v[36:39], v[44:47], v[112:127]
    v_add_f32 v26, v26, v2
    v_add_f32 v27, v27, v3
    v_and_b32 v6, 2, v4
    v_lshl_add_u32 v170, v6, 2, v5
    s_waitcnt lgkmcnt(6)
    v_mfma_f32_32x32x16_bf16 v[64:79], v[48:51], v[56:59], v[64:79]
    ds_read_b64_tr_b16 v[144:145], v226 offset:0
    ds_read_b64_tr_b16 v[146:147], v226 offset:512
    ds_read_b128 v[152:155], v231 offset:0
    v_lshlrev_b32 v2, 16, v34
    v_and_b32 v3, 0xffff0000, v34
    v_add_u32 v4, s72, v252
    v_add_u32 v4, 4, v4
    v_lshrrev_b32 v5, 2, v4
    v_mfma_f32_32x32x16_bf16 v[80:95], v[48:51], v[60:63], v[80:95]
    ds_read_b64_tr_b16 v[148:149], v227 offset:0
    ds_read_b64_tr_b16 v[150:151], v227 offset:512
    ds_read_b128 v[156:159], v231 offset:4096
    v_add_f32 v26, v26, v2
    v_add_f32 v27, v27, v3
    v_lshl_add_u32 v5, v5, 10, v7
    v_and_b32 v6, 1, v4
    v_lshl_add_u32 v5, v6, 9, v5
    v_mfma_f32_32x32x16_bf16 v[96:111], v[52:55], v[56:59], v[96:111]
    v_lshlrev_b32 v2, 16, v35
    v_and_b32 v3, 0xffff0000, v35
    v_and_b32 v6, 2, v4
    v_lshl_add_u32 v184, v6, 2, v5
    v_cndmask_b32 v184, v184, v8, s[92:93]
    v_mfma_f32_32x32x16_bf16 v[112:127], v[52:55], v[60:63], v[112:127]
    v_add_f32 v26, v26, v2
    v_add_f32 v27, v27, v3
    s_xor_b32 s72, s55, 1
    s_add_u32 s72, s72, s54
    s_waitcnt lgkmcnt(0)
    s_barrier
    v_mfma_f32_32x32x16_bf16 v[64:79], v[128:131], v[136:139], v[64:79]
    ds_read_b64_tr_b16 v[32:33], v10 offset:0
    ds_read_b64_tr_b16 v[34:35], v10 offset:512
    ds_read_b128 v[40:43], v18 offset:0
    v_lshlrev_b32 v2, 16, v132
    v_and_b32 v3, 0xffff0000, v132
    s_add_u32 s73, s54, s55
    s_mul_i32 s73, s73, 5
    s_mul_i32 s56, s69, 160
    s_add_u32 s56, s56, s73
    s_lshl_b32 s56, s56, 8
    s_add_u32 s56, s56, 9437184
    v_mov_b32 v204, -1
    v_mov_b32 v205, -1
    v_mov_b32 v206, -1
    v_mov_b32 v207, -1
    buffer_store_dwordx4 v[204:207], v253, s[44:47], s56 offen sc1
    buffer_store_dwordx4 v[204:207], v253, s[44:47], s56 offen offset:1024 sc1
    buffer_store_dwordx4 v[204:207], v253, s[44:47], s56 offen offset:1536 sc1
    s_mul_i32 s72, s72, 5
    v_add_u32 v4, s72, v252
    v_mfma_f32_32x32x16_bf16 v[80:95], v[128:131], v[140:143], v[80:95]
    ds_read_b64_tr_b16 v[36:37], v11 offset:0
    ds_read_b64_tr_b16 v[38:39], v11 offset:512
    ds_read_b128 v[44:47], v18 offset:4096
    v_add_f32 v28, v28, v2
    v_add_f32 v29, v29, v3
    v_lshrrev_b32 v5, 2, v4
    v_lshl_add_u32 v5, v5, 10, v7
    v_and_b32 v6, 1, v4
    v_mfma_f32_32x32x16_bf16 v[96:111], v[132:135], v[136:139], v[96:111]
    v_lshlrev_b32 v2, 16, v133
    v_and_b32 v3, 0xffff0000, v133
    v_lshl_add_u32 v5, v6, 9, v5
    v_and_b32 v6, 2, v4
    v_lshl_add_u32 v172, v6, 2, v5
    v_mfma_f32_32x32x16_bf16 v[112:127], v[132:135], v[140:143], v[112:127]
    v_add_f32 v28, v28, v2
    v_add_f32 v29, v29, v3
    v_add_u32 v4, s72, v252
    v_add_u32 v4, 2, v4
    v_lshrrev_b32 v5, 2, v4
    v_mfma_f32_32x32x16_bf16 v[64:79], v[144:147], v[152:155], v[64:79]
    ds_read_b64_tr_b16 v[48:49], v12 offset:0
    ds_read_b64_tr_b16 v[50:51], v12 offset:512
    ds_read_b128 v[56:59], v19 offset:0
    v_lshlrev_b32 v2, 16, v134
    v_and_b32 v3, 0xffff0000, v134
    v_lshl_add_u32 v5, v5, 10, v7
    v_and_b32 v6, 1, v4
    v_lshl_add_u32 v5, v6, 9, v5
    v_mfma_f32_32x32x16_bf16 v[80:95], v[144:147], v[156:159], v[80:95]
    ds_read_b64_tr_b16 v[52:53], v13 offset:0
    ds_read_b64_tr_b16 v[54:55], v13 offset:512
    ds_read_b128 v[60:63], v19 offset:4096
    v_add_f32 v28, v28, v2
    v_add_f32 v29, v29, v3
    v_and_b32 v6, 2, v4
    v_lshl_add_u32 v174, v6, 2, v5
    v_add_u32 v4, s72, v252
    v_mfma_f32_32x32x16_bf16 v[96:111], v[148:151], v[152:155], v[96:111]
    v_lshlrev_b32 v2, 16, v135
    v_and_b32 v3, 0xffff0000, v135
    v_add_u32 v4, 4, v4
    v_lshrrev_b32 v5, 2, v4
    v_lshl_add_u32 v5, v5, 10, v7
    v_mfma_f32_32x32x16_bf16 v[112:127], v[148:151], v[156:159], v[112:127]
    v_add_f32 v28, v28, v2
    v_add_f32 v29, v29, v3
    v_and_b32 v6, 1, v4
    v_lshl_add_u32 v5, v6, 9, v5
    v_and_b32 v6, 2, v4
    s_waitcnt lgkmcnt(6)
    v_mfma_f32_32x32x16_bf16 v[64:79], v[32:35], v[40:43], v[64:79]
    ds_read_b64_tr_b16 v[128:129], v14 offset:0
    ds_read_b64_tr_b16 v[130:131], v14 offset:512
    ds_read_b128 v[136:139], v20 offset:0
    v_lshlrev_b32 v2, 16, v32
    v_and_b32 v3, 0xffff0000, v32
    v_lshl_add_u32 v186, v6, 2, v5
    v_cndmask_b32 v186, v186, v8, s[92:93]
    s_xor_b32 s72, s55, 2
    v_mfma_f32_32x32x16_bf16 v[80:95], v[32:35], v[44:47], v[80:95]
    ds_read_b64_tr_b16 v[132:133], v15 offset:0
    ds_read_b64_tr_b16 v[134:135], v15 offset:512
    ds_read_b128 v[140:143], v20 offset:4096
    v_add_f32 v26, v26, v2
    v_add_f32 v27, v27, v3
    s_add_u32 s72, s72, s54
    s_mul_i32 s72, s72, 5
    v_add_u32 v4, s72, v252
    v_mfma_f32_32x32x16_bf16 v[96:111], v[36:39], v[40:43], v[96:111]
    v_lshlrev_b32 v2, 16, v33
    v_and_b32 v3, 0xffff0000, v33
    v_lshrrev_b32 v5, 2, v4
    v_lshl_add_u32 v5, v5, 10, v7
    v_and_b32 v6, 1, v4
    v_mfma_f32_32x32x16_bf16 v[112:127], v[36:39], v[44:47], v[112:127]
    v_add_f32 v26, v26, v2
    v_add_f32 v27, v27, v3
    v_lshl_add_u32 v5, v6, 9, v5
    v_and_b32 v6, 2, v4
    v_lshl_add_u32 v176, v6, 2, v5
    s_waitcnt lgkmcnt(6)
    v_mfma_f32_32x32x16_bf16 v[64:79], v[48:51], v[56:59], v[64:79]
    ds_read_b64_tr_b16 v[144:145], v16 offset:0
    ds_read_b64_tr_b16 v[146:147], v16 offset:512
    ds_read_b128 v[152:155], v21 offset:0
    v_lshlrev_b32 v2, 16, v34
    v_and_b32 v3, 0xffff0000, v34
    v_add_u32 v4, s72, v252
    v_add_u32 v4, 2, v4
    v_lshrrev_b32 v5, 2, v4
    v_mfma_f32_32x32x16_bf16 v[80:95], v[48:51], v[60:63], v[80:95]
    ds_read_b64_tr_b16 v[148:149], v17 offset:0
    ds_read_b64_tr_b16 v[150:151], v17 offset:512
    ds_read_b128 v[156:159], v21 offset:4096
    v_add_f32 v26, v26, v2
    v_add_f32 v27, v27, v3
    v_lshl_add_u32 v5, v5, 10, v7
    v_and_b32 v6, 1, v4
    v_lshl_add_u32 v5, v6, 9, v5
    v_mfma_f32_32x32x16_bf16 v[96:111], v[52:55], v[56:59], v[96:111]
    v_lshlrev_b32 v2, 16, v35
    v_and_b32 v3, 0xffff0000, v35
    v_and_b32 v6, 2, v4
    v_lshl_add_u32 v178, v6, 2, v5
    v_add_u32 v4, s72, v252
    v_mfma_f32_32x32x16_bf16 v[112:127], v[52:55], v[60:63], v[112:127]
    v_add_f32 v26, v26, v2
    v_add_f32 v27, v27, v3
    s_waitcnt lgkmcnt(0)
    s_barrier
    v_mfma_f32_32x32x16_bf16 v[64:79], v[128:131], v[136:139], v[64:79]
    ds_read_b64_tr_b16 v[32:33], v208 offset:0
    ds_read_b64_tr_b16 v[34:35], v208 offset:512
    ds_read_b128 v[40:43], v216 offset:0
    v_lshlrev_b32 v2, 16, v132
    v_and_b32 v3, 0xffff0000, v132
    v_add_u32 v4, 4, v4
    v_lshrrev_b32 v5, 2, v4
    v_lshl_add_u32 v5, v5, 10, v7
    v_mfma_f32_32x32x16_bf16 v[80:95], v[128:131], v[140:143], v[80:95]
    ds_read_b64_tr_b16 v[36:37], v209 offset:0
    ds_read_b64_tr_b16 v[38:39], v209 offset:512
    ds_read_b128 v[44:47], v216 offset:4096
    v_add_f32 v28, v28, v2
    v_add_f32 v29, v29, v3
    v_and_b32 v6, 1, v4
    v_lshl_add_u32 v5, v6, 9, v5
    v_and_b32 v6, 2, v4
    v_mfma_f32_32x32x16_bf16 v[96:111], v[132:135], v[136:139], v[96:111]
    v_lshlrev_b32 v2, 16, v133
    v_and_b32 v3, 0xffff0000, v133
    v_lshl_add_u32 v188, v6, 2, v5
    v_cndmask_b32 v188, v188, v8, s[92:93]
    s_xor_b32 s72, s55, 3
    v_mfma_f32_32x32x16_bf16 v[112:127], v[132:135], v[140:143], v[112:127]
    v_add_f32 v28, v28, v2
    v_add_f32 v29, v29, v3
    s_add_u32 s72, s72, s54
    s_mul_i32 s72, s72, 5
    v_mfma_f32_32x32x16_bf16 v[64:79], v[144:147], v[152:155], v[64:79]
    ds_read_b64_tr_b16 v[48:49], v210 offset:0
    ds_read_b64_tr_b16 v[50:51], v210 offset:512
    ds_read_b128 v[56:59], v217 offset:0
    v_lshlrev_b32 v2, 16, v134
    v_and_b32 v3, 0xffff0000, v134
    v_add_u32 v4, s72, v252
    v_lshrrev_b32 v5, 2, v4
    v_lshl_add_u32 v5, v5, 10, v7
    v_mfma_f32_32x32x16_bf16 v[80:95], v[144:147], v[156:159], v[80:95]
    ds_read_b64_tr_b16 v[52:53], v211 offset:0
    ds_read_b64_tr_b16 v[54:55], v211 offset:512
    ds_read_b128 v[60:63], v217 offset:4096
    v_add_f32 v28, v28, v2
    v_add_f32 v29, v29, v3
    v_and_b32 v6, 1, v4
    v_lshl_add_u32 v5, v6, 9, v5
    v_and_b32 v6, 2, v4
    v_mfma_f32_32x32x16_bf16 v[96:111], v[148:151], v[152:155], v[96:111]
    v_lshlrev_b32 v2, 16, v135
    v_and_b32 v3, 0xffff0000, v135
    v_lshl_add_u32 v180, v6, 2, v5
    v_add_u32 v4, s72, v252
    v_add_u32 v4, 2, v4
    v_mfma_f32_32x32x16_bf16 v[112:127], v[148:151], v[156:159], v[112:127]
    v_add_f32 v28, v28, v2
    v_add_f32 v29, v29, v3
    v_lshrrev_b32 v5, 2, v4
    v_lshl_add_u32 v5, v5, 10, v7
    s_waitcnt lgkmcnt(6)
    v_mfma_f32_32x32x16_bf16 v[64:79], v[32:35], v[40:43], v[64:79]
    ds_read_b64_tr_b16 v[128:129], v212 offset:0
    ds_read_b64_tr_b16 v[130:131], v212 offset:512
    ds_read_b128 v[136:139], v218 offset:0
    v_lshlrev_b32 v2, 16, v32
    v_and_b32 v3, 0xffff0000, v32
    v_and_b32 v6, 1, v4
    v_lshl_add_u32 v5, v6, 9, v5
    v_and_b32 v6, 2, v4
    v_mfma_f32_32x32x16_bf16 v[80:95], v[32:35], v[44:47], v[80:95]
    ds_read_b64_tr_b16 v[132:133], v213 offset:0
    ds_read_b64_tr_b16 v[134:135], v213 offset:512
    ds_read_b128 v[140:143], v218 offset:4096
    v_add_f32 v26, v26, v2
    v_add_f32 v27, v27, v3
    v_lshl_add_u32 v182, v6, 2, v5
    v_add_u32 v4, s72, v252
    v_add_u32 v4, 4, v4
    v_mfma_f32_32x32x16_bf16 v[96:111], v[36:39], v[40:43], v[96:111]
    v_lshlrev_b32 v2, 16, v33
    v_and_b32 v3, 0xffff0000, v33
    v_lshrrev_b32 v5, 2, v4
    v_lshl_add_u32 v5, v5, 10, v7
    v_and_b32 v6, 1, v4
    v_mfma_f32_32x32x16_bf16 v[112:127], v[36:39], v[44:47], v[112:127]
    v_add_f32 v26, v26, v2
    v_add_f32 v27, v27, v3
    v_lshl_add_u32 v5, v6, 9, v5
    v_and_b32 v6, 2, v4
    s_waitcnt lgkmcnt(6)
    v_mfma_f32_32x32x16_bf16 v[64:79], v[48:51], v[56:59], v[64:79]
    ds_read_b64_tr_b16 v[144:145], v214 offset:0
    ds_read_b64_tr_b16 v[146:147], v214 offset:512
    ds_read_b128 v[152:155], v219 offset:0
    v_lshlrev_b32 v2, 16, v34
    v_and_b32 v3, 0xffff0000, v34
    v_lshl_add_u32 v190, v6, 2, v5
    v_cndmask_b32 v190, v190, v8, s[92:93]
    s_lshl_b32 s72, s67, 13
    v_mfma_f32_32x32x16_bf16 v[80:95], v[48:51], v[60:63], v[80:95]
    ds_read_b64_tr_b16 v[148:149], v215 offset:0
    ds_read_b64_tr_b16 v[150:151], v215 offset:512
    ds_read_b128 v[156:159], v219 offset:4096
    v_add_f32 v26, v26, v2
    v_add_f32 v27, v27, v3
    s_add_u32 s72, s72, 122880
    s_xor_b32 s73, s67, 2
    s_lshl_b32 s73, s73, 13
    v_mfma_f32_32x32x16_bf16 v[96:111], v[52:55], v[56:59], v[96:111]
    v_lshlrev_b32 v2, 16, v35
    v_and_b32 v3, 0xffff0000, v35
    s_add_u32 s73, s73, 122880
    v_add_u32 v22, s72, v253
    v_add_u32 v23, s73, v253
    v_mfma_f32_32x32x16_bf16 v[112:127], v[52:55], v[60:63], v[112:127]
    v_add_f32 v26, v26, v2
    v_add_f32 v27, v27, v3
    s_waitcnt lgkmcnt(0)
    s_barrier
    s_waitcnt vmcnt(0)
    s_mov_b64 exec, 1
    buffer_store_dword v203, v242, s[44:47], s52 offen sc1
    s_mov_b64 exec, -1
    s_cmp_lg_u32 s3, 4
    s_cbranch_scc1 L1_hk
    s_lshl_b32 s72, s71, 3
    s_add_u32 s83, s72, 3080192
    buffer_load_dwordx4 v[160:163], v253, s[44:47], s83 offen sc1
    buffer_load_dwordx4 v[164:167], v253, s[44:47], s83 offen offset:1024 sc1
L1_hk:
    v_mfma_f32_32x32x16_bf16 v[64:79], v[128:131], v[136:139], v[64:79]
    ds_read_b64_tr_b16 v[32:33], v220 offset:0
    ds_read_b64_tr_b16 v[34:35], v220 offset:512
    ds_read_b128 v[40:43], v228 offset:0
    v_lshlrev_b32 v2, 16, v132
    v_and_b32 v3, 0xffff0000, v132
    v_mfma_f32_32x32x16_bf16 v[80:95], v[128:131], v[140:143], v[80:95]
    ds_read_b64_tr_b16 v[36:37], v221 offset:0
    ds_read_b64_tr_b16 v[38:39], v221 offset:512
    ds_read_b128 v[44:47], v228 offset:4096
    v_add_f32 v28, v28, v2
    v_add_f32 v29, v29, v3
    v_mfma_f32_32x32x16_bf16 v[96:111], v[132:135], v[136:139], v[96:111]
    v_lshlrev_b32 v2, 16, v133
    v_and_b32 v3, 0xffff0000, v133
    v_mfma_f32_32x32x16_bf16 v[112:127], v[132:135], v[140:143], v[112:127]
    v_add_f32 v28, v28, v2
    v_add_f32 v29, v29, v3
    v_mfma_f32_32x32x16_bf16 v[64:79], v[144:147], v[152:155], v[64:79]
    ds_read_b64_tr_b16 v[48:49], v222 offset:0
    ds_read_b64_tr_b16 v[50:51], v222 offset:512
    ds_read_b128 v[56:59], v229 offset:0
    v_lshlrev_b32 v2, 16, v134
    v_and_b32 v3, 0xffff0000, v134
    v_mfma_f32_32x32x16_bf16 v[80:95], v[144:147], v[156:159], v[80:95]
    ds_read_b64_tr_b16 v[52:53], v223 offset:0
    ds_read_b64_tr_b16 v[54:55], v223 offset:512
    ds_read_b128 v[60:63], v229 offset:4096
    v_add_f32 v28, v28, v2
    v_add_f32 v29, v29, v3
    v_mfma_f32_32x32x16_bf16 v[96:111], v[148:151], v[152:155], v[96:111]
    v_lshlrev_b32 v2, 16, v135
    v_and_b32 v3, 0xffff0000, v135
    v_mfma_f32_32x32x16_bf16 v[112:127], v[148:151], v[156:159], v[112:127]
    v_add_f32 v28, v28, v2
    v_add_f32 v29, v29, v3
    s_waitcnt lgkmcnt(6)
    v_mfma_f32_32x32x16_bf16 v[64:79], v[32:35], v[40:43], v[64:79]
    ds_read_b64_tr_b16 v[128:129], v224 offset:0
    ds_read_b64_tr_b16 v[130:131], v224 offset:512
    ds_read_b128 v[136:139], v230 offset:0
    v_lshlrev_b32 v2, 16, v32
    v_and_b32 v3, 0xffff0000, v32
    v_mfma_f32_32x32x16_bf16 v[80:95], v[32:35], v[44:47], v[80:95]
    ds_read_b64_tr_b16 v[132:133], v225 offset:0
    ds_read_b64_tr_b16 v[134:135], v225 offset:512
    ds_read_b128 v[140:143], v230 offset:4096
    v_add_f32 v26, v26, v2
    v_add_f32 v27, v27, v3
    v_mfma_f32_32x32x16_bf16 v[96:111], v[36:39], v[40:43], v[96:111]
    v_lshlrev_b32 v2, 16, v33
    v_and_b32 v3, 0xffff0000, v33
    v_mfma_f32_32x32x16_bf16 v[112:127], v[36:39], v[44:47], v[112:127]
    v_add_f32 v26, v26, v2
    v_add_f32 v27, v27, v3
    s_waitcnt lgkmcnt(6)
    v_mfma_f32_32x32x16_bf16 v[64:79], v[48:51], v[56:59], v[64:79]
    ds_read_b64_tr_b16 v[144:145], v226 offset:0
    ds_read_b64_tr_b16 v[146:147], v226 offset:512
    ds_read_b128 v[152:155], v231 offset:0
    v_lshlrev_b32 v2, 16, v34
    v_and_b32 v3, 0xffff0000, v34
    v_mfma_f32_32x32x16_bf16 v[80:95], v[48:51], v[60:63], v[80:95]
    ds_read_b64_tr_b16 v[148:149], v227 offset:0
    ds_read_b64_tr_b16 v[150:151], v227 offset:512
    ds_read_b128 v[156:159], v231 offset:4096
    v_add_f32 v26, v26, v2
    v_add_f32 v27, v27, v3
    v_mfma_f32_32x32x16_bf16 v[96:111], v[52:55], v[56:59], v[96:111]
    v_lshlrev_b32 v2, 16, v35
    v_and_b32 v3, 0xffff0000, v35
    v_mfma_f32_32x32x16_bf16 v[112:127], v[52:55], v[60:63], v[112:127]
    v_add_f32 v26, v26, v2
    v_add_f32 v27, v27, v3
    s_waitcnt lgkmcnt(0)
    s_barrier
    s_cmp_lg_u32 s3, 4
    s_cbranch_scc1 L2_hk
    s_call_b64 s[76:77], L_stats
    s_lshr_b32 s73, s69, 2
    s_lshl_b32 s73, s73, 9
    v_and_b32 v2, 3, v250
    v_lshl_add_u32 v2, v2, 7, s73
    v_and_b32 v3, 15, v250
    v_lshlrev_b32 v3, 9, v3
    v_add_u32 v3, 384, v3
    s_mov_b32 s72, 2949120
    v_cndmask_b32 v2, v3, v2, s[92:93]
    buffer_load_dword v249, v2, s[44:47], s72 offen sc1
L2_hk:
    v_mfma_f32_32x32x16_bf16 v[64:79], v[128:131], v[136:139], v[64:79]
    ds_read_b64_tr_b16 v[32:33], v10 offset:0
    ds_read_b64_tr_b16 v[34:35], v10 offset:512
    ds_read_b128 v[40:43], v18 offset:0
    v_lshlrev_b32 v2, 16, v132
    v_and_b32 v3, 0xffff0000, v132
    v_mfma_f32_32x32x16_bf16 v[80:95], v[128:131], v[140:143], v[80:95]
    ds_read_b64_tr_b16 v[36:37], v11 offset:0
    ds_read_b64_tr_b16 v[38:39], v11 offset:512
    ds_read_b128 v[44:47], v18 offset:4096
    v_add_f32 v28, v28, v2
    v_add_f32 v29, v29, v3
    v_mfma_f32_32x32x16_bf16 v[96:111], v[132:135], v[136:139], v[96:111]
    v_lshlrev_b32 v2, 16, v133
    v_and_b32 v3, 0xffff0000, v133
    v_mfma_f32_32x32x16_bf16 v[112:127], v[132:135], v[140:143], v[112:127]
    v_add_f32 v28, v28, v2
    v_add_f32 v29, v29, v3
    v_mfma_f32_32x32x16_bf16 v[64:79], v[144:147], v[152:155], v[64:79]
    ds_read_b64_tr_b16 v[48:49], v12 offset:0
    ds_read_b64_tr_b16 v[50:51], v12 offset:512
    ds_read_b128 v[56:59], v19 offset:0
    v_lshlrev_b32 v2, 16, v134
    v_and_b32 v3, 0xffff0000, v134
    v_mfma_f32_32x32x16_bf16 v[80:95], v[144:147], v[156:159], v[80:95]
    ds_read_b64_tr_b16 v[52:53], v13 offset:0
    ds_read_b64_tr_b16 v[54:55], v13 offset:512
    ds_read_b128 v[60:63], v19 offset:4096
    v_add_f32 v28, v28, v2
    v_add_f32 v29, v29, v3
    v_mfma_f32_32x32x16_bf16 v[96:111], v[148:151], v[152:155], v[96:111]
    v_lshlrev_b32 v2, 16, v135
    v_and_b32 v3, 0xffff0000, v135
    v_mfma_f32_32x32x16_bf16 v[112:127], v[148:151], v[156:159], v[112:127]
    v_add_f32 v28, v28, v2
    v_add_f32 v29, v29, v3
    s_waitcnt lgkmcnt(6)
    v_mfma_f32_32x32x16_bf16 v[64:79], v[32:35], v[40:43], v[64:79]
    ds_read_b64_tr_b16 v[128:129], v14 offset:0
    ds_read_b64_tr_b16 v[130:131], v14 offset:512
    ds_read_b128 v[136:139], v20 offset:0
    v_lshlrev_b32 v2, 16, v32
    v_and_b32 v3, 0xffff0000, v32
    v_mfma_f32_32x32x16_bf16 v[80:95], v[32:35], v[44:47], v[80:95]
    ds_read_b64_tr_b16 v[132:133], v15 offset:0
    ds_read_b64_tr_b16 v[134:135], v15 offset:512
    ds_read_b128 v[140:143], v20 offset:4096
    v_add_f32 v26, v26, v2
    v_add_f32 v27, v27, v3
    v_mfma_f32_32x32x16_bf16 v[96:111], v[36:39], v[40:43], v[96:111]
    v_lshlrev_b32 v2, 16, v33
    v_and_b32 v3, 0xffff0000, v33
    v_mfma_f32_32x32x16_bf16 v[112:127], v[36:39], v[44:47], v[112:127]
    v_add_f32 v26, v26, v2
    v_add_f32 v27, v27, v3
    s_waitcnt lgkmcnt(6)
    v_mfma_f32_32x32x16_bf16 v[64:79], v[48:51], v[56:59], v[64:79]
    ds_read_b64_tr_b16 v[144:145], v16 offset:0
    ds_read_b64_tr_b16 v[146:147], v16 offset:512
    ds_read_b128 v[152:155], v21 offset:0
    v_lshlrev_b32 v2, 16, v34
    v_and_b32 v3, 0xffff0000, v34
    v_mfma_f32_32x32x16_bf16 v[80:95], v[48:51], v[60:63], v[80:95]
    ds_read_b64_tr_b16 v[148:149], v17 offset:0
    ds_read_b64_tr_b16 v[150:151], v17 offset:512
    ds_read_b128 v[156:159], v21 offset:4096
    v_add_f32 v26, v26, v2
    v_add_f32 v27, v27, v3
    v_mfma_f32_32x32x16_bf16 v[96:111], v[52:55], v[56:59], v[96:111]
    v_lshlrev_b32 v2, 16, v35
    v_and_b32 v3, 0xffff0000, v35
    v_mfma_f32_32x32x16_bf16 v[112:127], v[52:55], v[60:63], v[112:127]
    v_add_f32 v26, v26, v2
    v_add_f32 v27, v27, v3
    s_waitcnt lgkmcnt(0)
L_gu_fin:
    v_mfma_f32_32x32x16_bf16 v[64:79], v[128:131], v[136:139], v[64:79]
    v_lshlrev_b32 v2, 16, v132
    v_and_b32 v3, 0xffff0000, v132
    v_add_f32 v28, v28, v2
    v_add_f32 v29, v29, v3
    v_mfma_f32_32x32x16_bf16 v[80:95], v[128:131], v[140:143], v[80:95]
    v_lshlrev_b32 v2, 16, v133
    v_and_b32 v3, 0xffff0000, v133
    v_add_f32 v28, v28, v2
    v_add_f32 v29, v29, v3
    v_mfma_f32_32x32x16_bf16 v[96:111], v[132:135], v[136:139], v[96:111]
    v_lshlrev_b32 v2, 16, v134
    v_and_b32 v3, 0xffff0000, v134
    v_add_f32 v28, v28, v2
    v_add_f32 v29, v29, v3
    v_mfma_f32_32x32x16_bf16 v[112:127], v[132:135], v[140:143], v[112:127]
    v_lshlrev_b32 v2, 16, v135
    v_and_b32 v3, 0xffff0000, v135
    v_add_f32 v28, v28, v2
    v_add_f32 v29, v29, v3
    v_mfma_f32_32x32x16_bf16 v[64:79], v[144:147], v[152:155], v[64:79]
    v_mfma_f32_32x32x16_bf16 v[80:95], v[144:147], v[156:159], v[80:95]
    v_mfma_f32_32x32x16_bf16 v[96:111], v[148:151], v[152:155], v[96:111]
    v_mfma_f32_32x32x16_bf16 v[112:127], v[148:151], v[156:159], v[112:127]
    s_mul_i32 s74, s101, 2
    s_lshl_b32 s72, s74, 10
    s_add_u32 s72, s72, 122880
    v_add_u32 v1, s72, v253
    s_lshl_b32 s73, s100, 2
    v_add_u32 v9, s73, v1
    v_add_f32 v2, v26, v27
    v_add_f32 v3, v28, v29
    v_cvt_pk_bf16_f32 v5, v2, v2
    v_cvt_pk_bf16_f32 v6, v3, v3
    v_lshlrev_b32 v5, 16, v5
    v_lshlrev_b32 v6, 16, v6
    v_sub_f32 v5, v2, v5
    v_sub_f32 v6, v3, v6
    v_cvt_pk_bf16_f32 v5, v2, v5
    ds_write_b32 v9, v5 offset:0
    v_cvt_pk_bf16_f32 v6, v3, v6
    ds_write_b32 v9, v6 offset:1024
    s_cmp_lg_u32 s3, 4
    s_cbranch_scc1 L3_nost
    s_waitcnt vmcnt(0)
    v_cmp_ne_u32 vcc, s79, v249
    s_cmp_eq_u64 vcc, 0
    s_cbranch_scc0 L3_nost
    v_mov_b32 v2, 155712
    v_mov_b32 v3, 1
    ds_write_b32 v2, v3
L3_nost:
    s_lshl_b32 s73, s100, 9
    s_add_u32 s73, s73, 148224
    v_lshl_add_u32 v5, v251, 3, s73
    v_mov_b32 v6, 155712
    s_waitcnt lgkmcnt(0)
    s_barrier
    ds_read_b64 v[160:161], v5 offset:0
    ds_read_b64 v[164:165], v5 offset:256
    ds_read_b128 v[10:13], v1 offset:0
    ds_read_b128 v[14:17], v1 offset:1024
    ds_read_b32 v4, v6
    s_cmp_eq_u32 s68, 0
    s_cbranch_scc1 L_gu_np
    s_setprio 2
L_gu_np:
    s_waitcnt lgkmcnt(3)
    v_mov_b32 v26, v161
    v_mov_b32 v161, v160
    v_mov_b32 v162, v160
    v_mov_b32 v163, v160
    v_mov_b32 v27, v165
    v_mov_b32 v165, v164
    v_mov_b32 v166, v164
    v_mov_b32 v167, v164
    s_waitcnt lgkmcnt(0)
    s_nop 0
    v_mfma_f32_32x32x16_bf16 v[64:79], v[10:13], v[160:163], v[64:79]
    v_mfma_f32_32x32x16_bf16 v[96:111], v[14:17], v[160:163], v[96:111]
    v_mfma_f32_32x32x16_bf16 v[80:95], v[10:13], v[164:167], v[80:95]
    v_mfma_f32_32x32x16_bf16 v[112:127], v[14:17], v[164:167], v[112:127]
    v_readfirstlane_b32 s86, v4
    v_mul_f32 v26, v26, v26
    v_mul_f32 v28, v27, v27
    s_and_b32 s86, s86, s68
    s_cmp_eq_u32 s86, 1
    s_cbranch_scc0 L_gu_ne
    s_call_b64 s[76:77], L_attn_loads
L_gu_ne:
    s_lshr_b32 s72, s71, 5
    s_lshl_b32 s73, s100, 1
    s_add_u32 s72, s72, s73
    s_mul_i32 s72, s72, 96
    s_lshl_b32 s73, s87, 2
    s_add_u32 s72, s72, s73
    s_add_u32 s72, s72, s74
    s_lshl_b32 s72, s72, 10
    s_add_u32 s72, s72, 3145728
    s_add_u32 s73, s72, 98304
    s_mov_b64 s[88:89], s[72:73]
    s_nop 0
    v_pk_mul_f32 v[64:65], v[64:65], v[26:27] op_sel_hi:[1,0]
    v_pk_mul_f32 v[66:67], v[66:67], v[26:27] op_sel_hi:[1,0]
    v_pk_mul_f32 v[68:69], v[68:69], v[26:27] op_sel_hi:[1,0]
    v_pk_mul_f32 v[70:71], v[70:71], v[26:27] op_sel_hi:[1,0]
    v_pk_mul_f32 v[64:65], v[64:65], v[72:73]
    v_pk_mul_f32 v[66:67], v[66:67], v[74:75]
    v_pk_mul_f32 v[68:69], v[68:69], v[76:77]
    v_pk_mul_f32 v[70:71], v[70:71], v[78:79]
    v_cvt_pk_bf16_f32 v64, v64, v65
    v_cvt_pk_bf16_f32 v65, v66, v67
    v_cvt_pk_bf16_f32 v66, v68, v69
    v_cvt_pk_bf16_f32 v67, v70, v71
    v_pk_mul_f32 v[96:97], v[96:97], v[26:27] op_sel_hi:[1,0]
    v_pk_mul_f32 v[98:99], v[98:99], v[26:27] op_sel_hi:[1,0]
    v_pk_mul_f32 v[100:101], v[100:101], v[26:27] op_sel_hi:[1,0]
    v_pk_mul_f32 v[102:103], v[102:103], v[26:27] op_sel_hi:[1,0]
    v_pk_mul_f32 v[96:97], v[96:97], v[104:105]
    v_pk_mul_f32 v[98:99], v[98:99], v[106:107]
    v_pk_mul_f32 v[100:101], v[100:101], v[108:109]
    v_pk_mul_f32 v[102:103], v[102:103], v[110:111]
    v_cvt_pk_bf16_f32 v96, v96, v97
    v_cvt_pk_bf16_f32 v97, v98, v99
    v_cvt_pk_bf16_f32 v98, v100, v101
    v_cvt_pk_bf16_f32 v99, v102, v103
    v_pk_mul_f32 v[80:81], v[80:81], v[28:29] op_sel_hi:[1,0]
    v_pk_mul_f32 v[82:83], v[82:83], v[28:29] op_sel_hi:[1,0]
    v_pk_mul_f32 v[84:85], v[84:85], v[28:29] op_sel_hi:[1,0]
    v_pk_mul_f32 v[86:87], v[86:87], v[28:29] op_sel_hi:[1,0]
    v_pk_mul_f32 v[80:81], v[80:81], v[88:89]
    v_pk_mul_f32 v[82:83], v[82:83], v[90:91]
    v_pk_mul_f32 v[84:85], v[84:85], v[92:93]
    v_pk_mul_f32 v[86:87], v[86:87], v[94:95]
    v_cvt_pk_bf16_f32 v80, v80, v81
    v_cvt_pk_bf16_f32 v81, v82, v83
    v_cvt_pk_bf16_f32 v82, v84, v85
    v_cvt_pk_bf16_f32 v83, v86, v87
    v_pk_mul_f32 v[112:113], v[112:113], v[28:29] op_sel_hi:[1,0]
    v_pk_mul_f32 v[114:115], v[114:115], v[28:29] op_sel_hi:[1,0]
    v_pk_mul_f32 v[116:117], v[116:117], v[28:29] op_sel_hi:[1,0]
    v_pk_mul_f32 v[118:119], v[118:119], v[28:29] op_sel_hi:[1,0]
    v_pk_mul_f32 v[112:113], v[112:113], v[120:121]
    v_pk_mul_f32 v[114:115], v[114:115], v[122:123]
    v_pk_mul_f32 v[116:117], v[116:117], v[124:125]
    v_pk_mul_f32 v[118:119], v[118:119], v[126:127]
    v_cvt_pk_bf16_f32 v112, v112, v113
    v_cvt_pk_bf16_f32 v113, v114, v115
    v_cvt_pk_bf16_f32 v114, v116, v117
    v_cvt_pk_bf16_f32 v115, v118, v119
    s_branch L_p2
L_p2:
    v_mov_b32 v15, 1
    v_mov_b32 v14, s79
    s_cmp_lg_u32 s68, 0
    s_cbranch_scc1 L_attn
    s_mov_b32 s52, s32
    s_mov_b32 s53, s33
    s_mov_b32 s54, 1966080
    s_mov_b32 s55, 0x00020000
    s_mov_b32 s56, s38
    s_mov_b32 s57, s39
    s_mov_b32 s58, 17825792
    s_mov_b32 s59, 0x00020000
    s_mov_b32 s60, s34
    s_mov_b32 s61, s35
    s_mov_b32 s62, 2621440
    s_mov_b32 s63, 0x00020000
    s_mul_i32 s78, s67, 491520
    s_mul_i32 s80, s67, 30720
    s_mul_i32 s82, s69, 96
    s_mul_i32 s72, s67, 24
    s_add_u32 s82, s82, s72
    s_lshl_b32 s82, s82, 10
    s_add_u32 s82, s82, 3145728
    s_and_b32 s83, s69, 3
    s_mul_i32 s72, s83, 122880
    s_add_u32 s78, s78, s72
    s_mul_i32 s72, s83, 6144
    s_add_u32 s82, s82, s72
    v_mov_b32 v2, 155760
L12_lw:
    ds_read_b128 v[4:7], v2
    s_waitcnt lgkmcnt(0)
    v_bitop3_b32 v4, v4, v5, v6 bitop3:0x80
    v_and_b32 v4, v4, v7
    s_nop 0
    v_readfirstlane_b32 s76, v4
    s_nop 0
    s_cmp_eq_u32 s76, 1
    s_cbranch_scc1 L12_lw_d
    s_sleep 2
    s_branch L12_lw
L12_lw_d:
    s_cmp_ge_u32 s66, 24
    s_cbranch_scc1 L13_hs
    buffer_store_dwordx4 v[64:67], v253, s[44:47], s88 offen offset:0 sc1
    buffer_store_dwordx4 v[96:99], v253, s[44:47], s88 offen offset:1024 sc1
    buffer_store_dwordx4 v[80:83], v253, s[44:47], s89 offen offset:0 sc1
    buffer_store_dwordx4 v[112:115], v253, s[44:47], s89 offen offset:1024 sc1
L13_hs:
    s_lshl_b32 s72, s69, 5
    s_lshl_b32 s73, s67, 3
    s_add_u32 s72, s72, s73
    s_mul_i32 s84, s72, 1280
    s_mul_i32 s72, s67, 2560
    s_add_u32 m0, s72, 122880
    v_add_u32 v191, s72, v253
    v_add_u32 v191, 122880, v191
    buffer_load_dwordx4 v168, s[40:43], s84 offen offset:0 lds
    buffer_load_dwordx4 v169, s[40:43], s84 offen offset:1024 lds
    s_mov_b32 exec_hi, 0
    buffer_load_dwordx4 v170, s[40:43], s84 offen offset:2048 lds
    s_mov_b32 exec_hi, -1
    v_mfma_f32_32x32x16_bf16 v[64:79], v[244:247], v[244:247], 0
    v_mfma_f32_32x32x16_bf16 v[80:95], v[244:247], v[244:247], 0
    v_mfma_f32_32x32x16_bf16 v[96:111], v[244:247], v[244:247], 0
    v_mfma_f32_32x32x16_bf16 v[112:127], v[244:247], v[244:247], 0
    v_mfma_f32_32x32x16_bf16 v[128:143], v[244:247], v[244:247], 0
    v_mul_u32_u24 v177, 320, v251
    v_lshl_add_u32 v177, v252, 3, v177
    s_lshl_b32 s72, s67, 4
    s_add_u32 s72, s72, 122880
    v_add_u32 v177, s72, v177
    s_waitcnt vmcnt(0)
    ds_write_b32 v248, v15
    s_cmp_lg_u32 s3, 0
    s_cbranch_scc1 L_l_ring
    s_cmp_ge_u32 s66, 24
    s_cbranch_scc1 L_l_ring
    v_mov_b32 v2, 155648
L14_lw:
    ds_read_b128 v[4:7], v2
    ds_read_b128 v[8:11], v2 offset:16
    s_waitcnt lgkmcnt(0)
    v_bitop3_b32 v4, v4, v5, v6 bitop3:0x80
    v_bitop3_b32 v8, v8, v9, v10 bitop3:0x80
    v_bitop3_b32 v4, v4, v8, v11 bitop3:0x80
    v_and_b32 v4, v4, v7
    s_nop 0
    v_readfirstlane_b32 s76, v4
    s_nop 0
    s_cmp_eq_u32 s76, 1
    s_cbranch_scc1 L14_lw_d
    s_sleep 1
    s_branch L14_lw
L14_lw_d:
    s_lshl_b32 s72, s71, 4
    s_lshl_b32 s73, s87, 7
    s_add_u32 s72, s72, s73
    s_add_u32 s72, s72, 2965504
    s_mov_b64 exec, 1
    buffer_store_dword v14, v244, s[44:47], s72 offen sc1
    s_mov_b64 exec, -1
L_l_ring:
    s_add_u32 m0, s80, 0
    s_add_u32 s74, s80, 4096
    buffer_load_dwordx4 v168, s[52:55], s78 offen offset:0 lds
    buffer_load_dwordx4 v169, s[52:55], s78 offen offset:1024 lds
    buffer_load_dwordx4 v170, s[52:55], s78 offen offset:2048 lds
    buffer_load_dwordx4 v171, s[52:55], s78 offen offset:3072 lds
    s_mov_b32 m0, s74
    s_nop 0
    buffer_load_dwordx4 v172, s[52:55], s78 offen lds
    s_add_u32 s78, s78, 20480
    s_waitcnt vmcnt(2)
    s_add_u32 m0, s80, 5120
    s_add_u32 s74, s80, 9216
    buffer_load_dwordx4 v168, s[52:55], s78 offen offset:0 lds
    buffer_load_dwordx4 v169, s[52:55], s78 offen offset:1024 lds
    buffer_load_dwordx4 v170, s[52:55], s78 offen offset:2048 lds
    buffer_load_dwordx4 v171, s[52:55], s78 offen offset:3072 lds
    s_mov_b32 m0, s74
    s_nop 0
    buffer_load_dwordx4 v172, s[52:55], s78 offen lds
    s_add_u32 s78, s78, 20480
    s_waitcnt vmcnt(2)
    s_add_u32 m0, s80, 10240
    s_add_u32 s74, s80, 14336
    buffer_load_dwordx4 v168, s[52:55], s78 offen offset:0 lds
    buffer_load_dwordx4 v169, s[52:55], s78 offen offset:1024 lds
    buffer_load_dwordx4 v170, s[52:55], s78 offen offset:2048 lds
    buffer_load_dwordx4 v171, s[52:55], s78 offen offset:3072 lds
    s_mov_b32 m0, s74
    s_nop 0
    buffer_load_dwordx4 v172, s[52:55], s78 offen lds
    s_add_u32 s78, s78, 20480
    s_waitcnt vmcnt(2)
    s_add_u32 m0, s80, 15360
    s_add_u32 s74, s80, 19456
    buffer_load_dwordx4 v168, s[52:55], s78 offen offset:0 lds
    buffer_load_dwordx4 v169, s[52:55], s78 offen offset:1024 lds
    buffer_load_dwordx4 v170, s[52:55], s78 offen offset:2048 lds
    buffer_load_dwordx4 v171, s[52:55], s78 offen offset:3072 lds
    s_mov_b32 m0, s74
    s_nop 0
    buffer_load_dwordx4 v172, s[52:55], s78 offen lds
    s_add_u32 s78, s78, 20480
    s_waitcnt vmcnt(2)
    s_add_u32 m0, s80, 20480
    s_add_u32 s74, s80, 24576
    buffer_load_dwordx4 v168, s[52:55], s78 offen offset:0 lds
    buffer_load_dwordx4 v169, s[52:55], s78 offen offset:1024 lds
    buffer_load_dwordx4 v170, s[52:55], s78 offen offset:2048 lds
    buffer_load_dwordx4 v171, s[52:55], s78 offen offset:3072 lds
    s_mov_b32 m0, s74
    s_nop 0
    buffer_load_dwordx4 v172, s[52:55], s78 offen lds
    s_add_u32 s78, s78, 20480
    s_waitcnt vmcnt(2)
    s_add_u32 m0, s80, 25600
    s_add_u32 s74, s80, 29696
    buffer_load_dwordx4 v168, s[52:55], s78 offen offset:0 lds
    buffer_load_dwordx4 v169, s[52:55], s78 offen offset:1024 lds
    buffer_load_dwordx4 v170, s[52:55], s78 offen offset:2048 lds
    buffer_load_dwordx4 v171, s[52:55], s78 offen offset:3072 lds
    s_mov_b32 m0, s74
    s_nop 0
    buffer_load_dwordx4 v172, s[52:55], s78 offen lds
    s_add_u32 s78, s78, 20480
    s_waitcnt vmcnt(2)
    v_mov_b32 v2, 155648
L15_lw:
    ds_read_b128 v[4:7], v2
    s_waitcnt lgkmcnt(0)
    v_bitop3_b32 v4, v4, v5, v6 bitop3:0x80
    v_and_b32 v4, v4, v7
    s_nop 0
    v_readfirstlane_b32 s76, v4
    s_nop 0
    s_cmp_eq_u32 s76, 1
    s_cbranch_scc1 L15_lw_d
    s_sleep 1
    s_branch L15_lw
L15_lw_d:
    ds_read_b64 v[180:181], v177 offset:0
    ds_read_b64 v[182:183], v177 offset:64
    ds_read_b64 v[184:185], v177 offset:128
    ds_read_b64 v[186:187], v177 offset:192
    ds_read_b64 v[188:189], v177 offset:256
    s_waitcnt lgkmcnt(0)
    v_lshlrev_b32 v64, 16, v180
    v_and_b32 v65, 0xffff0000, v180
    v_lshlrev_b32 v66, 16, v181
    v_and_b32 v67, 0xffff0000, v181
    v_lshlrev_b32 v80, 16, v182
    v_and_b32 v81, 0xffff0000, v182
    v_lshlrev_b32 v82, 16, v183
    v_and_b32 v83, 0xffff0000, v183
    v_lshlrev_b32 v96, 16, v184
    v_and_b32 v97, 0xffff0000, v184
    v_lshlrev_b32 v98, 16, v185
    v_and_b32 v99, 0xffff0000, v185
    v_lshlrev_b32 v112, 16, v186
    v_and_b32 v113, 0xffff0000, v186
    v_lshlrev_b32 v114, 16, v187
    v_and_b32 v115, 0xffff0000, v187
    v_lshlrev_b32 v128, 16, v188
    v_and_b32 v129, 0xffff0000, v188
    v_lshlrev_b32 v130, 16, v189
    v_and_b32 v131, 0xffff0000, v189
    s_cmp_lg_u32 s3, 0
    s_cbranch_scc1 L_l_pub
    s_mov_b32 s77, 0
    s_and_b32 s72, s2, 7
    s_lshl_b32 s72, s72, 12
    s_add_u32 s72, s72, 2965504
    s_lshl_b32 s73, s69, 7
    s_add_u32 s73, s73, 3112960
    s_sub_u32 s73, s73, s72
    v_and_b32 v2, 15, v250
    v_lshl_add_u32 v2, v2, 2, s73
    v_min_u32 v3, 23, v250
    v_lshlrev_b32 v3, 7, v3
    v_cndmask_b32 v2, v3, v2, s[92:93]
    buffer_load_dword v249, v2, s[44:47], s72 offen sc1
L16_spin:
    s_add_u32 s77, s77, 1
    s_waitcnt vmcnt(0)
    v_cmp_ne_u32 vcc, s79, v249
    s_cmp_eq_u64 vcc, 0
    s_cbranch_scc1 L17_done
    s_sleep 6
    buffer_load_dword v249, v2, s[44:47], s72 offen sc1
    s_cmp_lt_u32 s77, 262144
    s_cbranch_scc1 L16_spin
L17_done:
    v_mov_b32 v2, 155720
    v_mov_b32 v3, 1
    ds_write_b32 v2, v3
L_l_pub:
    v_mov_b32 v2, 155720
L18_lw:
    ds_read_b32 v4, v2
    s_waitcnt lgkmcnt(0)
    v_readfirstlane_b32 s76, v4
    s_nop 0
    s_cmp_eq_u32 s76, 1
    s_cbranch_scc1 L18_lw_d
    s_sleep 4
    s_branch L18_lw
L18_lw_d:
    buffer_load_dwordx4 v[192:195], v253, s[56:59], s82 offen sc1
    s_add_u32 s82, s82, 1024
    buffer_load_dwordx4 v[196:199], v253, s[56:59], s82 offen sc1
    s_add_u32 s82, s82, 1024
    buffer_load_dwordx4 v[200:203], v253, s[56:59], s82 offen sc1
    s_add_u32 s82, s82, 1024
    buffer_load_dwordx4 v[204:207], v253, s[56:59], s82 offen sc1
    s_add_u32 s82, s82, 1024
    buffer_load_dwordx4 v[208:211], v253, s[56:59], s82 offen sc1
    s_add_u32 s82, s82, 1024
    buffer_load_dwordx4 v[212:215], v253, s[56:59], s82 offen sc1
    s_add_u32 s82, s82, 1024
    s_mov_b32 s81, 0
    s_waitcnt vmcnt(0)
    .p2align 6
L_gloop:
    s_add_u32 s83, s83, 1
    s_cmp_eq_u32 s83, 4
    s_cselect_b32 s72, 491520, 0
    s_cselect_b32 s73, 24576, 0
    s_sub_u32 s78, s78, s72
    s_sub_u32 s82, s82, s73
    s_cmp_lt_u32 s81, 3
    s_cbranch_scc1 L_gl1
    s_mov_b64 s[52:53], s[24:25]
    s_mov_b32 s54, 819200
    s_mov_b32 s58, 0
    s_mul_i32 s78, s67, 204800
L_gl1:
    s_waitcnt vmcnt(30)
    ds_read_b64_tr_b16 v[144:145], v173 offset:0
    ds_read_b64_tr_b16 v[146:147], v173 offset:2560
    ds_read_b64_tr_b16 v[148:149], v173 offset:64
    ds_read_b64_tr_b16 v[150:151], v173 offset:2624
    ds_read_b64_tr_b16 v[152:153], v173 offset:128
    ds_read_b64_tr_b16 v[154:155], v173 offset:2688
    ds_read_b64_tr_b16 v[156:157], v173 offset:192
    ds_read_b64_tr_b16 v[158:159], v173 offset:2752
    ds_read_b64_tr_b16 v[160:161], v173 offset:256
    ds_read_b64_tr_b16 v[162:163], v173 offset:2816
    s_waitcnt lgkmcnt(0)
    v_mfma_f32_32x32x16_bf16 v[64:79], v[144:147], v[192:195], v[64:79]
    s_add_u32 m0, s80, 0
    s_add_u32 s74, s80, 4096
    buffer_load_dwordx4 v168, s[52:55], s78 offen lds
    v_mfma_f32_32x32x16_bf16 v[80:95], v[148:151], v[192:195], v[80:95]
    buffer_load_dwordx4 v169, s[52:55], s78 offen offset:1024 lds
    v_mfma_f32_32x32x16_bf16 v[96:111], v[152:155], v[192:195], v[96:111]
    buffer_load_dwordx4 v170, s[52:55], s78 offen offset:2048 lds
    v_mfma_f32_32x32x16_bf16 v[112:127], v[156:159], v[192:195], v[112:127]
    buffer_load_dwordx4 v171, s[52:55], s78 offen offset:3072 lds
    v_mfma_f32_32x32x16_bf16 v[128:143], v[160:163], v[192:195], v[128:143]
    s_mov_b32 m0, s74
    s_nop 0
    buffer_load_dwordx4 v172, s[52:55], s78 offen lds
    s_add_u32 s78, s78, 20480
    buffer_load_dwordx4 v[192:195], v253, s[56:59], s82 offen sc1
    s_add_u32 s82, s82, 1024
    s_waitcnt vmcnt(30)
    ds_read_b64_tr_b16 v[144:145], v173 offset:5120
    ds_read_b64_tr_b16 v[146:147], v173 offset:7680
    ds_read_b64_tr_b16 v[148:149], v173 offset:5184
    ds_read_b64_tr_b16 v[150:151], v173 offset:7744
    ds_read_b64_tr_b16 v[152:153], v173 offset:5248
    ds_read_b64_tr_b16 v[154:155], v173 offset:7808
    ds_read_b64_tr_b16 v[156:157], v173 offset:5312
    ds_read_b64_tr_b16 v[158:159], v173 offset:7872
    ds_read_b64_tr_b16 v[160:161], v173 offset:5376
    ds_read_b64_tr_b16 v[162:163], v173 offset:7936
    s_waitcnt lgkmcnt(0)
    v_mfma_f32_32x32x16_bf16 v[64:79], v[144:147], v[196:199], v[64:79]
    s_add_u32 m0, s80, 5120
    s_add_u32 s74, s80, 9216
    buffer_load_dwordx4 v168, s[52:55], s78 offen lds
    v_mfma_f32_32x32x16_bf16 v[80:95], v[148:151], v[196:199], v[80:95]
    buffer_load_dwordx4 v169, s[52:55], s78 offen offset:1024 lds
    v_mfma_f32_32x32x16_bf16 v[96:111], v[152:155], v[196:199], v[96:111]
    buffer_load_dwordx4 v170, s[52:55], s78 offen offset:2048 lds
    v_mfma_f32_32x32x16_bf16 v[112:127], v[156:159], v[196:199], v[112:127]
    buffer_load_dwordx4 v171, s[52:55], s78 offen offset:3072 lds
    v_mfma_f32_32x32x16_bf16 v[128:143], v[160:163], v[196:199], v[128:143]
    s_mov_b32 m0, s74
    s_nop 0
    buffer_load_dwordx4 v172, s[52:55], s78 offen lds
    s_add_u32 s78, s78, 20480
    buffer_load_dwordx4 v[196:199], v253, s[56:59], s82 offen sc1
    s_add_u32 s82, s82, 1024
    s_waitcnt vmcnt(30)
    ds_read_b64_tr_b16 v[144:145], v173 offset:10240
    ds_read_b64_tr_b16 v[146:147], v173 offset:12800
    ds_read_b64_tr_b16 v[148:149], v173 offset:10304
    ds_read_b64_tr_b16 v[150:151], v173 offset:12864
    ds_read_b64_tr_b16 v[152:153], v173 offset:10368
    ds_read_b64_tr_b16 v[154:155], v173 offset:12928
    ds_read_b64_tr_b16 v[156:157], v173 offset:10432
    ds_read_b64_tr_b16 v[158:159], v173 offset:12992
    ds_read_b64_tr_b16 v[160:161], v173 offset:10496
    ds_read_b64_tr_b16 v[162:163], v173 offset:13056
    s_waitcnt lgkmcnt(0)
    v_mfma_f32_32x32x16_bf16 v[64:79], v[144:147], v[200:203], v[64:79]
    s_add_u32 m0, s80, 10240
    s_add_u32 s74, s80, 14336
    buffer_load_dwordx4 v168, s[52:55], s78 offen lds
    v_mfma_f32_32x32x16_bf16 v[80:95], v[148:151], v[200:203], v[80:95]
    buffer_load_dwordx4 v169, s[52:55], s78 offen offset:1024 lds
    v_mfma_f32_32x32x16_bf16 v[96:111], v[152:155], v[200:203], v[96:111]
    buffer_load_dwordx4 v170, s[52:55], s78 offen offset:2048 lds
    v_mfma_f32_32x32x16_bf16 v[112:127], v[156:159], v[200:203], v[112:127]
    buffer_load_dwordx4 v171, s[52:55], s78 offen offset:3072 lds
    v_mfma_f32_32x32x16_bf16 v[128:143], v[160:163], v[200:203], v[128:143]
    s_mov_b32 m0, s74
    s_nop 0
    buffer_load_dwordx4 v172, s[52:55], s78 offen lds
    s_add_u32 s78, s78, 20480
    buffer_load_dwordx4 v[200:203], v253, s[56:59], s82 offen sc1
    s_add_u32 s82, s82, 1024
    s_waitcnt vmcnt(30)
    ds_read_b64_tr_b16 v[144:145], v173 offset:15360
    ds_read_b64_tr_b16 v[146:147], v173 offset:17920
    ds_read_b64_tr_b16 v[148:149], v173 offset:15424
    ds_read_b64_tr_b16 v[150:151], v173 offset:17984
    ds_read_b64_tr_b16 v[152:153], v173 offset:15488
    ds_read_b64_tr_b16 v[154:155], v173 offset:18048
    ds_read_b64_tr_b16 v[156:157], v173 offset:15552
    ds_read_b64_tr_b16 v[158:159], v173 offset:18112
    ds_read_b64_tr_b16 v[160:161], v173 offset:15616
    ds_read_b64_tr_b16 v[162:163], v173 offset:18176
    s_waitcnt lgkmcnt(0)
    v_mfma_f32_32x32x16_bf16 v[64:79], v[144:147], v[204:207], v[64:79]
    s_add_u32 m0, s80, 15360
    s_add_u32 s74, s80, 19456
    buffer_load_dwordx4 v168, s[52:55], s78 offen lds
    v_mfma_f32_32x32x16_bf16 v[80:95], v[148:151], v[204:207], v[80:95]
    buffer_load_dwordx4 v169, s[52:55], s78 offen offset:1024 lds
    v_mfma_f32_32x32x16_bf16 v[96:111], v[152:155], v[204:207], v[96:111]
    buffer_load_dwordx4 v170, s[52:55], s78 offen offset:2048 lds
    v_mfma_f32_32x32x16_bf16 v[112:127], v[156:159], v[204:207], v[112:127]
    buffer_load_dwordx4 v171, s[52:55], s78 offen offset:3072 lds
    v_mfma_f32_32x32x16_bf16 v[128:143], v[160:163], v[204:207], v[128:143]
    s_mov_b32 m0, s74
    s_nop 0
    buffer_load_dwordx4 v172, s[52:55], s78 offen lds
    s_add_u32 s78, s78, 20480
    buffer_load_dwordx4 v[204:207], v253, s[56:59], s82 offen sc1
    s_add_u32 s82, s82, 1024
    s_waitcnt vmcnt(30)
    ds_read_b64_tr_b16 v[144:145], v173 offset:20480
    ds_read_b64_tr_b16 v[146:147], v173 offset:23040
    ds_read_b64_tr_b16 v[148:149], v173 offset:20544
    ds_read_b64_tr_b16 v[150:151], v173 offset:23104
    ds_read_b64_tr_b16 v[152:153], v173 offset:20608
    ds_read_b64_tr_b16 v[154:155], v173 offset:23168
    ds_read_b64_tr_b16 v[156:157], v173 offset:20672
    ds_read_b64_tr_b16 v[158:159], v173 offset:23232
    ds_read_b64_tr_b16 v[160:161], v173 offset:20736
    ds_read_b64_tr_b16 v[162:163], v173 offset:23296
    s_waitcnt lgkmcnt(0)
    v_mfma_f32_32x32x16_bf16 v[64:79], v[144:147], v[208:211], v[64:79]
    s_add_u32 m0, s80, 20480
    s_add_u32 s74, s80, 24576
    buffer_load_dwordx4 v168, s[52:55], s78 offen lds
    v_mfma_f32_32x32x16_bf16 v[80:95], v[148:151], v[208:211], v[80:95]
    buffer_load_dwordx4 v169, s[52:55], s78 offen offset:1024 lds
    v_mfma_f32_32x32x16_bf16 v[96:111], v[152:155], v[208:211], v[96:111]
    buffer_load_dwordx4 v170, s[52:55], s78 offen offset:2048 lds
    v_mfma_f32_32x32x16_bf16 v[112:127], v[156:159], v[208:211], v[112:127]
    buffer_load_dwordx4 v171, s[52:55], s78 offen offset:3072 lds
    v_mfma_f32_32x32x16_bf16 v[128:143], v[160:163], v[208:211], v[128:143]
    s_mov_b32 m0, s74
    s_nop 0
    buffer_load_dwordx4 v172, s[52:55], s78 offen lds
    s_add_u32 s78, s78, 20480
    buffer_load_dwordx4 v[208:211], v253, s[56:59], s82 offen sc1
    s_add_u32 s82, s82, 1024
    s_waitcnt vmcnt(30)
    ds_read_b64_tr_b16 v[144:145], v173 offset:25600
    ds_read_b64_tr_b16 v[146:147], v173 offset:28160
    ds_read_b64_tr_b16 v[148:149], v173 offset:25664
    ds_read_b64_tr_b16 v[150:151], v173 offset:28224
    ds_read_b64_tr_b16 v[152:153], v173 offset:25728
    ds_read_b64_tr_b16 v[154:155], v173 offset:28288
    ds_read_b64_tr_b16 v[156:157], v173 offset:25792
    ds_read_b64_tr_b16 v[158:159], v173 offset:28352
    ds_read_b64_tr_b16 v[160:161], v173 offset:25856
    ds_read_b64_tr_b16 v[162:163], v173 offset:28416
    s_waitcnt lgkmcnt(0)
    v_mfma_f32_32x32x16_bf16 v[64:79], v[144:147], v[212:215], v[64:79]
    s_add_u32 m0, s80, 25600
    s_add_u32 s74, s80, 29696
    buffer_load_dwordx4 v168, s[52:55], s78 offen lds
    v_mfma_f32_32x32x16_bf16 v[80:95], v[148:151], v[212:215], v[80:95]
    buffer_load_dwordx4 v169, s[52:55], s78 offen offset:1024 lds
    v_mfma_f32_32x32x16_bf16 v[96:111], v[152:155], v[212:215], v[96:111]
    buffer_load_dwordx4 v170, s[52:55], s78 offen offset:2048 lds
    v_mfma_f32_32x32x16_bf16 v[112:127], v[156:159], v[212:215], v[112:127]
    buffer_load_dwordx4 v171, s[52:55], s78 offen offset:3072 lds
    v_mfma_f32_32x32x16_bf16 v[128:143], v[160:163], v[212:215], v[128:143]
    s_mov_b32 m0, s74
    s_nop 0
    buffer_load_dwordx4 v172, s[52:55], s78 offen lds
    s_add_u32 s78, s78, 20480
    buffer_load_dwordx4 v[212:215], v253, s[56:59], s82 offen sc1
    s_add_u32 s82, s82, 1024
    s_add_u32 s81, s81, 1
    s_cmp_lt_u32 s81, 4
    s_cbranch_scc1 L_gloop
    s_mov_b32 s58, 17825792
    s_mul_i32 s82, s69, 40
    s_mul_i32 s72, s67, 10
    s_add_u32 s82, s82, s72
    s_lshl_b32 s82, s82, 10
    s_add_u32 s82, s82, 9437184
    s_add_u32 s72, s82, 4096
    s_add_u32 s73, s82, 8192
    s_waitcnt vmcnt(12)
    ds_read_b64_tr_b16 v[144:145], v174 offset:0
    ds_read_b64_tr_b16 v[146:147], v174 offset:1280
    ds_read_b64_tr_b16 v[148:149], v174 offset:64
    ds_read_b64_tr_b16 v[150:151], v174 offset:1344
    ds_read_b64_tr_b16 v[152:153], v174 offset:128
    ds_read_b64_tr_b16 v[154:155], v174 offset:1408
    ds_read_b64_tr_b16 v[156:157], v174 offset:192
    ds_read_b64_tr_b16 v[158:159], v174 offset:1472
    ds_read_b64_tr_b16 v[160:161], v174 offset:256
    ds_read_b64_tr_b16 v[162:163], v174 offset:1536
    ds_read_b64_tr_b16 v[2:3], v174 offset:5120
    ds_read_b64_tr_b16 v[4:5], v174 offset:6400
    ds_read_b64_tr_b16 v[6:7], v174 offset:5184
    ds_read_b64_tr_b16 v[8:9], v174 offset:6464
    ds_read_b64_tr_b16 v[10:11], v174 offset:5248
    ds_read_b64_tr_b16 v[12:13], v174 offset:6528
    ds_read_b64_tr_b16 v[14:15], v174 offset:5312
    ds_read_b64_tr_b16 v[16:17], v174 offset:6592
    ds_read_b64_tr_b16 v[18:19], v174 offset:5376
    ds_read_b64_tr_b16 v[20:21], v174 offset:6656
    ds_read_b64_tr_b16 v[22:23], v174 offset:10240
    ds_read_b64_tr_b16 v[24:25], v174 offset:11520
    ds_read_b64_tr_b16 v[26:27], v174 offset:10304
    ds_read_b64_tr_b16 v[28:29], v174 offset:11584
    ds_read_b64_tr_b16 v[30:31], v174 offset:10368
    ds_read_b64_tr_b16 v[32:33], v174 offset:11648
    ds_read_b64_tr_b16 v[34:35], v174 offset:10432
    ds_read_b64_tr_b16 v[36:37], v174 offset:11712
    ds_read_b64_tr_b16 v[38:39], v174 offset:10496
    ds_read_b64_tr_b16 v[40:41], v174 offset:11776
    ds_read_b64_tr_b16 v[42:43], v174 offset:15360
    ds_read_b64_tr_b16 v[44:45], v174 offset:16640
    ds_read_b64_tr_b16 v[46:47], v174 offset:15424
    ds_read_b64_tr_b16 v[48:49], v174 offset:16704
    ds_read_b64_tr_b16 v[50:51], v174 offset:15488
    ds_read_b64_tr_b16 v[52:53], v174 offset:16768
    ds_read_b64_tr_b16 v[54:55], v174 offset:15552
    ds_read_b64_tr_b16 v[56:57], v174 offset:16832
    ds_read_b64_tr_b16 v[58:59], v174 offset:15616
    ds_read_b64_tr_b16 v[60:61], v174 offset:16896
    s_waitcnt lgkmcnt(0)
    s_add_u32 m0, s80, 0
    s_add_u32 s74, s80, 4096
    buffer_load_dwordx4 v168, s[52:55], s78 offen offset:0 lds
    buffer_load_dwordx4 v169, s[52:55], s78 offen offset:1024 lds
    buffer_load_dwordx4 v170, s[52:55], s78 offen offset:2048 lds
    buffer_load_dwordx4 v171, s[52:55], s78 offen offset:3072 lds
    s_mov_b32 m0, s74
    s_nop 0
    buffer_load_dwordx4 v172, s[52:55], s78 offen lds
    s_add_u32 s78, s78, 20480
    s_waitcnt vmcnt(2)
    s_add_u32 m0, s80, 5120
    s_add_u32 s74, s80, 9216
    buffer_load_dwordx4 v168, s[52:55], s78 offen offset:0 lds
    buffer_load_dwordx4 v169, s[52:55], s78 offen offset:1024 lds
    buffer_load_dwordx4 v170, s[52:55], s78 offen offset:2048 lds
    buffer_load_dwordx4 v171, s[52:55], s78 offen offset:3072 lds
    s_mov_b32 m0, s74
    s_nop 0
    buffer_load_dwordx4 v172, s[52:55], s78 offen lds
    s_add_u32 s78, s78, 20480
    s_waitcnt vmcnt(2)
    s_add_u32 m0, s80, 10240
    s_add_u32 s74, s80, 14336
    buffer_load_dwordx4 v168, s[52:55], s78 offen offset:0 lds
    buffer_load_dwordx4 v169, s[52:55], s78 offen offset:1024 lds
    buffer_load_dwordx4 v170, s[52:55], s78 offen offset:2048 lds
    buffer_load_dwordx4 v171, s[52:55], s78 offen offset:3072 lds
    s_mov_b32 m0, s74
    s_nop 0
    buffer_load_dwordx4 v172, s[52:55], s78 offen lds
    s_add_u32 s78, s78, 20480
    s_waitcnt vmcnt(2)
    s_add_u32 m0, s80, 15360
    s_add_u32 s74, s80, 19456
    buffer_load_dwordx4 v168, s[52:55], s78 offen offset:0 lds
    buffer_load_dwordx4 v169, s[52:55], s78 offen offset:1024 lds
    buffer_load_dwordx4 v170, s[52:55], s78 offen offset:2048 lds
    buffer_load_dwordx4 v171, s[52:55], s78 offen offset:3072 lds
    s_mov_b32 m0, s74
    s_nop 0
    buffer_load_dwordx4 v172, s[52:55], s78 offen lds
    s_add_u32 s78, s78, 20480
    s_waitcnt vmcnt(2)
    v_mov_b32 v232, 155728
L_ow:
    ds_read_b128 v[236:239], v232
    s_waitcnt lgkmcnt(0)
    v_bitop3_b32 v236, v236, v237, v238 bitop3:0x80
    v_and_b32 v236, v236, v239
    s_nop 0
    v_readfirstlane_b32 s76, v236
    s_nop 0
    s_cmp_eq_u32 s76, 1
    s_cbranch_scc1 L_owd
    s_sleep 4
    s_branch L_ow
L_owd:
    s_mov_b32 s77, 0
    buffer_load_dwordx4 v[192:195], v253, s[56:59], s82 offen offset:0 sc1
    buffer_load_dwordx4 v[196:199], v253, s[56:59], s82 offen offset:1024 sc1
    buffer_load_dwordx4 v[200:203], v253, s[56:59], s82 offen offset:2048 sc1
    buffer_load_dwordx4 v[204:207], v253, s[56:59], s82 offen offset:3072 sc1
    buffer_load_dwordx4 v[208:211], v253, s[56:59], s72 offen offset:0 sc1
    buffer_load_dwordx4 v[212:215], v253, s[56:59], s72 offen offset:1024 sc1
    buffer_load_dwordx4 v[216:219], v253, s[56:59], s72 offen offset:2048 sc1
    buffer_load_dwordx4 v[220:223], v253, s[56:59], s72 offen offset:3072 sc1
    buffer_load_dwordx4 v[224:227], v253, s[56:59], s73 offen offset:0 sc1
    buffer_load_dwordx4 v[228:231], v253, s[56:59], s73 offen offset:1024 sc1
    s_waitcnt vmcnt(9)
L_oc0:
    v_max3_u32 v232, v192, v193, v194
    v_max_u32 v232, v232, v195
    v_cmp_eq_u32 vcc, -1, v232
    s_cmp_lg_u64 vcc, 0
    s_cbranch_scc1 L_or0
L_og0:
    v_mfma_f32_32x32x16_bf16 v[64:79], v[144:147], v[192:195], v[64:79]
    v_mfma_f32_32x32x16_bf16 v[80:95], v[148:151], v[192:195], v[80:95]
    v_mfma_f32_32x32x16_bf16 v[96:111], v[152:155], v[192:195], v[96:111]
    v_mfma_f32_32x32x16_bf16 v[112:127], v[156:159], v[192:195], v[112:127]
    v_mfma_f32_32x32x16_bf16 v[128:143], v[160:163], v[192:195], v[128:143]
    ds_read_b64_tr_b16 v[144:145], v174 offset:20480
    ds_read_b64_tr_b16 v[146:147], v174 offset:21760
    ds_read_b64_tr_b16 v[148:149], v174 offset:20544
    ds_read_b64_tr_b16 v[150:151], v174 offset:21824
    ds_read_b64_tr_b16 v[152:153], v174 offset:20608
    ds_read_b64_tr_b16 v[154:155], v174 offset:21888
    ds_read_b64_tr_b16 v[156:157], v174 offset:20672
    ds_read_b64_tr_b16 v[158:159], v174 offset:21952
    ds_read_b64_tr_b16 v[160:161], v174 offset:20736
    ds_read_b64_tr_b16 v[162:163], v174 offset:22016
    s_waitcnt vmcnt(8)
L_oc1:
    v_max3_u32 v232, v196, v197, v198
    v_max_u32 v232, v232, v199
    v_cmp_eq_u32 vcc, -1, v232
    s_cmp_lg_u64 vcc, 0
    s_cbranch_scc1 L_or1
L_og1:
    v_mfma_f32_32x32x16_bf16 v[64:79], v[2:5], v[196:199], v[64:79]
    v_mfma_f32_32x32x16_bf16 v[80:95], v[6:9], v[196:199], v[80:95]
    v_mfma_f32_32x32x16_bf16 v[96:111], v[10:13], v[196:199], v[96:111]
    v_mfma_f32_32x32x16_bf16 v[112:127], v[14:17], v[196:199], v[112:127]
    v_mfma_f32_32x32x16_bf16 v[128:143], v[18:21], v[196:199], v[128:143]
    ds_read_b64_tr_b16 v[2:3], v174 offset:25600
    ds_read_b64_tr_b16 v[4:5], v174 offset:26880
    ds_read_b64_tr_b16 v[6:7], v174 offset:25664
    ds_read_b64_tr_b16 v[8:9], v174 offset:26944
    ds_read_b64_tr_b16 v[10:11], v174 offset:25728
    ds_read_b64_tr_b16 v[12:13], v174 offset:27008
    ds_read_b64_tr_b16 v[14:15], v174 offset:25792
    ds_read_b64_tr_b16 v[16:17], v174 offset:27072
    ds_read_b64_tr_b16 v[18:19], v174 offset:25856
    ds_read_b64_tr_b16 v[20:21], v174 offset:27136
    s_waitcnt vmcnt(7)
L_oc2:
    v_max3_u32 v232, v200, v201, v202
    v_max_u32 v232, v232, v203
    v_cmp_eq_u32 vcc, -1, v232
    s_cmp_lg_u64 vcc, 0
    s_cbranch_scc1 L_or2
L_og2:
    v_mfma_f32_32x32x16_bf16 v[64:79], v[22:25], v[200:203], v[64:79]
    v_mfma_f32_32x32x16_bf16 v[80:95], v[26:29], v[200:203], v[80:95]
    v_mfma_f32_32x32x16_bf16 v[96:111], v[30:33], v[200:203], v[96:111]
    v_mfma_f32_32x32x16_bf16 v[112:127], v[34:37], v[200:203], v[112:127]
    v_mfma_f32_32x32x16_bf16 v[128:143], v[38:41], v[200:203], v[128:143]
    ds_read_b64_tr_b16 v[22:23], v174 offset:0
    ds_read_b64_tr_b16 v[24:25], v174 offset:1280
    ds_read_b64_tr_b16 v[26:27], v174 offset:64
    ds_read_b64_tr_b16 v[28:29], v174 offset:1344
    ds_read_b64_tr_b16 v[30:31], v174 offset:128
    ds_read_b64_tr_b16 v[32:33], v174 offset:1408
    ds_read_b64_tr_b16 v[34:35], v174 offset:192
    ds_read_b64_tr_b16 v[36:37], v174 offset:1472
    ds_read_b64_tr_b16 v[38:39], v174 offset:256
    ds_read_b64_tr_b16 v[40:41], v174 offset:1536
    s_waitcnt vmcnt(6)
L_oc3:
    v_max3_u32 v232, v204, v205, v206
    v_max_u32 v232, v232, v207
    v_cmp_eq_u32 vcc, -1, v232
    s_cmp_lg_u64 vcc, 0
    s_cbranch_scc1 L_or3
L_og3:
    v_mfma_f32_32x32x16_bf16 v[64:79], v[42:45], v[204:207], v[64:79]
    v_mfma_f32_32x32x16_bf16 v[80:95], v[46:49], v[204:207], v[80:95]
    v_mfma_f32_32x32x16_bf16 v[96:111], v[50:53], v[204:207], v[96:111]
    v_mfma_f32_32x32x16_bf16 v[112:127], v[54:57], v[204:207], v[112:127]
    v_mfma_f32_32x32x16_bf16 v[128:143], v[58:61], v[204:207], v[128:143]
    ds_read_b64_tr_b16 v[42:43], v174 offset:5120
    ds_read_b64_tr_b16 v[44:45], v174 offset:6400
    ds_read_b64_tr_b16 v[46:47], v174 offset:5184
    ds_read_b64_tr_b16 v[48:49], v174 offset:6464
    ds_read_b64_tr_b16 v[50:51], v174 offset:5248
    ds_read_b64_tr_b16 v[52:53], v174 offset:6528
    ds_read_b64_tr_b16 v[54:55], v174 offset:5312
    ds_read_b64_tr_b16 v[56:57], v174 offset:6592
    ds_read_b64_tr_b16 v[58:59], v174 offset:5376
    ds_read_b64_tr_b16 v[60:61], v174 offset:6656
    s_waitcnt vmcnt(5)
L_oc4:
    v_max3_u32 v232, v208, v209, v210
    v_max_u32 v232, v232, v211
    v_cmp_eq_u32 vcc, -1, v232
    s_waitcnt lgkmcnt(15)
    s_cmp_lg_u64 vcc, 0
    s_cbranch_scc1 L_or4
L_og4:
    v_mfma_f32_32x32x16_bf16 v[64:79], v[144:147], v[208:211], v[64:79]
    v_mfma_f32_32x32x16_bf16 v[80:95], v[148:151], v[208:211], v[80:95]
    v_mfma_f32_32x32x16_bf16 v[96:111], v[152:155], v[208:211], v[96:111]
    v_mfma_f32_32x32x16_bf16 v[112:127], v[156:159], v[208:211], v[112:127]
    v_mfma_f32_32x32x16_bf16 v[128:143], v[160:163], v[208:211], v[128:143]
    ds_read_b64_tr_b16 v[144:145], v174 offset:10240
    ds_read_b64_tr_b16 v[146:147], v174 offset:11520
    ds_read_b64_tr_b16 v[148:149], v174 offset:10304
    ds_read_b64_tr_b16 v[150:151], v174 offset:11584
    ds_read_b64_tr_b16 v[152:153], v174 offset:10368
    ds_read_b64_tr_b16 v[154:155], v174 offset:11648
    ds_read_b64_tr_b16 v[156:157], v174 offset:10432
    ds_read_b64_tr_b16 v[158:159], v174 offset:11712
    ds_read_b64_tr_b16 v[160:161], v174 offset:10496
    ds_read_b64_tr_b16 v[162:163], v174 offset:11776
    s_waitcnt vmcnt(4)
L_oc5:
    v_max3_u32 v232, v212, v213, v214
    v_max_u32 v232, v232, v215
    v_cmp_eq_u32 vcc, -1, v232
    s_waitcnt lgkmcnt(15)
    s_cmp_lg_u64 vcc, 0
    s_cbranch_scc1 L_or5
L_og5:
    v_mfma_f32_32x32x16_bf16 v[64:79], v[2:5], v[212:215], v[64:79]
    v_mfma_f32_32x32x16_bf16 v[80:95], v[6:9], v[212:215], v[80:95]
    v_mfma_f32_32x32x16_bf16 v[96:111], v[10:13], v[212:215], v[96:111]
    v_mfma_f32_32x32x16_bf16 v[112:127], v[14:17], v[212:215], v[112:127]
    v_mfma_f32_32x32x16_bf16 v[128:143], v[18:21], v[212:215], v[128:143]
    ds_read_b64_tr_b16 v[2:3], v174 offset:15360
    ds_read_b64_tr_b16 v[4:5], v174 offset:16640
    ds_read_b64_tr_b16 v[6:7], v174 offset:15424
    ds_read_b64_tr_b16 v[8:9], v174 offset:16704
    ds_read_b64_tr_b16 v[10:11], v174 offset:15488
    ds_read_b64_tr_b16 v[12:13], v174 offset:16768
    ds_read_b64_tr_b16 v[14:15], v174 offset:15552
    ds_read_b64_tr_b16 v[16:17], v174 offset:16832
    ds_read_b64_tr_b16 v[18:19], v174 offset:15616
    ds_read_b64_tr_b16 v[20:21], v174 offset:16896
    s_waitcnt vmcnt(3)
L_oc6:
    v_max3_u32 v232, v216, v217, v218
    v_max_u32 v232, v232, v219
    v_cmp_eq_u32 vcc, -1, v232
    s_waitcnt lgkmcnt(15)
    s_cmp_lg_u64 vcc, 0
    s_cbranch_scc1 L_or6
L_og6:
    v_mfma_f32_32x32x16_bf16 v[64:79], v[22:25], v[216:219], v[64:79]
    v_mfma_f32_32x32x16_bf16 v[80:95], v[26:29], v[216:219], v[80:95]
    v_mfma_f32_32x32x16_bf16 v[96:111], v[30:33], v[216:219], v[96:111]
    v_mfma_f32_32x32x16_bf16 v[112:127], v[34:37], v[216:219], v[112:127]
    v_mfma_f32_32x32x16_bf16 v[128:143], v[38:41], v[216:219], v[128:143]
    s_waitcnt vmcnt(2)
L_oc7:
    v_max3_u32 v232, v220, v221, v222
    v_max_u32 v232, v232, v223
    v_cmp_eq_u32 vcc, -1, v232
    s_waitcnt lgkmcnt(15)
    s_cmp_lg_u64 vcc, 0
    s_cbranch_scc1 L_or7
L_og7:
    v_mfma_f32_32x32x16_bf16 v[64:79], v[42:45], v[220:223], v[64:79]
    v_mfma_f32_32x32x16_bf16 v[80:95], v[46:49], v[220:223], v[80:95]
    v_mfma_f32_32x32x16_bf16 v[96:111], v[50:53], v[220:223], v[96:111]
    v_mfma_f32_32x32x16_bf16 v[112:127], v[54:57], v[220:223], v[112:127]
    v_mfma_f32_32x32x16_bf16 v[128:143], v[58:61], v[220:223], v[128:143]
    s_waitcnt vmcnt(1)
L_oc8:
    v_max3_u32 v232, v224, v225, v226
    v_max_u32 v232, v232, v227
    v_cmp_eq_u32 vcc, -1, v232
    s_waitcnt lgkmcnt(10)
    s_cmp_lg_u64 vcc, 0
    s_cbranch_scc1 L_or8
L_og8:
    v_mfma_f32_32x32x16_bf16 v[64:79], v[144:147], v[224:227], v[64:79]
    v_mfma_f32_32x32x16_bf16 v[80:95], v[148:151], v[224:227], v[80:95]
    v_mfma_f32_32x32x16_bf16 v[96:111], v[152:155], v[224:227], v[96:111]
    v_mfma_f32_32x32x16_bf16 v[112:127], v[156:159], v[224:227], v[112:127]
    v_mfma_f32_32x32x16_bf16 v[128:143], v[160:163], v[224:227], v[128:143]
    s_waitcnt vmcnt(0)
L_oc9:
    v_max3_u32 v232, v228, v229, v230
    v_max_u32 v232, v232, v231
    v_cmp_eq_u32 vcc, -1, v232
    s_waitcnt lgkmcnt(0)
    s_cmp_lg_u64 vcc, 0
    s_cbranch_scc1 L_or9
L_og9:
    v_mfma_f32_32x32x16_bf16 v[64:79], v[2:5], v[228:231], v[64:79]
    v_mfma_f32_32x32x16_bf16 v[80:95], v[6:9], v[228:231], v[80:95]
    v_mfma_f32_32x32x16_bf16 v[96:111], v[10:13], v[228:231], v[96:111]
    v_mfma_f32_32x32x16_bf16 v[112:127], v[14:17], v[228:231], v[112:127]
    v_mfma_f32_32x32x16_bf16 v[128:143], v[18:21], v[228:231], v[128:143]
    v_mov_b32 v15, 1
    v_mov_b32 v12, 155696
    s_nop 5
    ds_write_b128 v178, v[68:71] offset:0
    ds_write_b128 v178, v[72:75] offset:5120
    ds_write_b128 v178, v[76:79] offset:10240
    ds_write_b128 v178, v[84:87] offset:1024
    ds_write_b128 v178, v[88:91] offset:6144
    ds_write_b128 v178, v[92:95] offset:11264
    ds_write_b128 v178, v[100:103] offset:2048
    ds_write_b128 v178, v[104:107] offset:7168
    ds_write_b128 v178, v[108:111] offset:12288
    ds_write_b128 v178, v[116:119] offset:3072
    ds_write_b128 v178, v[120:123] offset:8192
    ds_write_b128 v178, v[124:127] offset:13312
    ds_write_b128 v178, v[132:135] offset:4096
    ds_write_b128 v178, v[136:139] offset:9216
    ds_write_b128 v178, v[140:143] offset:14336
    s_waitcnt lgkmcnt(0)
    ds_write_b32 v248, v15 offset:48
L_gpoll:
    ds_read_b128 v[4:7], v12
    s_waitcnt lgkmcnt(0)
    v_bitop3_b32 v4, v4, v5, v6 bitop3:0x80
    v_and_b32 v4, v4, v7
    s_nop 0
    v_readfirstlane_b32 s72, v4
    s_nop 0
    s_cmp_eq_u32 s72, 1
    s_cbranch_scc0 L_gpoll
    ds_read_b128 v[68:71], v175 offset:0
    ds_read_b128 v[72:75], v176 offset:5120
    ds_read_b128 v[76:79], v179 offset:10240
    ds_read_b128 v[84:87], v175 offset:1024
    ds_read_b128 v[88:91], v176 offset:6144
    ds_read_b128 v[92:95], v179 offset:11264
    ds_read_b128 v[100:103], v175 offset:2048
    ds_read_b128 v[104:107], v176 offset:7168
    ds_read_b128 v[108:111], v179 offset:12288
    ds_read_b128 v[116:119], v175 offset:3072
    ds_read_b128 v[120:123], v176 offset:8192
    ds_read_b128 v[124:127], v179 offset:13312
    ds_read_b128 v[132:135], v175 offset:4096
    ds_read_b128 v[136:139], v176 offset:9216
    ds_read_b128 v[140:143], v179 offset:14336
    s_waitcnt lgkmcnt(12)
    v_pk_add_f32 v[64:65], v[64:65], v[68:69]
    v_pk_add_f32 v[72:73], v[72:73], v[76:77]
    v_pk_add_f32 v[66:67], v[66:67], v[70:71]
    v_pk_add_f32 v[74:75], v[74:75], v[78:79]
    v_pk_add_f32 v[64:65], v[64:65], v[72:73]
    v_pk_add_f32 v[66:67], v[66:67], v[74:75]
    v_cvt_pk_bf16_f32 v64, v64, v65
    v_cvt_pk_bf16_f32 v65, v66, v67
    ds_write_b64 v177, v[64:65] offset:0
    s_waitcnt lgkmcnt(9)
    v_pk_add_f32 v[80:81], v[80:81], v[84:85]
    v_pk_add_f32 v[88:89], v[88:89], v[92:93]
    v_pk_add_f32 v[82:83], v[82:83], v[86:87]
    v_pk_add_f32 v[90:91], v[90:91], v[94:95]
    v_pk_add_f32 v[80:81], v[80:81], v[88:89]
    v_pk_add_f32 v[82:83], v[82:83], v[90:91]
    v_cvt_pk_bf16_f32 v80, v80, v81
    v_cvt_pk_bf16_f32 v81, v82, v83
    ds_write_b64 v177, v[80:81] offset:64
    s_waitcnt lgkmcnt(6)
    v_pk_add_f32 v[96:97], v[96:97], v[100:101]
    v_pk_add_f32 v[104:105], v[104:105], v[108:109]
    v_pk_add_f32 v[98:99], v[98:99], v[102:103]
    v_pk_add_f32 v[106:107], v[106:107], v[110:111]
    v_pk_add_f32 v[96:97], v[96:97], v[104:105]
    v_pk_add_f32 v[98:99], v[98:99], v[106:107]
    v_cvt_pk_bf16_f32 v96, v96, v97
    v_cvt_pk_bf16_f32 v97, v98, v99
    ds_write_b64 v177, v[96:97] offset:128
    s_waitcnt lgkmcnt(3)
    v_pk_add_f32 v[112:113], v[112:113], v[116:117]
    v_pk_add_f32 v[120:121], v[120:121], v[124:125]
    v_pk_add_f32 v[114:115], v[114:115], v[118:119]
    v_pk_add_f32 v[122:123], v[122:123], v[126:127]
    v_pk_add_f32 v[112:113], v[112:113], v[120:121]
    v_pk_add_f32 v[114:115], v[114:115], v[122:123]
    v_cvt_pk_bf16_f32 v112, v112, v113
    v_cvt_pk_bf16_f32 v113, v114, v115
    ds_write_b64 v177, v[112:113] offset:192
    s_waitcnt lgkmcnt(0)
    v_pk_add_f32 v[128:129], v[128:129], v[132:133]
    v_pk_add_f32 v[136:137], v[136:137], v[140:141]
    v_pk_add_f32 v[130:131], v[130:131], v[134:135]
    v_pk_add_f32 v[138:139], v[138:139], v[142:143]
    v_pk_add_f32 v[128:129], v[128:129], v[136:137]
    v_pk_add_f32 v[130:131], v[130:131], v[138:139]
    v_cvt_pk_bf16_f32 v128, v128, v129
    v_cvt_pk_bf16_f32 v129, v130, v131
    ds_write_b64 v177, v[128:129] offset:256
    s_waitcnt lgkmcnt(0)
    ds_write_b32 v248, v15 offset:144
L_gpoll2:
    ds_read_b128 v[4:7], v12 offset:96
    s_waitcnt lgkmcnt(0)
    v_bitop3_b32 v4, v4, v5, v6 bitop3:0x80
    v_and_b32 v4, v4, v7
    s_nop 0
    v_readfirstlane_b32 s72, v4
    s_nop 0
    s_cmp_eq_u32 s72, 1
    s_cbranch_scc0 L_gpoll2
    ds_read_b128 v[64:67], v191 offset:0
    ds_read_b128 v[68:71], v191 offset:1024
    ds_read_b128 v[72:75], v191 offset:2048
    s_waitcnt lgkmcnt(2)
    buffer_store_dwordx4 v[64:67], v168, s[60:63], s84 offen offset:0
    s_waitcnt lgkmcnt(1)
    buffer_store_dwordx4 v[68:71], v169, s[60:63], s84 offen offset:1024
    s_waitcnt lgkmcnt(0)
    s_mov_b32 exec_hi, 0
    buffer_store_dwordx4 v[72:75], v170, s[60:63], s84 offen offset:2048
    s_mov_b32 exec_hi, -1
    s_endpgm
L_or0:
    s_waitcnt vmcnt(0)
    s_sleep 4
    buffer_load_dwordx4 v[192:195], v253, s[56:59], s82 offen offset:0 sc1
    buffer_load_dwordx4 v[196:199], v253, s[56:59], s82 offen offset:1024 sc1
    buffer_load_dwordx4 v[200:203], v253, s[56:59], s82 offen offset:2048 sc1
    buffer_load_dwordx4 v[204:207], v253, s[56:59], s82 offen offset:3072 sc1
    buffer_load_dwordx4 v[208:211], v253, s[56:59], s72 offen offset:0 sc1
    buffer_load_dwordx4 v[212:215], v253, s[56:59], s72 offen offset:1024 sc1
    buffer_load_dwordx4 v[216:219], v253, s[56:59], s72 offen offset:2048 sc1
    buffer_load_dwordx4 v[220:223], v253, s[56:59], s72 offen offset:3072 sc1
    buffer_load_dwordx4 v[224:227], v253, s[56:59], s73 offen offset:0 sc1
    buffer_load_dwordx4 v[228:231], v253, s[56:59], s73 offen offset:1024 sc1
    s_add_u32 s77, s77, 1
    s_cmp_lt_u32 s77, 262144
    s_waitcnt vmcnt(9)
    s_cbranch_scc1 L_oc0
    s_branch L_og0
L_or1:
    s_waitcnt vmcnt(0)
    s_sleep 4
    buffer_load_dwordx4 v[196:199], v253, s[56:59], s82 offen offset:1024 sc1
    buffer_load_dwordx4 v[200:203], v253, s[56:59], s82 offen offset:2048 sc1
    buffer_load_dwordx4 v[204:207], v253, s[56:59], s82 offen offset:3072 sc1
    buffer_load_dwordx4 v[208:211], v253, s[56:59], s72 offen offset:0 sc1
    buffer_load_dwordx4 v[212:215], v253, s[56:59], s72 offen offset:1024 sc1
    buffer_load_dwordx4 v[216:219], v253, s[56:59], s72 offen offset:2048 sc1
    buffer_load_dwordx4 v[220:223], v253, s[56:59], s72 offen offset:3072 sc1
    buffer_load_dwordx4 v[224:227], v253, s[56:59], s73 offen offset:0 sc1
    buffer_load_dwordx4 v[228:231], v253, s[56:59], s73 offen offset:1024 sc1
    s_add_u32 s77, s77, 1
    s_cmp_lt_u32 s77, 262144
    s_waitcnt vmcnt(8)
    s_cbranch_scc1 L_oc1
    s_branch L_og1
L_or2:
    s_waitcnt vmcnt(0)
    s_sleep 4
    buffer_load_dwordx4 v[200:203], v253, s[56:59], s82 offen offset:2048 sc1
    buffer_load_dwordx4 v[204:207], v253, s[56:59], s82 offen offset:3072 sc1
    buffer_load_dwordx4 v[208:211], v253, s[56:59], s72 offen offset:0 sc1
    buffer_load_dwordx4 v[212:215], v253, s[56:59], s72 offen offset:1024 sc1
    buffer_load_dwordx4 v[216:219], v253, s[56:59], s72 offen offset:2048 sc1
    buffer_load_dwordx4 v[220:223], v253, s[56:59], s72 offen offset:3072 sc1
    buffer_load_dwordx4 v[224:227], v253, s[56:59], s73 offen offset:0 sc1
    buffer_load_dwordx4 v[228:231], v253, s[56:59], s73 offen offset:1024 sc1
    s_add_u32 s77, s77, 1
    s_cmp_lt_u32 s77, 262144
    s_waitcnt vmcnt(7)
    s_cbranch_scc1 L_oc2
    s_branch L_og2
L_or3:
    s_waitcnt vmcnt(0)
    s_sleep 4
    buffer_load_dwordx4 v[204:207], v253, s[56:59], s82 offen offset:3072 sc1
    buffer_load_dwordx4 v[208:211], v253, s[56:59], s72 offen offset:0 sc1
    buffer_load_dwordx4 v[212:215], v253, s[56:59], s72 offen offset:1024 sc1
    buffer_load_dwordx4 v[216:219], v253, s[56:59], s72 offen offset:2048 sc1
    buffer_load_dwordx4 v[220:223], v253, s[56:59], s72 offen offset:3072 sc1
    buffer_load_dwordx4 v[224:227], v253, s[56:59], s73 offen offset:0 sc1
    buffer_load_dwordx4 v[228:231], v253, s[56:59], s73 offen offset:1024 sc1
    s_add_u32 s77, s77, 1
    s_cmp_lt_u32 s77, 262144
    s_waitcnt vmcnt(6)
    s_cbranch_scc1 L_oc3
    s_branch L_og3
L_or4:
    s_waitcnt vmcnt(0)
    s_sleep 4
    buffer_load_dwordx4 v[208:211], v253, s[56:59], s72 offen offset:0 sc1
    buffer_load_dwordx4 v[212:215], v253, s[56:59], s72 offen offset:1024 sc1
    buffer_load_dwordx4 v[216:219], v253, s[56:59], s72 offen offset:2048 sc1
    buffer_load_dwordx4 v[220:223], v253, s[56:59], s72 offen offset:3072 sc1
    buffer_load_dwordx4 v[224:227], v253, s[56:59], s73 offen offset:0 sc1
    buffer_load_dwordx4 v[228:231], v253, s[56:59], s73 offen offset:1024 sc1
    s_add_u32 s77, s77, 1
    s_cmp_lt_u32 s77, 262144
    s_waitcnt vmcnt(5)
    s_cbranch_scc1 L_oc4
    s_branch L_og4
L_or5:
    s_waitcnt vmcnt(0)
    s_sleep 4
    buffer_load_dwordx4 v[212:215], v253, s[56:59], s72 offen offset:1024 sc1
    buffer_load_dwordx4 v[216:219], v253, s[56:59], s72 offen offset:2048 sc1
    buffer_load_dwordx4 v[220:223], v253, s[56:59], s72 offen offset:3072 sc1
    buffer_load_dwordx4 v[224:227], v253, s[56:59], s73 offen offset:0 sc1
    buffer_load_dwordx4 v[228:231], v253, s[56:59], s73 offen offset:1024 sc1
    s_add_u32 s77, s77, 1
    s_cmp_lt_u32 s77, 262144
    s_waitcnt vmcnt(4)
    s_cbranch_scc1 L_oc5
    s_branch L_og5
L_or6:
    s_waitcnt vmcnt(0)
    s_sleep 4
    buffer_load_dwordx4 v[216:219], v253, s[56:59], s72 offen offset:2048 sc1
    buffer_load_dwordx4 v[220:223], v253, s[56:59], s72 offen offset:3072 sc1
    buffer_load_dwordx4 v[224:227], v253, s[56:59], s73 offen offset:0 sc1
    buffer_load_dwordx4 v[228:231], v253, s[56:59], s73 offen offset:1024 sc1
    s_add_u32 s77, s77, 1
    s_cmp_lt_u32 s77, 262144
    s_waitcnt vmcnt(3)
    s_cbranch_scc1 L_oc6
    s_branch L_og6
L_or7:
    s_waitcnt vmcnt(0)
    s_sleep 4
    buffer_load_dwordx4 v[220:223], v253, s[56:59], s72 offen offset:3072 sc1
    buffer_load_dwordx4 v[224:227], v253, s[56:59], s73 offen offset:0 sc1
    buffer_load_dwordx4 v[228:231], v253, s[56:59], s73 offen offset:1024 sc1
    s_add_u32 s77, s77, 1
    s_cmp_lt_u32 s77, 262144
    s_waitcnt vmcnt(2)
    s_cbranch_scc1 L_oc7
    s_branch L_og7
L_or8:
    s_waitcnt vmcnt(0)
    s_sleep 4
    buffer_load_dwordx4 v[224:227], v253, s[56:59], s73 offen offset:0 sc1
    buffer_load_dwordx4 v[228:231], v253, s[56:59], s73 offen offset:1024 sc1
    s_add_u32 s77, s77, 1
    s_cmp_lt_u32 s77, 262144
    s_waitcnt vmcnt(1)
    s_cbranch_scc1 L_oc8
    s_branch L_og8
L_or9:
    s_waitcnt vmcnt(0)
    s_sleep 4
    buffer_load_dwordx4 v[228:231], v253, s[56:59], s73 offen offset:1024 sc1
    s_add_u32 s77, s77, 1
    s_cmp_lt_u32 s77, 262144
    s_waitcnt vmcnt(0)
    s_cbranch_scc1 L_oc9
    s_branch L_og9
L_attn_loads:
    s_mul_i32 s72, s69, 40960
    buffer_load_dwordx2 v[168:169], v168, s[44:47], s72 offen sc1
    buffer_load_dwordx2 v[170:171], v170, s[44:47], s72 offen sc1
    buffer_load_dwordx2 v[184:185], v184, s[44:47], s72 offen sc1
    buffer_load_dwordx4 v[192:195], v253, s[44:47], s53 offen sc1
    buffer_load_dwordx2 v[204:205], v254, s[44:47], s53 offen offset:1024 sc1
    buffer_load_dwordx4 v[196:199], v0, s[44:47], s53 offen offset:1280 sc1
    buffer_load_dwordx4 v[200:203], v0, s[44:47], s53 offen offset:1952 sc1
    s_add_u32 s53, s53, 2688
    buffer_load_dwordx2 v[172:173], v172, s[44:47], s72 offen sc1
    buffer_load_dwordx2 v[174:175], v174, s[44:47], s72 offen sc1
    buffer_load_dwordx2 v[186:187], v186, s[44:47], s72 offen sc1
    buffer_load_dwordx2 v[176:177], v176, s[44:47], s72 offen sc1
    buffer_load_dwordx2 v[178:179], v178, s[44:47], s72 offen sc1
    buffer_load_dwordx2 v[188:189], v188, s[44:47], s72 offen sc1
    buffer_load_dwordx2 v[180:181], v180, s[44:47], s72 offen sc1
    buffer_load_dwordx2 v[182:183], v182, s[44:47], s72 offen sc1
    buffer_load_dwordx2 v[190:191], v190, s[44:47], s72 offen sc1
    buffer_load_dwordx4 v[206:209], v253, s[44:47], s53 offen sc1
    buffer_load_dwordx2 v[218:219], v254, s[44:47], s53 offen offset:1024 sc1
    buffer_load_dwordx4 v[210:213], v0, s[44:47], s53 offen offset:1280 sc1
    buffer_load_dwordx4 v[214:217], v0, s[44:47], s53 offen offset:1952 sc1
    s_add_u32 s53, s53, 2688
    buffer_load_dwordx4 v[220:223], v253, s[44:47], s53 offen sc1
    buffer_load_dwordx2 v[232:233], v254, s[44:47], s53 offen offset:1024 sc1
    buffer_load_dwordx4 v[224:227], v0, s[44:47], s53 offen offset:1280 sc1
    buffer_load_dwordx4 v[228:231], v0, s[44:47], s53 offen offset:1952 sc1
    s_add_u32 s53, s53, 2688
    s_setpc_b64 s[76:77]
L_attn:
    v_mfma_f32_32x32x16_bf16 v[32:47], v[242:245], v[242:245], 0
    v_mfma_f32_32x32x16_bf16 v[48:63], v[242:245], v[242:245], 0
    v_mfma_f32_32x32x16_bf16 v[128:143], v[242:245], v[242:245], 0
    v_mfma_f32_32x32x16_bf16 v[144:159], v[242:245], v[242:245], 0
    s_cmp_eq_u32 s86, 1
    s_cbranch_scc1 L_attn_go
    s_cmp_lg_u32 s3, 4
    s_cbranch_scc1 L_attn_w
    s_mov_b32 s77, 0
    s_lshr_b32 s73, s69, 2
    s_lshl_b32 s73, s73, 9
    v_and_b32 v2, 3, v250
    v_lshl_add_u32 v2, v2, 7, s73
    v_and_b32 v3, 15, v250
    v_lshlrev_b32 v3, 9, v3
    v_add_u32 v3, 384, v3
    s_mov_b32 s72, 2949120
    v_cndmask_b32 v2, v3, v2, s[92:93]
    buffer_load_dword v249, v2, s[44:47], s72 offen sc1
L19_spin:
    s_add_u32 s77, s77, 1
    s_waitcnt vmcnt(0)
    v_cmp_ne_u32 vcc, s79, v249
    s_cmp_eq_u64 vcc, 0
    s_cbranch_scc1 L20_done
    s_sleep 1
    buffer_load_dword v249, v2, s[44:47], s72 offen sc1
    s_cmp_lt_u32 s77, 262144
    s_cbranch_scc1 L19_spin
L20_done:
    v_mov_b32 v2, 155716
    v_mov_b32 v3, 1
    ds_write_b32 v2, v3
L_attn_w:
    v_mov_b32 v2, 155716
L21_lw:
    ds_read_b32 v4, v2
    s_waitcnt lgkmcnt(0)
    v_readfirstlane_b32 s76, v4
    s_nop 0
    s_cmp_eq_u32 s76, 1
    s_cbranch_scc1 L21_lw_d
    s_sleep 1
    s_branch L21_lw
L21_lw_d:
    s_call_b64 s[76:77], L_attn_loads
L_attn_go:
    s_cmp_ge_u32 s66, 24
    s_cbranch_scc1 L22_hs
    buffer_store_dwordx4 v[64:67], v253, s[44:47], s88 offen offset:0 sc1
    buffer_store_dwordx4 v[96:99], v253, s[44:47], s88 offen offset:1024 sc1
    buffer_store_dwordx4 v[80:83], v253, s[44:47], s89 offen offset:0 sc1
    buffer_store_dwordx4 v[112:115], v253, s[44:47], s89 offen offset:1024 sc1
L22_hs:
    s_lshl_b32 s72, s2, 3
    s_add_u32 s72, s72, s67
    s_cmp_lg_u32 s72, 0
    s_cbranch_scc1 L_attn_g2
    s_mov_b32 s72, 3141632
    v_mov_b32 v2, 0
    s_mov_b64 exec, 1
    buffer_store_dword v14, v2, s[44:47], s72 offen sc1
    s_mov_b64 exec, -1
L_attn_g2:
    v_mov_b32 v100, 0
    v_mov_b32 v101, 0
    v_mov_b32 v102, 0
    v_mov_b32 v103, 0
    s_mov_b32 s78, 0
    s_waitcnt vmcnt(17)
    ds_write_b32 v248, v15 offset:96
    v_mfma_f32_32x32x16_bf16 v[64:79], v[192:195], v[168:171], 0
    v_mfma_f32_32x32x8_bf16 v[64:79], v[204:205], v[184:185], v[64:79]
    s_nop 10
    .p2align 6
L_aloop:
    s_waitcnt vmcnt(14)
    v_mfma_f32_32x32x16_bf16 v[80:95], v[192:195], v[172:175], 0
    v_exp_f32 v64, v64
    v_exp_f32 v65, v65
    v_exp_f32 v66, v66
    v_exp_f32 v67, v67
    v_mfma_f32_32x32x16_bf16 v[144:159], v[242:245], v[100:103], v[144:159]
    v_cvt_pk_bf16_f32 v96, v64, v65
    v_cvt_pk_bf16_f32 v97, v66, v67
    buffer_load_dwordx4 v[234:237], v253, s[44:47], s53 offen sc1
    buffer_load_dwordx2 v[246:247], v254, s[44:47], s53 offen offset:1024 sc1
    buffer_load_dwordx4 v[238:241], v0, s[44:47], s53 offen offset:1280 sc1
    buffer_load_dwordx4 v[242:245], v0, s[44:47], s53 offen offset:1952 sc1
    s_add_u32 s53, s53, 2688
    v_exp_f32 v68, v68
    v_exp_f32 v69, v69
    v_exp_f32 v70, v70
    v_exp_f32 v71, v71
    v_mfma_f32_32x32x8_bf16 v[80:95], v[204:205], v[186:187], v[80:95]
    v_cvt_pk_bf16_f32 v98, v68, v69
    v_cvt_pk_bf16_f32 v99, v70, v71
    v_exp_f32 v72, v72
    v_exp_f32 v73, v73
    v_exp_f32 v74, v74
    v_exp_f32 v75, v75
    v_mfma_f32_32x32x16_bf16 v[32:47], v[196:199], v[96:99], v[32:47]
    v_cvt_pk_bf16_f32 v100, v72, v73
    v_cvt_pk_bf16_f32 v101, v74, v75
    v_exp_f32 v76, v76
    v_exp_f32 v77, v77
    v_exp_f32 v78, v78
    v_exp_f32 v79, v79
    v_cvt_pk_bf16_f32 v102, v76, v77
    v_cvt_pk_bf16_f32 v103, v78, v79
    s_waitcnt vmcnt(15)
    v_mfma_f32_32x32x16_bf16 v[64:79], v[192:195], v[176:179], 0
    v_exp_f32 v80, v80
    v_exp_f32 v81, v81
    v_exp_f32 v82, v82
    v_exp_f32 v83, v83
    v_mfma_f32_32x32x16_bf16 v[32:47], v[200:203], v[100:103], v[32:47]
    v_cvt_pk_bf16_f32 v96, v80, v81
    v_cvt_pk_bf16_f32 v97, v82, v83
    v_exp_f32 v84, v84
    v_exp_f32 v85, v85
    v_exp_f32 v86, v86
    v_exp_f32 v87, v87
    v_mfma_f32_32x32x8_bf16 v[64:79], v[204:205], v[188:189], v[64:79]
    v_cvt_pk_bf16_f32 v98, v84, v85
    v_cvt_pk_bf16_f32 v99, v86, v87
    v_exp_f32 v88, v88
    v_exp_f32 v89, v89
    v_exp_f32 v90, v90
    v_exp_f32 v91, v91
    v_mfma_f32_32x32x16_bf16 v[48:63], v[196:199], v[96:99], v[48:63]
    v_cvt_pk_bf16_f32 v100, v88, v89
    v_cvt_pk_bf16_f32 v101, v90, v91
    v_exp_f32 v92, v92
    v_exp_f32 v93, v93
    v_exp_f32 v94, v94
    v_exp_f32 v95, v95
    v_cvt_pk_bf16_f32 v102, v92, v93
    v_cvt_pk_bf16_f32 v103, v94, v95
    s_waitcnt vmcnt(12)
    v_mfma_f32_32x32x16_bf16 v[80:95], v[192:195], v[180:183], 0
    v_exp_f32 v64, v64
    v_exp_f32 v65, v65
    v_exp_f32 v66, v66
    v_exp_f32 v67, v67
    v_mfma_f32_32x32x16_bf16 v[48:63], v[200:203], v[100:103], v[48:63]
    v_cvt_pk_bf16_f32 v96, v64, v65
    v_cvt_pk_bf16_f32 v97, v66, v67
    v_exp_f32 v68, v68
    v_exp_f32 v69, v69
    v_exp_f32 v70, v70
    v_exp_f32 v71, v71
    v_mfma_f32_32x32x8_bf16 v[80:95], v[204:205], v[190:191], v[80:95]
    v_cvt_pk_bf16_f32 v98, v68, v69
    v_cvt_pk_bf16_f32 v99, v70, v71
    v_exp_f32 v72, v72
    v_exp_f32 v73, v73
    v_exp_f32 v74, v74
    v_exp_f32 v75, v75
    v_mfma_f32_32x32x16_bf16 v[128:143], v[196:199], v[96:99], v[128:143]
    v_cvt_pk_bf16_f32 v100, v72, v73
    v_cvt_pk_bf16_f32 v101, v74, v75
    v_exp_f32 v76, v76
    v_exp_f32 v77, v77
    v_exp_f32 v78, v78
    v_exp_f32 v79, v79
    v_cvt_pk_bf16_f32 v102, v76, v77
    v_cvt_pk_bf16_f32 v103, v78, v79
    s_waitcnt vmcnt(8)
    v_mfma_f32_32x32x16_bf16 v[64:79], v[206:209], v[168:171], 0
    v_exp_f32 v80, v80
    v_exp_f32 v81, v81
    v_exp_f32 v82, v82
    v_exp_f32 v83, v83
    v_mfma_f32_32x32x16_bf16 v[128:143], v[200:203], v[100:103], v[128:143]
    v_cvt_pk_bf16_f32 v96, v80, v81
    v_cvt_pk_bf16_f32 v97, v82, v83
    v_exp_f32 v84, v84
    v_exp_f32 v85, v85
    v_exp_f32 v86, v86
    v_exp_f32 v87, v87
    v_mfma_f32_32x32x8_bf16 v[64:79], v[218:219], v[184:185], v[64:79]
    v_cvt_pk_bf16_f32 v98, v84, v85
    v_cvt_pk_bf16_f32 v99, v86, v87
    v_exp_f32 v88, v88
    v_exp_f32 v89, v89
    v_exp_f32 v90, v90
    v_exp_f32 v91, v91
    v_mfma_f32_32x32x16_bf16 v[144:159], v[196:199], v[96:99], v[144:159]
    v_cvt_pk_bf16_f32 v100, v88, v89
    v_cvt_pk_bf16_f32 v101, v90, v91
    v_exp_f32 v92, v92
    v_exp_f32 v93, v93
    v_exp_f32 v94, v94
    v_exp_f32 v95, v95
    v_cvt_pk_bf16_f32 v102, v92, v93
    v_cvt_pk_bf16_f32 v103, v94, v95
    v_mfma_f32_32x32x16_bf16 v[80:95], v[206:209], v[172:175], 0
    v_exp_f32 v64, v64
    v_exp_f32 v65, v65
    v_exp_f32 v66, v66
    v_exp_f32 v67, v67
    v_mfma_f32_32x32x16_bf16 v[144:159], v[200:203], v[100:103], v[144:159]
    v_cvt_pk_bf16_f32 v96, v64, v65
    v_cvt_pk_bf16_f32 v97, v66, v67
    buffer_load_dwordx4 v[192:195], v253, s[44:47], s53 offen sc1
    buffer_load_dwordx2 v[204:205], v254, s[44:47], s53 offen offset:1024 sc1
    buffer_load_dwordx4 v[196:199], v0, s[44:47], s53 offen offset:1280 sc1
    buffer_load_dwordx4 v[200:203], v0, s[44:47], s53 offen offset:1952 sc1
    s_add_u32 s53, s53, 2688
    v_exp_f32 v68, v68
    v_exp_f32 v69, v69
    v_exp_f32 v70, v70
    v_exp_f32 v71, v71
    v_mfma_f32_32x32x8_bf16 v[80:95], v[218:219], v[186:187], v[80:95]
    v_cvt_pk_bf16_f32 v98, v68, v69
    v_cvt_pk_bf16_f32 v99, v70, v71
    v_exp_f32 v72, v72
    v_exp_f32 v73, v73
    v_exp_f32 v74, v74
    v_exp_f32 v75, v75
    v_mfma_f32_32x32x16_bf16 v[32:47], v[210:213], v[96:99], v[32:47]
    v_cvt_pk_bf16_f32 v100, v72, v73
    v_cvt_pk_bf16_f32 v101, v74, v75
    v_exp_f32 v76, v76
    v_exp_f32 v77, v77
    v_exp_f32 v78, v78
    v_exp_f32 v79, v79
    v_cvt_pk_bf16_f32 v102, v76, v77
    v_cvt_pk_bf16_f32 v103, v78, v79
    v_mfma_f32_32x32x16_bf16 v[64:79], v[206:209], v[176:179], 0
    v_exp_f32 v80, v80
    v_exp_f32 v81, v81
    v_exp_f32 v82, v82
    v_exp_f32 v83, v83
    v_mfma_f32_32x32x16_bf16 v[32:47], v[214:217], v[100:103], v[32:47]
    v_cvt_pk_bf16_f32 v96, v80, v81
    v_cvt_pk_bf16_f32 v97, v82, v83
    v_exp_f32 v84, v84
    v_exp_f32 v85, v85
    v_exp_f32 v86, v86
    v_exp_f32 v87, v87
    v_mfma_f32_32x32x8_bf16 v[64:79], v[218:219], v[188:189], v[64:79]
    v_cvt_pk_bf16_f32 v98, v84, v85
    v_cvt_pk_bf16_f32 v99, v86, v87
    v_exp_f32 v88, v88
    v_exp_f32 v89, v89
    v_exp_f32 v90, v90
    v_exp_f32 v91, v91
    v_mfma_f32_32x32x16_bf16 v[48:63], v[210:213], v[96:99], v[48:63]
    v_cvt_pk_bf16_f32 v100, v88, v89
    v_cvt_pk_bf16_f32 v101, v90, v91
    v_exp_f32 v92, v92
    v_exp_f32 v93, v93
    v_exp_f32 v94, v94
    v_exp_f32 v95, v95
    v_cvt_pk_bf16_f32 v102, v92, v93
    v_cvt_pk_bf16_f32 v103, v94, v95
    v_mfma_f32_32x32x16_bf16 v[80:95], v[206:209], v[180:183], 0
    v_exp_f32 v64, v64
    v_exp_f32 v65, v65
    v_exp_f32 v66, v66
    v_exp_f32 v67, v67
    v_mfma_f32_32x32x16_bf16 v[48:63], v[214:217], v[100:103], v[48:63]
    v_cvt_pk_bf16_f32 v96, v64, v65
    v_cvt_pk_bf16_f32 v97, v66, v67
    v_exp_f32 v68, v68
    v_exp_f32 v69, v69
    v_exp_f32 v70, v70
    v_exp_f32 v71, v71
    v_mfma_f32_32x32x8_bf16 v[80:95], v[218:219], v[190:191], v[80:95]
    v_cvt_pk_bf16_f32 v98, v68, v69
    v_cvt_pk_bf16_f32 v99, v70, v71
    v_exp_f32 v72, v72
    v_exp_f32 v73, v73
    v_exp_f32 v74, v74
    v_exp_f32 v75, v75
    v_mfma_f32_32x32x16_bf16 v[128:143], v[210:213], v[96:99], v[128:143]
    v_cvt_pk_bf16_f32 v100, v72, v73
    v_cvt_pk_bf16_f32 v101, v74, v75
    v_exp_f32 v76, v76
    v_exp_f32 v77, v77
    v_exp_f32 v78, v78
    v_exp_f32 v79, v79
    v_cvt_pk_bf16_f32 v102, v76, v77
    v_cvt_pk_bf16_f32 v103, v78, v79
    s_waitcnt vmcnt(8)
    ds_write_b32 v248, v15
    v_mfma_f32_32x32x16_bf16 v[64:79], v[220:223], v[168:171], 0
    v_exp_f32 v80, v80
    v_exp_f32 v81, v81
    v_exp_f32 v82, v82
    v_exp_f32 v83, v83
    v_mfma_f32_32x32x16_bf16 v[128:143], v[214:217], v[100:103], v[128:143]
    v_cvt_pk_bf16_f32 v96, v80, v81
    v_cvt_pk_bf16_f32 v97, v82, v83
    v_exp_f32 v84, v84
    v_exp_f32 v85, v85
    v_exp_f32 v86, v86
    v_exp_f32 v87, v87
    v_mfma_f32_32x32x8_bf16 v[64:79], v[232:233], v[184:185], v[64:79]
    v_cvt_pk_bf16_f32 v98, v84, v85
    v_cvt_pk_bf16_f32 v99, v86, v87
    v_exp_f32 v88, v88
    v_exp_f32 v89, v89
    v_exp_f32 v90, v90
    v_exp_f32 v91, v91
    v_mfma_f32_32x32x16_bf16 v[144:159], v[210:213], v[96:99], v[144:159]
    v_cvt_pk_bf16_f32 v100, v88, v89
    v_cvt_pk_bf16_f32 v101, v90, v91
    v_exp_f32 v92, v92
    v_exp_f32 v93, v93
    v_exp_f32 v94, v94
    v_exp_f32 v95, v95
    v_cvt_pk_bf16_f32 v102, v92, v93
    v_cvt_pk_bf16_f32 v103, v94, v95
    v_mfma_f32_32x32x16_bf16 v[80:95], v[220:223], v[172:175], 0
    v_exp_f32 v64, v64
    v_exp_f32 v65, v65
    v_exp_f32 v66, v66
    v_exp_f32 v67, v67
    v_mfma_f32_32x32x16_bf16 v[144:159], v[214:217], v[100:103], v[144:159]
    v_cvt_pk_bf16_f32 v96, v64, v65
    v_cvt_pk_bf16_f32 v97, v66, v67
    buffer_load_dwordx4 v[206:209], v253, s[44:47], s53 offen sc1
    buffer_load_dwordx2 v[218:219], v254, s[44:47], s53 offen offset:1024 sc1
    buffer_load_dwordx4 v[210:213], v0, s[44:47], s53 offen offset:1280 sc1
    buffer_load_dwordx4 v[214:217], v0, s[44:47], s53 offen offset:1952 sc1
    s_add_u32 s53, s53, 2688
    v_exp_f32 v68, v68
    v_exp_f32 v69, v69
    v_exp_f32 v70, v70
    v_exp_f32 v71, v71
    v_mfma_f32_32x32x8_bf16 v[80:95], v[232:233], v[186:187], v[80:95]
    v_cvt_pk_bf16_f32 v98, v68, v69
    v_cvt_pk_bf16_f32 v99, v70, v71
    v_exp_f32 v72, v72
    v_exp_f32 v73, v73
    v_exp_f32 v74, v74
    v_exp_f32 v75, v75
    v_mfma_f32_32x32x16_bf16 v[32:47], v[224:227], v[96:99], v[32:47]
    v_cvt_pk_bf16_f32 v100, v72, v73
    v_cvt_pk_bf16_f32 v101, v74, v75
    v_exp_f32 v76, v76
    v_exp_f32 v77, v77
    v_exp_f32 v78, v78
    v_exp_f32 v79, v79
    v_cvt_pk_bf16_f32 v102, v76, v77
    v_cvt_pk_bf16_f32 v103, v78, v79
    v_mfma_f32_32x32x16_bf16 v[64:79], v[220:223], v[176:179], 0
    v_exp_f32 v80, v80
    v_exp_f32 v81, v81
    v_exp_f32 v82, v82
    v_exp_f32 v83, v83
    v_mfma_f32_32x32x16_bf16 v[32:47], v[228:231], v[100:103], v[32:47]
    v_cvt_pk_bf16_f32 v96, v80, v81
    v_cvt_pk_bf16_f32 v97, v82, v83
    v_exp_f32 v84, v84
    v_exp_f32 v85, v85
    v_exp_f32 v86, v86
    v_exp_f32 v87, v87
    v_mfma_f32_32x32x8_bf16 v[64:79], v[232:233], v[188:189], v[64:79]
    v_cvt_pk_bf16_f32 v98, v84, v85
    v_cvt_pk_bf16_f32 v99, v86, v87
    v_exp_f32 v88, v88
    v_exp_f32 v89, v89
    v_exp_f32 v90, v90
    v_exp_f32 v91, v91
    v_mfma_f32_32x32x16_bf16 v[48:63], v[224:227], v[96:99], v[48:63]
    v_cvt_pk_bf16_f32 v100, v88, v89
    v_cvt_pk_bf16_f32 v101, v90, v91
    v_exp_f32 v92, v92
    v_exp_f32 v93, v93
    v_exp_f32 v94, v94
    v_exp_f32 v95, v95
    v_cvt_pk_bf16_f32 v102, v92, v93
    v_cvt_pk_bf16_f32 v103, v94, v95
    v_mfma_f32_32x32x16_bf16 v[80:95], v[220:223], v[180:183], 0
    v_exp_f32 v64, v64
    v_exp_f32 v65, v65
    v_exp_f32 v66, v66
    v_exp_f32 v67, v67
    v_mfma_f32_32x32x16_bf16 v[48:63], v[228:231], v[100:103], v[48:63]
    v_cvt_pk_bf16_f32 v96, v64, v65
    v_cvt_pk_bf16_f32 v97, v66, v67
    v_exp_f32 v68, v68
    v_exp_f32 v69, v69
    v_exp_f32 v70, v70
    v_exp_f32 v71, v71
    v_mfma_f32_32x32x8_bf16 v[80:95], v[232:233], v[190:191], v[80:95]
    v_cvt_pk_bf16_f32 v98, v68, v69
    v_cvt_pk_bf16_f32 v99, v70, v71
    v_exp_f32 v72, v72
    v_exp_f32 v73, v73
    v_exp_f32 v74, v74
    v_exp_f32 v75, v75
    v_mfma_f32_32x32x16_bf16 v[128:143], v[224:227], v[96:99], v[128:143]
    v_cvt_pk_bf16_f32 v100, v72, v73
    v_cvt_pk_bf16_f32 v101, v74, v75
    v_exp_f32 v76, v76
    v_exp_f32 v77, v77
    v_exp_f32 v78, v78
    v_exp_f32 v79, v79
    v_cvt_pk_bf16_f32 v102, v76, v77
    v_cvt_pk_bf16_f32 v103, v78, v79
    s_waitcnt vmcnt(8)
    v_mfma_f32_32x32x16_bf16 v[64:79], v[234:237], v[168:171], 0
    v_exp_f32 v80, v80
    v_exp_f32 v81, v81
    v_exp_f32 v82, v82
    v_exp_f32 v83, v83
    v_mfma_f32_32x32x16_bf16 v[128:143], v[228:231], v[100:103], v[128:143]
    v_cvt_pk_bf16_f32 v96, v80, v81
    v_cvt_pk_bf16_f32 v97, v82, v83
    v_exp_f32 v84, v84
    v_exp_f32 v85, v85
    v_exp_f32 v86, v86
    v_exp_f32 v87, v87
    v_mfma_f32_32x32x8_bf16 v[64:79], v[246:247], v[184:185], v[64:79]
    v_cvt_pk_bf16_f32 v98, v84, v85
    v_cvt_pk_bf16_f32 v99, v86, v87
    v_exp_f32 v88, v88
    v_exp_f32 v89, v89
    v_exp_f32 v90, v90
    v_exp_f32 v91, v91
    v_mfma_f32_32x32x16_bf16 v[144:159], v[224:227], v[96:99], v[144:159]
    v_cvt_pk_bf16_f32 v100, v88, v89
    v_cvt_pk_bf16_f32 v101, v90, v91
    v_exp_f32 v92, v92
    v_exp_f32 v93, v93
    v_exp_f32 v94, v94
    v_exp_f32 v95, v95
    v_cvt_pk_bf16_f32 v102, v92, v93
    v_cvt_pk_bf16_f32 v103, v94, v95
    v_mfma_f32_32x32x16_bf16 v[80:95], v[234:237], v[172:175], 0
    v_exp_f32 v64, v64
    v_exp_f32 v65, v65
    v_exp_f32 v66, v66
    v_exp_f32 v67, v67
    v_mfma_f32_32x32x16_bf16 v[144:159], v[228:231], v[100:103], v[144:159]
    v_cvt_pk_bf16_f32 v96, v64, v65
    v_cvt_pk_bf16_f32 v97, v66, v67
    buffer_load_dwordx4 v[220:223], v253, s[44:47], s53 offen sc1
    buffer_load_dwordx2 v[232:233], v254, s[44:47], s53 offen offset:1024 sc1
    buffer_load_dwordx4 v[224:227], v0, s[44:47], s53 offen offset:1280 sc1
    buffer_load_dwordx4 v[228:231], v0, s[44:47], s53 offen offset:1952 sc1
    s_add_u32 s53, s53, 2688
    v_exp_f32 v68, v68
    v_exp_f32 v69, v69
    v_exp_f32 v70, v70
    v_exp_f32 v71, v71
    v_mfma_f32_32x32x8_bf16 v[80:95], v[246:247], v[186:187], v[80:95]
    v_cvt_pk_bf16_f32 v98, v68, v69
    v_cvt_pk_bf16_f32 v99, v70, v71
    v_exp_f32 v72, v72
    v_exp_f32 v73, v73
    v_exp_f32 v74, v74
    v_exp_f32 v75, v75
    v_mfma_f32_32x32x16_bf16 v[32:47], v[238:241], v[96:99], v[32:47]
    v_cvt_pk_bf16_f32 v100, v72, v73
    v_cvt_pk_bf16_f32 v101, v74, v75
    v_exp_f32 v76, v76
    v_exp_f32 v77, v77
    v_exp_f32 v78, v78
    v_exp_f32 v79, v79
    v_cvt_pk_bf16_f32 v102, v76, v77
    v_cvt_pk_bf16_f32 v103, v78, v79
    v_mfma_f32_32x32x16_bf16 v[64:79], v[234:237], v[176:179], 0
    v_exp_f32 v80, v80
    v_exp_f32 v81, v81
    v_exp_f32 v82, v82
    v_exp_f32 v83, v83
    v_mfma_f32_32x32x16_bf16 v[32:47], v[242:245], v[100:103], v[32:47]
    v_cvt_pk_bf16_f32 v96, v80, v81
    v_cvt_pk_bf16_f32 v97, v82, v83
    v_exp_f32 v84, v84
    v_exp_f32 v85, v85
    v_exp_f32 v86, v86
    v_exp_f32 v87, v87
    v_mfma_f32_32x32x8_bf16 v[64:79], v[246:247], v[188:189], v[64:79]
    v_cvt_pk_bf16_f32 v98, v84, v85
    v_cvt_pk_bf16_f32 v99, v86, v87
    v_exp_f32 v88, v88
    v_exp_f32 v89, v89
    v_exp_f32 v90, v90
    v_exp_f32 v91, v91
    v_mfma_f32_32x32x16_bf16 v[48:63], v[238:241], v[96:99], v[48:63]
    v_cvt_pk_bf16_f32 v100, v88, v89
    v_cvt_pk_bf16_f32 v101, v90, v91
    v_exp_f32 v92, v92
    v_exp_f32 v93, v93
    v_exp_f32 v94, v94
    v_exp_f32 v95, v95
    v_cvt_pk_bf16_f32 v102, v92, v93
    v_cvt_pk_bf16_f32 v103, v94, v95
    v_mfma_f32_32x32x16_bf16 v[80:95], v[234:237], v[180:183], 0
    v_exp_f32 v64, v64
    v_exp_f32 v65, v65
    v_exp_f32 v66, v66
    v_exp_f32 v67, v67
    v_mfma_f32_32x32x16_bf16 v[48:63], v[242:245], v[100:103], v[48:63]
    v_cvt_pk_bf16_f32 v96, v64, v65
    v_cvt_pk_bf16_f32 v97, v66, v67
    v_exp_f32 v68, v68
    v_exp_f32 v69, v69
    v_exp_f32 v70, v70
    v_exp_f32 v71, v71
    v_mfma_f32_32x32x8_bf16 v[80:95], v[246:247], v[190:191], v[80:95]
    v_cvt_pk_bf16_f32 v98, v68, v69
    v_cvt_pk_bf16_f32 v99, v70, v71
    v_exp_f32 v72, v72
    v_exp_f32 v73, v73
    v_exp_f32 v74, v74
    v_exp_f32 v75, v75
    v_mfma_f32_32x32x16_bf16 v[128:143], v[238:241], v[96:99], v[128:143]
    v_cvt_pk_bf16_f32 v100, v72, v73
    v_cvt_pk_bf16_f32 v101, v74, v75
    v_exp_f32 v76, v76
    v_exp_f32 v77, v77
    v_exp_f32 v78, v78
    v_exp_f32 v79, v79
    v_cvt_pk_bf16_f32 v102, v76, v77
    v_cvt_pk_bf16_f32 v103, v78, v79
    s_waitcnt vmcnt(8)
    v_mfma_f32_32x32x16_bf16 v[64:79], v[192:195], v[168:171], 0
    v_exp_f32 v80, v80
    v_exp_f32 v81, v81
    v_exp_f32 v82, v82
    v_exp_f32 v83, v83
    v_mfma_f32_32x32x16_bf16 v[128:143], v[242:245], v[100:103], v[128:143]
    v_cvt_pk_bf16_f32 v96, v80, v81
    v_cvt_pk_bf16_f32 v97, v82, v83
    v_exp_f32 v84, v84
    v_exp_f32 v85, v85
    v_exp_f32 v86, v86
    v_exp_f32 v87, v87
    v_mfma_f32_32x32x8_bf16 v[64:79], v[204:205], v[184:185], v[64:79]
    v_cvt_pk_bf16_f32 v98, v84, v85
    v_cvt_pk_bf16_f32 v99, v86, v87
    v_exp_f32 v88, v88
    v_exp_f32 v89, v89
    v_exp_f32 v90, v90
    v_exp_f32 v91, v91
    v_mfma_f32_32x32x16_bf16 v[144:159], v[238:241], v[96:99], v[144:159]
    v_cvt_pk_bf16_f32 v100, v88, v89
    v_cvt_pk_bf16_f32 v101, v90, v91
    v_exp_f32 v92, v92
    v_exp_f32 v93, v93
    v_exp_f32 v94, v94
    v_exp_f32 v95, v95
    v_cvt_pk_bf16_f32 v102, v92, v93
    v_cvt_pk_bf16_f32 v103, v94, v95
    s_add_u32 s78, s78, 1
    s_cmp_lt_u32 s78, 8
    s_cbranch_scc1 L_aloop
    s_nop 0
    v_mfma_f32_32x32x16_bf16 v[144:159], v[242:245], v[100:103], v[144:159]
    ds_write_b128 v22, v[128:131] offset:0
    ds_write_b128 v22, v[132:135] offset:1024
    ds_write_b128 v22, v[136:139] offset:2048
    s_nop 9
    ds_write_b128 v22, v[144:147] offset:4096
    ds_write_b128 v22, v[148:151] offset:5120
    ds_write_b128 v22, v[152:155] offset:6144
    s_waitcnt lgkmcnt(0)
    ds_write_b32 v248, v15 offset:16
L_apoll:
    ds_read_b32 v2, v255 offset:16
    s_waitcnt lgkmcnt(0)
    v_readfirstlane_b32 s72, v2
    s_nop 0
    s_cmp_eq_u32 s72, 1
    s_cbranch_scc0 L_apoll
    ds_read_b128 v[128:131], v23 offset:0
    ds_read_b128 v[132:135], v23 offset:1024
    ds_read_b128 v[136:139], v23 offset:2048
    ds_read_b128 v[144:147], v23 offset:4096
    ds_read_b128 v[148:151], v23 offset:5120
    ds_read_b128 v[152:155], v23 offset:6144
    s_waitcnt lgkmcnt(3)
    v_pk_add_f32 v[32:33], v[32:33], v[128:129]
    v_pk_add_f32 v[34:35], v[34:35], v[130:131]
    v_pk_add_f32 v[36:37], v[36:37], v[132:133]
    v_pk_add_f32 v[38:39], v[38:39], v[134:135]
    v_pk_add_f32 v[40:41], v[40:41], v[136:137]
    v_pk_add_f32 v[42:43], v[42:43], v[138:139]
    s_waitcnt lgkmcnt(0)
    v_pk_add_f32 v[48:49], v[48:49], v[144:145]
    v_pk_add_f32 v[50:51], v[50:51], v[146:147]
    v_pk_add_f32 v[52:53], v[52:53], v[148:149]
    v_pk_add_f32 v[54:55], v[54:55], v[150:151]
    v_pk_add_f32 v[56:57], v[56:57], v[152:153]
    v_pk_add_f32 v[58:59], v[58:59], v[154:155]
    v_mov_b32 v4, v40
    v_mov_b32 v5, v40
    v_mov_b32 v6, v56
    v_mov_b32 v7, v56
    s_nop 0
    v_permlane32_swap_b32 v5, v4
    v_permlane32_swap_b32 v7, v6
    v_mov_b32 v2, 0
    v_mov_b32 v3, 0
    v_mov_b32 v8, 0
    v_pk_fma_f32 v[2:3], v[32:33], v[8:9], v[2:3] op_sel_hi:[1,0,1]
    v_pk_fma_f32 v[2:3], v[34:35], v[8:9], v[2:3] op_sel_hi:[1,0,1]
    v_pk_fma_f32 v[2:3], v[36:37], v[8:9], v[2:3] op_sel_hi:[1,0,1]
    v_pk_fma_f32 v[2:3], v[38:39], v[8:9], v[2:3] op_sel_hi:[1,0,1]
    v_pk_fma_f32 v[2:3], v[40:41], v[8:9], v[2:3] op_sel_hi:[1,0,1]
    v_pk_fma_f32 v[2:3], v[42:43], v[8:9], v[2:3] op_sel_hi:[1,0,1]
    v_pk_fma_f32 v[2:3], v[48:49], v[8:9], v[2:3] op_sel_hi:[1,0,1]
    v_pk_fma_f32 v[2:3], v[50:51], v[8:9], v[2:3] op_sel_hi:[1,0,1]
    v_pk_fma_f32 v[2:3], v[52:53], v[8:9], v[2:3] op_sel_hi:[1,0,1]
    v_pk_fma_f32 v[2:3], v[54:55], v[8:9], v[2:3] op_sel_hi:[1,0,1]
    v_pk_fma_f32 v[2:3], v[56:57], v[8:9], v[2:3] op_sel_hi:[1,0,1]
    v_pk_fma_f32 v[2:3], v[58:59], v[8:9], v[2:3] op_sel_hi:[1,0,1]
    v_min_f32 v10, v4, v6
    v_max_f32 v11, v4, v6
    v_fmac_f32 v2, 0, v4
    v_fmac_f32 v3, 0, v6
    v_cmp_le_f32 vcc, 0x1f800000, v10
    s_mov_b64 s[72:73], vcc
    v_cmp_ge_f32 vcc, 0x5f800000, v11
    s_and_b64 s[72:73], s[72:73], vcc
    v_cmp_o_f32 vcc, v2, v3
    s_and_b64 s[72:73], s[72:73], vcc
    s_cmp_eq_u64 s[72:73], exec
    s_cbranch_scc0 L_fb
L_norm:
    v_rcp_f32 v4, v4
    v_rcp_f32 v6, v6
    s_nop 0
    v_pk_mul_f32 v[32:33], v[32:33], v[4:5] op_sel_hi:[1,0]
    v_pk_mul_f32 v[34:35], v[34:35], v[4:5] op_sel_hi:[1,0]
    v_pk_mul_f32 v[36:37], v[36:37], v[4:5] op_sel_hi:[1,0]
    v_pk_mul_f32 v[38:39], v[38:39], v[4:5] op_sel_hi:[1,0]
    v_pk_mul_f32 v[40:41], v[40:41], v[4:5] op_sel_hi:[1,0]
    v_pk_mul_f32 v[42:43], v[42:43], v[4:5] op_sel_hi:[1,0]
    v_pk_mul_f32 v[48:49], v[48:49], v[6:7] op_sel_hi:[1,0]
    v_pk_mul_f32 v[50:51], v[50:51], v[6:7] op_sel_hi:[1,0]
    v_pk_mul_f32 v[52:53], v[52:53], v[6:7] op_sel_hi:[1,0]
    v_pk_mul_f32 v[54:55], v[54:55], v[6:7] op_sel_hi:[1,0]
    v_pk_mul_f32 v[56:57], v[56:57], v[6:7] op_sel_hi:[1,0]
    v_pk_mul_f32 v[58:59], v[58:59], v[6:7] op_sel_hi:[1,0]
    v_cvt_pk_bf16_f32 v32, v32, v33
    v_cvt_pk_bf16_f32 v33, v34, v35
    v_cvt_pk_bf16_f32 v34, v36, v37
    v_cvt_pk_bf16_f32 v35, v38, v39
    v_min_u32 v32, -2, v32
    v_min_u32 v33, -2, v33
    v_min_u32 v34, -2, v34
    v_min_u32 v35, -2, v35
    v_cvt_pk_bf16_f32 v36, v40, v41
    v_cvt_pk_bf16_f32 v37, v42, v43
    v_permlane32_swap_b32 v32, v34
    v_permlane32_swap_b32 v33, v35
    v_cvt_pk_bf16_f32 v38, v48, v49
    v_cvt_pk_bf16_f32 v39, v50, v51
    buffer_store_dwordx4 v[32:35], v253, s[44:47], s56 offen sc1
    v_cvt_pk_bf16_f32 v48, v52, v53
    v_cvt_pk_bf16_f32 v49, v54, v55
    v_cvt_pk_bf16_f32 v52, v56, v57
    v_cvt_pk_bf16_f32 v53, v58, v59
    v_min_u32 v36, -2, v36
    v_min_u32 v37, -2, v37
    v_min_u32 v38, -2, v38
    v_min_u32 v39, -2, v39
    v_min_u32 v48, -2, v48
    v_min_u32 v49, -2, v49
    v_min_u32 v52, -2, v52
    v_min_u32 v53, -2, v53
    v_cndmask_b32 v36, v36, v38, s[92:93]
    v_cndmask_b32 v37, v37, v39, s[92:93]
    v_permlane32_swap_b32 v38, v48
    v_permlane32_swap_b32 v39, v49
    v_permlane32_swap_b32 v50, v52
    v_permlane32_swap_b32 v51, v53
    buffer_store_dwordx4 v[36:39], v253, s[44:47], s56 offen offset:1024 sc1
    s_mov_b32 exec_lo, 0
    buffer_store_dwordx4 v[48:51], v253, s[44:47], s56 offen offset:1536 sc1
    s_mov_b64 exec, -1
    ds_write_b32 v248, v15 offset:64
    s_endpgm
L_fb:
    s_waitcnt vmcnt(0)
    v_mov_b32 v4, 0xff800000
    v_mov_b32 v5, 0xff800000
    s_mov_b32 s53, 2621440
    s_mov_b32 s78, 0
L_fb1:
    buffer_load_dwordx4 v[192:195], v253, s[44:47], s53 offen sc1
    buffer_load_dwordx2 v[204:205], v254, s[44:47], s53 offen offset:1024 sc1
    buffer_load_dwordx4 v[196:199], v0, s[44:47], s53 offen offset:1280 sc1
    buffer_load_dwordx4 v[200:203], v0, s[44:47], s53 offen offset:1952 sc1
    s_add_u32 s53, s53, 2688
    s_waitcnt vmcnt(0)
    v_mfma_f32_32x32x16_bf16 v[64:79], v[192:195], v[168:171], 0
    v_mfma_f32_32x32x8_bf16 v[64:79], v[204:205], v[184:185], v[64:79]
    v_mfma_f32_32x32x16_bf16 v[80:95], v[192:195], v[172:175], 0
    v_mfma_f32_32x32x8_bf16 v[80:95], v[204:205], v[186:187], v[80:95]
    s_nop 15
    v_max3_f32 v4, v64, v65, v4
    v_max3_f32 v4, v66, v67, v4
    v_max3_f32 v4, v68, v69, v4
    v_max3_f32 v4, v70, v71, v4
    v_max3_f32 v4, v72, v73, v4
    v_max3_f32 v4, v74, v75, v4
    v_max3_f32 v4, v76, v77, v4
    v_max3_f32 v4, v78, v79, v4
    v_max3_f32 v5, v80, v81, v5
    v_max3_f32 v5, v82, v83, v5
    v_max3_f32 v5, v84, v85, v5
    v_max3_f32 v5, v86, v87, v5
    v_max3_f32 v5, v88, v89, v5
    v_max3_f32 v5, v90, v91, v5
    v_max3_f32 v5, v92, v93, v5
    v_max3_f32 v5, v94, v95, v5
    s_add_u32 s78, s78, 1
    s_cmp_lt_u32 s78, 64
    s_cbranch_scc1 L_fb1
    v_mov_b32 v6, v4
    s_nop 1
    v_permlane32_swap_b32 v6, v4
    s_nop 1
    v_max_f32 v6, v6, v4
    v_sub_f32 v6, 0, v6
    v_cvt_pk_bf16_f32 v7, v6, v6
    v_lshlrev_b32 v7, 16, v7
    v_sub_f32 v8, v6, v7
    v_cvt_pk_bf16_f32 v7, v7, v8
    v_cndmask_b32 v184, v184, v7, s[92:93]
    v_mov_b32 v32, 0
    v_mov_b32 v33, 0
    v_mov_b32 v34, 0
    v_mov_b32 v35, 0
    v_mov_b32 v36, 0
    v_mov_b32 v37, 0
    v_mov_b32 v38, 0
    v_mov_b32 v39, 0
    v_mov_b32 v40, 0
    v_mov_b32 v41, 0
    v_mov_b32 v42, 0
    v_mov_b32 v43, 0
    v_mov_b32 v44, 0
    v_mov_b32 v45, 0
    v_mov_b32 v46, 0
    v_mov_b32 v47, 0
    v_mov_b32 v6, v5
    s_nop 1
    v_permlane32_swap_b32 v6, v5
    s_nop 1
    v_max_f32 v6, v6, v5
    v_sub_f32 v6, 0, v6
    v_cvt_pk_bf16_f32 v7, v6, v6
    v_lshlrev_b32 v7, 16, v7
    v_sub_f32 v8, v6, v7
    v_cvt_pk_bf16_f32 v7, v7, v8
    v_cndmask_b32 v186, v186, v7, s[92:93]
    v_mov_b32 v48, 0
    v_mov_b32 v49, 0
    v_mov_b32 v50, 0
    v_mov_b32 v51, 0
    v_mov_b32 v52, 0
    v_mov_b32 v53, 0
    v_mov_b32 v54, 0
    v_mov_b32 v55, 0
    v_mov_b32 v56, 0
    v_mov_b32 v57, 0
    v_mov_b32 v58, 0
    v_mov_b32 v59, 0
    v_mov_b32 v60, 0
    v_mov_b32 v61, 0
    v_mov_b32 v62, 0
    v_mov_b32 v63, 0
    s_mov_b32 s53, 2621440
    s_mov_b32 s78, 0
    v_mov_b32 v9, 0x3f803f80
L_fb2:
    buffer_load_dwordx4 v[192:195], v253, s[44:47], s53 offen sc1
    buffer_load_dwordx2 v[204:205], v254, s[44:47], s53 offen offset:1024 sc1
    buffer_load_dwordx4 v[196:199], v0, s[44:47], s53 offen offset:1280 sc1
    buffer_load_dwordx4 v[200:203], v0, s[44:47], s53 offen offset:1952 sc1
    s_add_u32 s53, s53, 2688
    s_waitcnt vmcnt(0)
    v_cndmask_b32 v204, v204, v9, s[92:93]
    s_nop 1
    v_mfma_f32_32x32x16_bf16 v[64:79], v[192:195], v[168:171], 0
    v_mfma_f32_32x32x8_bf16 v[64:79], v[204:205], v[184:185], v[64:79]
    v_mfma_f32_32x32x16_bf16 v[80:95], v[192:195], v[172:175], 0
    v_mfma_f32_32x32x8_bf16 v[80:95], v[204:205], v[186:187], v[80:95]
    s_nop 15
    v_exp_f32 v64, v64
    v_exp_f32 v65, v65
    v_exp_f32 v66, v66
    v_exp_f32 v67, v67
    v_exp_f32 v68, v68
    v_exp_f32 v69, v69
    v_exp_f32 v70, v70
    v_exp_f32 v71, v71
    v_exp_f32 v72, v72
    v_exp_f32 v73, v73
    v_exp_f32 v74, v74
    v_exp_f32 v75, v75
    v_exp_f32 v76, v76
    v_exp_f32 v77, v77
    v_exp_f32 v78, v78
    v_exp_f32 v79, v79
    s_nop 0
    v_cvt_pk_bf16_f32 v96, v64, v65
    v_cvt_pk_bf16_f32 v97, v66, v67
    v_cvt_pk_bf16_f32 v98, v68, v69
    v_cvt_pk_bf16_f32 v99, v70, v71
    v_cvt_pk_bf16_f32 v100, v72, v73
    v_cvt_pk_bf16_f32 v101, v74, v75
    v_cvt_pk_bf16_f32 v102, v76, v77
    v_cvt_pk_bf16_f32 v103, v78, v79
    s_nop 1
    v_mfma_f32_32x32x16_bf16 v[32:47], v[196:199], v[96:99], v[32:47]
    v_mfma_f32_32x32x16_bf16 v[32:47], v[200:203], v[100:103], v[32:47]
    v_exp_f32 v80, v80
    v_exp_f32 v81, v81
    v_exp_f32 v82, v82
    v_exp_f32 v83, v83
    v_exp_f32 v84, v84
    v_exp_f32 v85, v85
    v_exp_f32 v86, v86
    v_exp_f32 v87, v87
    v_exp_f32 v88, v88
    v_exp_f32 v89, v89
    v_exp_f32 v90, v90
    v_exp_f32 v91, v91
    v_exp_f32 v92, v92
    v_exp_f32 v93, v93
    v_exp_f32 v94, v94
    v_exp_f32 v95, v95
    s_nop 0
    v_cvt_pk_bf16_f32 v96, v80, v81
    v_cvt_pk_bf16_f32 v97, v82, v83
    v_cvt_pk_bf16_f32 v98, v84, v85
    v_cvt_pk_bf16_f32 v99, v86, v87
    v_cvt_pk_bf16_f32 v100, v88, v89
    v_cvt_pk_bf16_f32 v101, v90, v91
    v_cvt_pk_bf16_f32 v102, v92, v93
    v_cvt_pk_bf16_f32 v103, v94, v95
    s_nop 1
    v_mfma_f32_32x32x16_bf16 v[48:63], v[196:199], v[96:99], v[48:63]
    v_mfma_f32_32x32x16_bf16 v[48:63], v[200:203], v[100:103], v[48:63]
    s_add_u32 s78, s78, 1
    s_cmp_lt_u32 s78, 64
    s_cbranch_scc1 L_fb2
    s_nop 15
    v_mov_b32 v4, v40
    v_mov_b32 v5, v40
    v_mov_b32 v6, v56
    v_mov_b32 v7, v56
    s_nop 0
    v_permlane32_swap_b32 v5, v4
    v_permlane32_swap_b32 v7, v6
    s_nop 1
    s_branch L_norm
L_end:
    s_endpgm
.section .rodata,"a"
.p2align 6
.amdhsa_kernel parallel_sum__grouped_kv_mqa__glu_gated_bilinear__prompt_kernel
  .amdhsa_next_free_vgpr 256
  .amdhsa_next_free_sgpr 102
  .amdhsa_accum_offset 256
  .amdhsa_group_segment_fixed_size 0
  .amdhsa_kernarg_size 96
  .amdhsa_user_sgpr_count 2
  .amdhsa_user_sgpr_kernarg_segment_ptr 1
  .amdhsa_system_sgpr_workgroup_id_x 1
.end_amdhsa_kernel
```
